```python
import torch

def _softmax(x, axis=-1):
    return torch.softmax(x, dim=axis)
def _gelu(x):
    return torch.nn.functional.gelu(x, approximate="tanh")
def _silu(x):
    return torch.nn.functional.silu(x)
def _sigmoid(x):
    return torch.sigmoid(x)
def _layernorm(x, axis=-1, eps=1e-5):
    m = x.mean(dim=axis, keepdim=True)
    v = x.var(dim=axis, keepdim=True, unbiased=False)
    return (x - m) / torch.sqrt(v + eps)
def _scatter_add(tgt, idx, src, axis=0):
    return tgt.clone().index_add_(axis, idx, src)
def _segment_sum(src, seg, n):
    out = torch.zeros((n,) + src.shape[1:], dtype=src.dtype)
    return out.index_add_(0, seg, src)
def _pad(x, pw):
    flat = tuple(v for pair in reversed(pw) for v in pair)
    return torch.nn.functional.pad(x, flat)

kernel_name = 'parallel_sum__sliding_block__dense_activation_silu__prompt'

def setup_inputs():

    _w = (lambda a: (lambda t: t.to(torch.bfloat16) if t.is_floating_point() else t)(torch.as_tensor(a)))
    def _A_setup():
        B, S, D = 1, 2048, 640
        return {
            "x": _w((lambda *s: torch.randn(*s, dtype=torch.bfloat16) * 0.05)(B, S, D)),
            "wqkv": _w((lambda *s: torch.randn(*s, dtype=torch.bfloat16) * 0.05)(D, 3 * D)),
            "wo": _w((lambda *s: torch.randn(*s, dtype=torch.bfloat16) * 0.05)(D, D)),
        }
    _A_in = _A_setup()

    def _B_setup():
        B, S, D, F = 1, 2048, 640, 1728
        return {
            "x": _w((lambda *s: torch.randn(*s, dtype=torch.bfloat16) * 0.05)(B, S, D)),
            "w1": _w((lambda *s: torch.randn(*s, dtype=torch.bfloat16) * 0.8)(D, F) * (D ** -0.5)),
            "w2": _w((lambda *s: torch.randn(*s, dtype=torch.bfloat16) * 0.8)(F, D) * (F ** -0.5)),
        }
    _B_in = _B_setup()

    return {
        "A_x": _A_in["x"],
        "A_wqkv": _A_in["wqkv"],
        "A_wo": _A_in["wo"],
        "B_x": _B_in["x"],
        "B_w1": _B_in["w1"],
        "B_w2": _B_in["w2"],
    }

def reference(A_x, A_wqkv, A_wo, B_x, B_w1, B_w2):
    def _A_ref(x, wqkv, wo):
        B, S, D = x.shape
        H = 32; Dh = D // H; W = 256
        qkv = (lambda x, *d: x.permute(*d))((x @ wqkv).reshape(B, S, 3, H, Dh), 2, 0, 3, 1, 4)
        q, k, v = qkv[0], qkv[1], qkv[2]
        scores = torch.einsum("bhqd,bhkd->bhqk", q, k) * (Dh ** -0.5)
        idx = torch.arange(S)
        mask = (idx[:, None] - idx[None, :] >= 0) & (idx[:, None] - idx[None, :] < W)
        scores = torch.where(mask[None, None], scores, -1e9)
        p = _softmax(scores, axis=-1)
        o = torch.einsum("bhqk,bhkd->bhqd", p, v)
        return (lambda x, *d: x.permute(*d))(o, 0, 2, 1, 3).reshape(B, S, D) @ wo

    def _B_ref(x, w1, w2):
        h = torch.einsum("bsd,df->bsf", x, w1)
        h = _silu(h)
        out = torch.einsum("bsf,fd->bsd", h, w2)
        return out

    x = A_x
    xn = _layernorm(x, axis=-1)
    return x + _A_ref(xn, A_wqkv, A_wo) + _B_ref(xn, B_w1, B_w2)
```

```asm
; @launch grid=(256,1,1) block=(256,1,1) lds=163840
.amdgcn_target "amdgcn-amd-amdhsa--gfx950"
.text
.globl parallel_sum__sliding_block__dense_activation_silu__prompt_kernel
.p2align 8
.type parallel_sum__sliding_block__dense_activation_silu__prompt_kernel,@function
parallel_sum__sliding_block__dense_activation_silu__prompt_kernel:
    s_cmp_ge_u32 s2, 256
    s_cbranch_scc0 L_start
    s_endpgm
L_start:
    s_load_dwordx2 s[4:5], s[0:1], 0
    s_load_dwordx2 s[8:9], s[0:1], 8
    s_load_dwordx2 s[12:13], s[0:1], 32
    s_load_dwordx2 s[16:17], s[0:1], 64
    s_load_dwordx2 s[20:21], s[0:1], 48
    s_load_dwordx2 s[24:25], s[0:1], 56
    s_load_dwordx2 s[28:29], s[0:1], 40
    s_load_dwordx2 s[32:33], s[0:1], 16
    v_lshrrev_b32 v1, 6, v0
    v_and_b32 v0, 63, v0
    v_readfirstlane_b32 s36, v1
    v_lshlrev_b32 v21, 4, v0
    s_mov_b32 s6, 2621440
    s_mov_b32 s7, 0x20000
    s_mov_b32 s10, 2457600
    s_mov_b32 s11, 0x20000
    s_and_b32 s47, s2, 3
    s_lshr_b32 s46, s2, 3
    s_mul_i32 s48, s47, 30
    s_add_u32 s48, s48, s46
    s_lshr_b32 s38, s48, 3
    s_and_b32 s48, s48, 7
    s_lshl_b32 s47, s47, 1
    s_add_u32 s47, s47, s46
    s_sub_u32 s47, s47, 30
    s_cmp_ge_u32 s46, 30
    s_cselect_b32 s48, s47, s48
    s_cselect_b32 s38, 15, s38
    s_and_b32 s47, s2, 4
    s_lshl_b32 s47, s47, 1
    s_add_u32 s37, s47, s48
    s_lshl_b32 s51, s36, 12
    s_add_u32 s52, s51, 65536
    s_cmp_eq_u32 s38, 15
    s_cbranch_scc0 L_gemm
    s_branch L_retile
L_gemm:
    v_lshrrev_b32 v34, 3, v0
    v_lshrrev_b32 v35, 4, v0
    v_and_b32 v36, 7, v0
    v_xor_b32 v36, v36, v35
    v_mul_u32_u24 v37, 1280, v34
    v_lshl_add_u32 v1, v36, 4, v37
    v_xor_b32 v36, 4, v36
    v_lshl_add_u32 v2, v36, 4, v37
    v_add_u32 v2, 9216, v2
    v_add_u32 v3, 18432, v1
    v_add_u32 v4, 18432, v2
    v_and_b32 v36, 15, v0
    v_lshlrev_b32 v38, 2, v35
    v_xor_b32 v39, v36, v38
    v_mul_u32_u24 v37, 3840, v35
    v_lshl_add_u32 v5, v39, 4, v37
    v_add_u32 v6, 14336, v5
    v_add_u32 v7, 28672, v5
    v_add_u32 v8, 43008, v5
    s_lshl_b32 s47, s37, 2
    s_add_u32 s47, s47, s36
    s_mul_i32 s49, s47, 40960
    s_mul_i32 s50, s36, 61440
    s_lshl_b32 s48, s38, 8
    s_add_u32 s50, s50, s48
    s_add_u32 s93, s37, s38
    s_mul_i32 s89, s93, 52
    s_lshr_b32 s89, s89, 8
    s_mul_i32 s89, s89, 5
    s_sub_u32 s93, s93, s89
    v_and_b32 v88, 31, v0
    v_lshrrev_b32 v89, 5, v0
    v_mul_u32_u24 v90, 1280, v89
    v_lshl_add_u32 v90, v88, 4, v90
    v_bfe_u32 v91, v0, 4, 1
    v_lshl_add_u32 v91, v91, 30, v90
    s_lshl_b32 s86, s37, 4
    s_add_u32 s86, s86, s38
    s_lshl_b32 s86, s86, 2
    s_add_u32 s86, s86, s36
    s_mul_i32 s87, s86, 2560
    s_waitcnt lgkmcnt(0)
    buffer_load_dwordx4 v[92:95], v90, s[4:7], s87 offen
    buffer_load_dwordx4 v[96:99], v90, s[4:7], s87 offen offset:512
    buffer_load_dwordx4 v[100:103], v91, s[4:7], s87 offen offset:1024
    s_lshl_b32 s45, s93, 7
    s_add_u32 m0, s52, 0
    s_add_u32 s45, s45, s49
    buffer_load_dwordx4 v1, s[4:7], s45 offen offset:0 lds
    buffer_load_dwordx4 v2, s[4:7], s45 offen offset:1024 lds
    buffer_load_dwordx4 v3, s[4:7], s45 offen offset:2048 lds
    buffer_load_dwordx4 v4, s[4:7], s45 offen offset:3072 lds
    s_mul_i32 s46, s93, 245760
    s_add_u32 m0, s51, 0
    s_add_u32 s46, s46, s50
    buffer_load_dwordx4 v5, s[8:11], s46 offen offset:0 lds
    buffer_load_dwordx4 v6, s[8:11], s46 offen offset:1024 lds
    buffer_load_dwordx4 v7, s[8:11], s46 offen offset:2048 lds
    buffer_load_dwordx4 v8, s[8:11], s46 offen offset:3072 lds
    s_getpc_b64 s[66:67]
L_pc1:
    s_sub_u32 s66, s66, L_pc1-parallel_sum__sliding_block__dense_activation_silu__prompt_kernel
    s_subb_u32 s67, s67, 0
    s_lshr_b32 s65, s2, 3
    s_lshl_b32 s65, s65, 2
    s_add_u32 s65, s65, s36
    s_lshl_b32 s65, s65, 10
    s_min_u32 s65, s65, (L_codeend-parallel_sum__sliding_block__dense_activation_silu__prompt_kernel-1024)&0xffffff80
    v_add_u32 v249, s65, v21
    global_load_dwordx4 v[244:247], v249, s[66:67]
    s_mov_b32 s14, 2211840
    s_mov_b32 s15, 0x20000
    s_mov_b32 s18, 20795392
    s_mov_b32 s19, 0x20000
    s_mov_b32 s22, 2621440
    s_mov_b32 s23, 0x20000
    s_mov_b32 s26, 256
    s_mov_b32 s27, 0x20000
    s_mov_b32 s30, 2211840
    s_mov_b32 s31, 0x20000
    s_mov_b32 s34, 819200
    s_mov_b32 s35, 0x20000
    s_and_b32 s90, s2, 7
    s_lshr_b32 s91, s2, 3
    s_lshr_b32 s48, s91, 2
    s_lshr_b32 s47, s90, 1
    s_lshl_b32 s47, s47, 3
    s_add_u32 s41, s47, s48
    s_and_b32 s48, s91, 3
    s_and_b32 s47, s90, 1
    s_lshl_b32 s47, s47, 2
    s_add_u32 s42, s47, s48
    s_lshr_b32 s39, s91, 1
    s_and_b32 s48, s91, 1
    s_lshl_b32 s47, s90, 1
    s_add_u32 s40, s47, s48
    s_and_b32 s43, s36, 1
    s_lshr_b32 s44, s36, 1
    s_mov_b32 s58, 0x3f803f80
    v_cmp_eq_u32 vcc, 0, v0
    v_mov_b32 v252, 0x7ff00000
    v_mov_b32 v253, 1
    v_cndmask_b32_e64 v252, v252, 0, vcc
    s_add_u32 s94, s93, 1
    s_cmp_eq_u32 s94, 5
    s_cselect_b32 s94, 0, s94
    s_add_u32 s95, s94, 1
    s_cmp_eq_u32 s95, 5
    s_cselect_b32 s95, 0, s95
    s_add_u32 s96, s95, 1
    s_cmp_eq_u32 s96, 5
    s_cselect_b32 s96, 0, s96
    s_add_u32 s97, s96, 1
    s_cmp_eq_u32 s97, 5
    s_cselect_b32 s97, 0, s97
    s_add_u32 s98, s49, 640
    s_add_u32 s99, s50, 1228800
    v_and_b32 v34, 31, v0
    v_lshrrev_b32 v36, 5, v0
    v_bfe_u32 v37, v0, 1, 3
    v_xor_b32 v37, v37, v36
    s_lshl_b32 s47, s44, 2
    v_xor_b32 v37, s47, v37
    v_lshlrev_b32 v38, 7, v34
    v_add_u32 v38, s52, v38
    v_lshl_add_u32 v9, v37, 4, v38
    v_xor_b32 v10, 32, v9
    v_xor_b32 v11, 64, v9
    v_xor_b32 v12, 96, v9
    v_and_b32 v37, 15, v0
    v_lshrrev_b32 v38, 4, v0
    s_lshl_b32 s47, s43, 7
    s_lshl_b32 s48, s44, 10
    s_add_u32 s47, s47, s48
    s_add_u32 s47, s47, 157696
    v_lshlrev_b32 v39, 4, v38
    v_lshl_add_u32 v39, v37, 6, v39
    v_add_u32 v39, s47, v39
    v_add_u32 v35, 159744, v21
    v_cmp_gt_u32 vcc, 2, v37
    s_nop 1
    v_cndmask_b32 v25, v35, v39, vcc
    v_and_b32 v38, 1, v38
    v_cmp_eq_u32 vcc, v37, v38
    v_mov_b32 v39, s58
    s_nop 0
    v_cndmask_b32_e64 v38, 0, v39, vcc
    v_accvgpr_write_b32 a252, v38
    v_accvgpr_write_b32 a253, v38
    v_accvgpr_write_b32 a254, v38
    v_accvgpr_write_b32 a255, v38
    s_lshl_b32 s59, s38, 1
    s_add_u32 s47, s38, 12
    s_cmp_lt_u32 s38, 12
    s_cselect_b32 s59, s59, s47
    s_add_u32 s60, s59, 1
    s_cmp_ge_u32 s38, 10
    s_cbranch_scc0 L_p1qk
    s_branch L_p1v
L_p1qk:
    v_and_b32 v34, 15, v0
    v_lshrrev_b32 v35, 2, v34
    v_bfe_u32 v37, v0, 1, 1
    v_and_b32 v36, 1, v0
    v_lshl_add_u32 v36, v36, 1, v37
    v_lshrrev_b32 v37, 5, v0
    v_lshl_add_u32 v37, v37, 3, v35
    v_lshlrev_b32 v37, 8, v37
    v_lshl_add_u32 v37, v36, 3, v37
    v_bfe_u32 v38, v0, 4, 1
    v_lshl_add_u32 v37, v38, 5, v37
    v_xor_b32 v35, s43, v35
    s_lshl_b32 s47, s44, 13
    v_add_u32 v37, s47, v37
    v_lshl_add_u32 v13, v35, 6, v37
    v_xor_b32 v14, 0x2000, v13
    v_xor_b32 v15, 64, v13
    v_xor_b32 v16, 64, v14
    v_xor_b32 v17, 0x80, v13
    v_xor_b32 v18, 0x80, v14
    v_xor_b32 v19, 0xc0, v13
    v_xor_b32 v20, 0xc0, v14
    v_and_b32 v37, 31, v0
    v_lshlrev_b32 v38, 2, v37
    s_lshl_b32 s47, s43, 7
    s_add_u32 s48, s47, 157696
    s_sub_u32 s47, 157696, s47
    v_add_u32 v23, s48, v38
    v_add_u32 v24, s47, v38
    v_mov_b32 v226, 0
    v_mov_b32 v227, 0
    v_mov_b32 v230, 0
    v_mov_b32 v231, 0
    v_mov_b32 v234, 0
    v_mov_b32 v235, 0
    s_lshl_b32 s47, s37, 2
    s_add_u32 s47, s47, s36
    s_mul_i32 s45, s47, 81920
    s_lshl_b32 s48, s38, 13
    s_add_u32 s45, s45, s48
    s_lshl_b32 s48, s43, 11
    s_cmp_lt_u32 s38, 5
    s_cselect_b32 s57, 0x3ea52b5c, 1.0
    s_add_u32 s53, s45, s48
    s_sub_u32 s54, s45, s48
    s_add_u32 s54, s54, 2048
    s_add_u32 s55, s53, 4096
    s_add_u32 s56, s54, 4096
    s_lshl_b32 s45, s94, 7
    s_add_u32 m0, s52, 16384
    s_add_u32 s45, s45, s49
    buffer_load_dwordx4 v1, s[4:7], s45 offen offset:0 lds
    buffer_load_dwordx4 v2, s[4:7], s45 offen offset:1024 lds
    buffer_load_dwordx4 v3, s[4:7], s45 offen offset:2048 lds
    buffer_load_dwordx4 v4, s[4:7], s45 offen offset:3072 lds
    s_mul_i32 s46, s94, 245760
    s_add_u32 m0, s51, 16384
    s_add_u32 s46, s46, s50
    buffer_load_dwordx4 v5, s[8:11], s46 offen offset:0 lds
    buffer_load_dwordx4 v6, s[8:11], s46 offen offset:1024 lds
    buffer_load_dwordx4 v7, s[8:11], s46 offen offset:2048 lds
    buffer_load_dwordx4 v8, s[8:11], s46 offen offset:3072 lds
    v_mov_b32 v90, 0
    v_mov_b32 v91, 0
    v_cmp_ne_u32 vcc, 0, v88
    v_lshlrev_b32 v89, 3, v89
    s_lshl_b32 s86, s86, 4
    s_add_u32 s86, s86, 20643840
    v_mov_b32 v88, 0x7ff00000
    v_cndmask_b32 v86, v89, v88, vcc
    s_waitcnt vmcnt(19)
    v_dot2c_f32_bf16 v90, s58, v92
    v_dot2c_f32_bf16 v91, v92, v92
    v_dot2c_f32_bf16 v90, s58, v93
    v_dot2c_f32_bf16 v91, v93, v93
    v_dot2c_f32_bf16 v90, s58, v94
    v_dot2c_f32_bf16 v91, v94, v94
    v_dot2c_f32_bf16 v90, s58, v95
    v_dot2c_f32_bf16 v91, v95, v95
    s_waitcnt vmcnt(18)
    v_dot2c_f32_bf16 v90, s58, v96
    v_dot2c_f32_bf16 v91, v96, v96
    v_dot2c_f32_bf16 v90, s58, v97
    v_dot2c_f32_bf16 v91, v97, v97
    v_dot2c_f32_bf16 v90, s58, v98
    v_dot2c_f32_bf16 v91, v98, v98
    v_dot2c_f32_bf16 v90, s58, v99
    v_dot2c_f32_bf16 v91, v99, v99
    s_waitcnt vmcnt(17)
    v_dot2c_f32_bf16 v90, s58, v100
    v_dot2c_f32_bf16 v91, v100, v100
    v_dot2c_f32_bf16 v90, s58, v101
    v_dot2c_f32_bf16 v91, v101, v101
    v_dot2c_f32_bf16 v90, s58, v102
    v_dot2c_f32_bf16 v91, v102, v102
    v_dot2c_f32_bf16 v90, s58, v103
    v_dot2c_f32_bf16 v91, v103, v103
    s_waitcnt vmcnt(9)
    s_barrier
    ds_read_b128 a[92:95], v9 offset:0
    ds_read_b64_tr_b16 v[40:41], v13 offset:0
    ds_read_b64_tr_b16 v[42:43], v13 offset:1024
    ds_read_b64_tr_b16 v[44:45], v15 offset:0
    ds_read_b64_tr_b16 v[46:47], v15 offset:1024
    ds_read_b64_tr_b16 v[48:49], v17 offset:0
    ds_read_b64_tr_b16 v[50:51], v17 offset:1024
    ds_read_b64_tr_b16 v[52:53], v19 offset:0
    ds_read_b64_tr_b16 v[54:55], v19 offset:1024
    ds_read_b128 a[96:99], v10 offset:0
    ds_read_b64_tr_b16 v[56:57], v13 offset:4096
    ds_read_b64_tr_b16 v[58:59], v13 offset:5120
    ds_read_b64_tr_b16 v[60:61], v15 offset:4096
    ds_read_b64_tr_b16 v[62:63], v15 offset:5120
    ds_read_b64_tr_b16 v[64:65], v17 offset:4096
    s_waitcnt lgkmcnt(14)
    ds_read_b64_tr_b16 v[66:67], v17 offset:5120
    s_waitcnt lgkmcnt(14)
    ds_read_b64_tr_b16 v[68:69], v19 offset:4096
    s_waitcnt lgkmcnt(14)
    ds_read_b64_tr_b16 v[70:71], v19 offset:5120
    v_mfma_f32_32x32x16_bf16 v[112:127], v[40:43], a[92:95], 0
    s_lshl_b32 s45, s95, 7
    s_add_u32 m0, s52, 32768
    s_add_u32 s45, s45, s49
    buffer_load_dwordx4 v1, s[4:7], s45 offen offset:0 lds
    v_mfma_f32_16x16x32_bf16 v[26:29], v[40:43], a[252:255], 0
    s_waitcnt lgkmcnt(9)
    v_mfma_f32_32x32x16_bf16 v[128:143], v[44:47], a[92:95], 0
    ds_read_b64_tr_b16 v[40:41], v14 offset:0
    ds_read_b64_tr_b16 v[42:43], v14 offset:1024
    ds_read_b128 a[100:103], v11 offset:0
    buffer_load_dwordx4 v2, s[4:7], s45 offen offset:1024 lds
    v_mfma_f32_32x32x16_bf16 v[144:159], v[48:51], a[92:95], 0
    ds_read_b64_tr_b16 v[44:45], v16 offset:0
    ds_read_b64_tr_b16 v[46:47], v16 offset:1024
    buffer_load_dwordx4 v3, s[4:7], s45 offen offset:2048 lds
    v_mfma_f32_16x16x32_bf16 v[80:83], v[48:51], a[252:255], 0
    v_mfma_f32_32x32x16_bf16 v[160:175], v[52:55], a[92:95], 0
    ds_read_b64_tr_b16 v[48:49], v18 offset:0
    s_waitcnt lgkmcnt(6)
    ds_read_b64_tr_b16 v[50:51], v18 offset:1024
    buffer_load_dwordx4 v4, s[4:7], s45 offen offset:3072 lds
    v_mfma_f32_32x32x16_bf16 v[112:127], v[56:59], a[96:99], v[112:127]
    ds_read_b64_tr_b16 v[52:53], v20 offset:0
    ds_read_b64_tr_b16 v[54:55], v20 offset:1024
    s_mul_i32 s46, s95, 245760
    s_add_u32 m0, s51, 32768
    s_add_u32 s46, s46, s50
    buffer_load_dwordx4 v5, s[8:11], s46 offen offset:0 lds
    v_mfma_f32_16x16x32_bf16 v[26:29], v[56:59], a[252:255], v[26:29]
    v_add_f32_dpp v90, v90, v90 quad_perm:[1,0,3,2] row_mask:0xf bank_mask:0xf
    v_add_f32_dpp v91, v91, v91 quad_perm:[1,0,3,2] row_mask:0xf bank_mask:0xf
    v_mfma_f32_32x32x16_bf16 v[128:143], v[60:63], a[96:99], v[128:143]
    ds_read_b64_tr_b16 v[56:57], v14 offset:4096
    ds_read_b64_tr_b16 v[58:59], v14 offset:5120
    ds_read_b128 a[104:107], v12 offset:0
    buffer_load_dwordx4 v6, s[8:11], s46 offen offset:1024 lds
    v_mfma_f32_32x32x16_bf16 v[144:159], v[64:67], a[96:99], v[144:159]
    ds_read_b64_tr_b16 v[60:61], v16 offset:4096
    ds_read_b64_tr_b16 v[62:63], v16 offset:5120
    buffer_load_dwordx4 v7, s[8:11], s46 offen offset:2048 lds
    v_mfma_f32_16x16x32_bf16 v[80:83], v[64:67], a[252:255], v[80:83]
    v_add_f32_dpp v90, v90, v90 quad_perm:[2,3,0,1] row_mask:0xf bank_mask:0xf
    v_add_f32_dpp v91, v91, v91 quad_perm:[2,3,0,1] row_mask:0xf bank_mask:0xf
    v_mfma_f32_32x32x16_bf16 v[160:175], v[68:71], a[96:99], v[160:175]
    ds_read_b64_tr_b16 v[64:65], v18 offset:4096
    s_waitcnt lgkmcnt(6)
    ds_read_b64_tr_b16 v[66:67], v18 offset:5120
    buffer_load_dwordx4 v8, s[8:11], s46 offen offset:3072 lds
    v_mfma_f32_32x32x16_bf16 v[112:127], v[40:43], a[100:103], v[112:127]
    ds_read_b64_tr_b16 v[68:69], v20 offset:4096
    ds_read_b64_tr_b16 v[70:71], v20 offset:5120
    s_waitcnt vmcnt(8)
    s_barrier
    v_add_f32_dpp v90, v90, v90 row_half_mirror row_mask:0xf bank_mask:0xf
    v_mfma_f32_32x32x16_bf16 v[128:143], v[44:47], a[100:103], v[128:143]
    ds_read_b64_tr_b16 v[40:41], v13 offset:16384
    ds_read_b64_tr_b16 v[42:43], v13 offset:17408
    ds_read_b128 a[124:127], v9 offset:16384
    s_lshl_b32 s45, s93, 7
    s_add_u32 m0, s52, 49152
    s_add_u32 s45, s45, s98
    buffer_load_dwordx4 v1, s[4:7], s45 offen offset:0 lds
    v_mfma_f32_32x32x16_bf16 v[144:159], v[48:51], a[100:103], v[144:159]
    ds_read_b64_tr_b16 v[44:45], v15 offset:16384
    ds_read_b64_tr_b16 v[46:47], v15 offset:17408
    v_add_f32_dpp v91, v91, v91 row_half_mirror row_mask:0xf bank_mask:0xf
    v_add_f32_dpp v90, v90, v90 row_mirror row_mask:0xf bank_mask:0xf
    s_nop 0
    v_add_f32_dpp v91, v91, v91 row_mirror row_mask:0xf bank_mask:0xf
    v_mov_b32 v92, v90
    v_mfma_f32_32x32x16_bf16 v[160:175], v[52:55], a[100:103], v[160:175]
    ds_read_b64_tr_b16 v[48:49], v17 offset:16384
    s_waitcnt lgkmcnt(6)
    ds_read_b64_tr_b16 v[50:51], v17 offset:17408
    buffer_load_dwordx4 v2, s[4:7], s45 offen offset:1024 lds
    v_mfma_f32_32x32x16_bf16 v[112:127], v[56:59], a[104:107], v[112:127]
    ds_read_b64_tr_b16 v[52:53], v19 offset:16384
    ds_read_b64_tr_b16 v[54:55], v19 offset:17408
    v_mov_b32 v93, v91
    v_permlane16_swap_b32 v90, v92
    s_nop 0
    v_permlane16_swap_b32 v91, v93
    v_mfma_f32_32x32x16_bf16 v[128:143], v[60:63], a[104:107], v[128:143]
    ds_read_b64_tr_b16 v[56:57], v13 offset:20480
    ds_read_b64_tr_b16 v[58:59], v13 offset:21504
    ds_read_b128 a[128:131], v10 offset:16384
    buffer_load_dwordx4 v3, s[4:7], s45 offen offset:2048 lds
    v_mfma_f32_32x32x16_bf16 v[144:159], v[64:67], a[104:107], v[144:159]
    ds_read_b64_tr_b16 v[60:61], v15 offset:20480
    ds_read_b64_tr_b16 v[62:63], v15 offset:21504
    buffer_load_dwordx4 v4, s[4:7], s45 offen offset:3072 lds
    v_mfma_f32_32x32x16_bf16 v[160:175], v[68:71], a[104:107], v[160:175]
    ds_read_b64_tr_b16 v[64:65], v17 offset:20480
    s_waitcnt lgkmcnt(8)
    ds_read_b64_tr_b16 v[66:67], v17 offset:21504
    v_add_f32 v90, v90, v92
    v_add_f32 v91, v91, v93
    v_mul_f32 v90, 0x3acccccd, v90
    v_mul_f32 v91, 0x3acccccd, v91
    v_mfma_f32_32x32x16_bf16 v[112:127], v[40:43], a[124:127], v[112:127]
    ds_read_b64_tr_b16 v[68:69], v19 offset:20480
    ds_read_b64_tr_b16 v[70:71], v19 offset:21504
    s_mul_i32 s46, s93, 245760
    s_add_u32 m0, s51, 49152
    s_add_u32 s46, s46, s99
    buffer_load_dwordx4 v5, s[8:11], s46 offen offset:0 lds
    v_mfma_f32_16x16x32_bf16 v[26:29], v[40:43], a[252:255], v[26:29]
    v_fma_f32 v91, -v90, v90, v91
    v_max_f32 v91, 0, v91
    v_mfma_f32_32x32x16_bf16 v[128:143], v[44:47], a[124:127], v[128:143]
    ds_read_b64_tr_b16 v[40:41], v14 offset:16384
    ds_read_b64_tr_b16 v[42:43], v14 offset:17408
    ds_read_b128 a[132:135], v11 offset:16384
    v_cvt_pk_bf16_f32 v84, v90, v91
    v_and_b32 v85, 0xffff0000, v84
    v_mfma_f32_32x32x16_bf16 v[144:159], v[48:51], a[124:127], v[144:159]
    ds_read_b64_tr_b16 v[44:45], v16 offset:16384
    s_waitcnt lgkmcnt(6)
    ds_read_b64_tr_b16 v[46:47], v16 offset:17408
    v_and_b32 v84, 0xffff, v84
    v_add_f32 v85, 0x3727c5ac, v85
    v_xor_b32 v84, 0x8000, v84
    v_cvt_pk_bf16_f32 v85, v85, v85
    v_mfma_f32_16x16x32_bf16 v[80:83], v[48:51], a[252:255], v[80:83]
    v_lshlrev_b32 v85, 16, v85
    v_lshrrev_b32 v104, 4, v0
    v_mfma_f32_32x32x16_bf16 v[160:175], v[52:55], a[124:127], v[160:175]
    ds_read_b64_tr_b16 v[48:49], v18 offset:16384
    ds_read_b64_tr_b16 v[50:51], v18 offset:17408
    buffer_load_dwordx4 v6, s[8:11], s46 offen offset:1024 lds
    v_mfma_f32_32x32x16_bf16 v[112:127], v[56:59], a[128:131], v[112:127]
    ds_read_b64_tr_b16 v[52:53], v20 offset:16384
    ds_read_b64_tr_b16 v[54:55], v20 offset:17408
    buffer_load_dwordx4 v7, s[8:11], s46 offen offset:2048 lds
    v_mfma_f32_16x16x32_bf16 v[26:29], v[56:59], a[252:255], v[26:29]
    v_sqrt_f32 v85, v85
    v_mfma_f32_32x32x16_bf16 v[128:143], v[60:63], a[128:131], v[128:143]
    ds_read_b64_tr_b16 v[56:57], v14 offset:20480
    ds_read_b64_tr_b16 v[58:59], v14 offset:21504
    ds_read_b128 a[136:139], v12 offset:16384
    v_cvt_pk_bf16_f32 v85, v85, v85
    v_lshlrev_b32 v85, 16, v85
    v_mfma_f32_32x32x16_bf16 v[144:159], v[64:67], a[128:131], v[144:159]
    ds_read_b64_tr_b16 v[60:61], v16 offset:20480
    s_waitcnt lgkmcnt(6)
    ds_read_b64_tr_b16 v[62:63], v16 offset:21504
    buffer_load_dwordx4 v8, s[8:11], s46 offen offset:3072 lds
    v_mfma_f32_16x16x32_bf16 v[80:83], v[64:67], a[252:255], v[80:83]
    v_and_b32 v105, 15, v0
    v_lshlrev_b32 v107, 2, v104
    v_mfma_f32_32x32x16_bf16 v[160:175], v[68:71], a[128:131], v[160:175]
    ds_read_b64_tr_b16 v[64:65], v18 offset:20480
    ds_read_b64_tr_b16 v[66:67], v18 offset:21504
    v_xor_b32 v108, v105, v107
    v_lshrrev_b32 v105, 3, v108
    v_mul_u32_u24 v105, 320, v105
    v_add_u32 v104, v105, v104
    v_mfma_f32_32x32x16_bf16 v[112:127], v[40:43], a[132:135], v[112:127]
    ds_read_b64_tr_b16 v[68:69], v20 offset:20480
    ds_read_b64_tr_b16 v[70:71], v20 offset:21504
    s_waitcnt vmcnt(8)
    s_barrier
    v_and_b32 v250, 3, v0
    v_mfma_f32_32x32x16_bf16 v[128:143], v[44:47], a[132:135], v[128:143]
    ds_read_b64_tr_b16 v[40:41], v13 offset:32768
    ds_read_b64_tr_b16 v[42:43], v13 offset:33792
    ds_read_b128 a[156:159], v9 offset:32768
    s_lshl_b32 s45, s96, 7
    s_add_u32 m0, s52, 0
    s_add_u32 s45, s45, s49
    buffer_load_dwordx4 v1, s[4:7], s45 offen offset:0 lds
    v_lshlrev_b32 v250, 2, v250
    v_mfma_f32_32x32x16_bf16 v[144:159], v[48:51], a[132:135], v[144:159]
    ds_read_b64_tr_b16 v[44:45], v15 offset:32768
    s_waitcnt lgkmcnt(6)
    ds_read_b64_tr_b16 v[46:47], v15 offset:33792
    v_mul_u32_u24 v106, 3456, v104
    v_and_b32 v108, 7, v108
    v_lshl_add_u32 v236, v108, 4, v106
    v_add_u32 v237, 12800, v236
    v_mfma_f32_32x32x16_bf16 v[160:175], v[52:55], a[132:135], v[160:175]
    ds_read_b64_tr_b16 v[48:49], v17 offset:32768
    ds_read_b64_tr_b16 v[50:51], v17 offset:33792
    buffer_load_dwordx4 v2, s[4:7], s45 offen offset:1024 lds
    buffer_load_dword v251, v250, s[24:27], 0 offen sc1
    v_mfma_f32_32x32x16_bf16 v[112:127], v[56:59], a[136:139], v[112:127]
    ds_read_b64_tr_b16 v[52:53], v19 offset:32768
    ds_read_b64_tr_b16 v[54:55], v19 offset:33792
    v_add_u32 v238, 25600, v236
    v_add_u32 v239, 38400, v236
    v_mfma_f32_32x32x16_bf16 v[128:143], v[60:63], a[136:139], v[128:143]
    ds_read_b64_tr_b16 v[56:57], v13 offset:36864
    ds_read_b64_tr_b16 v[58:59], v13 offset:37888
    ds_read_b128 a[160:163], v10 offset:32768
    buffer_load_dwordx4 v3, s[4:7], s45 offen offset:2048 lds
    v_mfma_f32_32x32x16_bf16 v[144:159], v[64:67], a[136:139], v[144:159]
    ds_read_b64_tr_b16 v[60:61], v15 offset:36864
    s_waitcnt lgkmcnt(8)
    ds_read_b64_tr_b16 v[62:63], v15 offset:37888
    buffer_load_dwordx4 v4, s[4:7], s45 offen offset:3072 lds
    v_mfma_f32_32x32x16_bf16 v[160:175], v[68:71], a[136:139], v[160:175]
    ds_read_b64_tr_b16 v[64:65], v17 offset:36864
    ds_read_b64_tr_b16 v[66:67], v17 offset:37888
    v_mfma_f32_32x32x16_bf16 v[112:127], v[40:43], a[156:159], v[112:127]
    ds_read_b64_tr_b16 v[68:69], v19 offset:36864
    ds_read_b64_tr_b16 v[70:71], v19 offset:37888
    s_mul_i32 s46, s96, 245760
    s_add_u32 m0, s51, 0
    s_add_u32 s46, s46, s50
    buffer_load_dwordx4 v5, s[8:11], s46 offen offset:0 lds
    v_mfma_f32_16x16x32_bf16 v[26:29], v[40:43], a[252:255], v[26:29]
    s_lshl_b32 s92, s37, 2
    s_add_u32 s92, s92, s36
    v_mfma_f32_32x32x16_bf16 v[128:143], v[44:47], a[156:159], v[128:143]
    ds_read_b64_tr_b16 v[40:41], v14 offset:32768
    ds_read_b64_tr_b16 v[42:43], v14 offset:33792
    s_waitcnt lgkmcnt(6)
    ds_read_b128 a[164:167], v11 offset:32768
    s_lshl_b32 s92, s92, 4
    s_add_u32 s92, s92, s38
    v_mfma_f32_32x32x16_bf16 v[144:159], v[48:51], a[156:159], v[144:159]
    ds_read_b64_tr_b16 v[44:45], v16 offset:32768
    ds_read_b64_tr_b16 v[46:47], v16 offset:33792
    s_lshl_b32 s92, s92, 4
    s_add_u32 s92, s92, 20594688
    v_mfma_f32_16x16x32_bf16 v[80:83], v[48:51], a[252:255], v[80:83]
    v_mfma_f32_32x32x16_bf16 v[160:175], v[52:55], a[156:159], v[160:175]
    ds_read_b64_tr_b16 v[48:49], v18 offset:32768
    ds_read_b64_tr_b16 v[50:51], v18 offset:33792
    buffer_load_dwordx4 v6, s[8:11], s46 offen offset:1024 lds
    v_mfma_f32_32x32x16_bf16 v[112:127], v[56:59], a[160:163], v[112:127]
    ds_read_b64_tr_b16 v[52:53], v20 offset:32768
    ds_read_b64_tr_b16 v[54:55], v20 offset:33792
    buffer_load_dwordx4 v7, s[8:11], s46 offen offset:2048 lds
    v_mfma_f32_16x16x32_bf16 v[26:29], v[56:59], a[252:255], v[26:29]
    v_mfma_f32_32x32x16_bf16 v[128:143], v[60:63], a[160:163], v[128:143]
    ds_read_b64_tr_b16 v[56:57], v14 offset:36864
    ds_read_b64_tr_b16 v[58:59], v14 offset:37888
    s_waitcnt lgkmcnt(6)
    ds_read_b128 a[168:171], v12 offset:32768
    v_mfma_f32_32x32x16_bf16 v[144:159], v[64:67], a[160:163], v[144:159]
    ds_read_b64_tr_b16 v[60:61], v16 offset:36864
    ds_read_b64_tr_b16 v[62:63], v16 offset:37888
    buffer_load_dwordx4 v8, s[8:11], s46 offen offset:3072 lds
    v_mfma_f32_16x16x32_bf16 v[80:83], v[64:67], a[252:255], v[80:83]
    v_mfma_f32_32x32x16_bf16 v[160:175], v[68:71], a[160:163], v[160:175]
    ds_read_b64_tr_b16 v[64:65], v18 offset:36864
    ds_read_b64_tr_b16 v[66:67], v18 offset:37888
    v_mfma_f32_32x32x16_bf16 v[112:127], v[40:43], a[164:167], v[112:127]
    ds_read_b64_tr_b16 v[68:69], v20 offset:36864
    ds_read_b64_tr_b16 v[70:71], v20 offset:37888
    s_waitcnt vmcnt(9)
    s_barrier
    v_mfma_f32_32x32x16_bf16 v[128:143], v[44:47], a[164:167], v[128:143]
    ds_read_b64_tr_b16 v[40:41], v13 offset:49152
    ds_read_b64_tr_b16 v[42:43], v13 offset:50176
    s_waitcnt lgkmcnt(8)
    ds_read_b128 a[108:111], v9 offset:49152
    s_lshl_b32 s45, s97, 7
    s_add_u32 m0, s52, 16384
    s_add_u32 s45, s45, s49
    buffer_load_dwordx4 v1, s[4:7], s45 offen offset:0 lds
    v_mfma_f32_32x32x16_bf16 v[144:159], v[48:51], a[164:167], v[144:159]
    ds_read_b64_tr_b16 v[44:45], v15 offset:49152
    ds_read_b64_tr_b16 v[46:47], v15 offset:50176
    v_mfma_f32_32x32x16_bf16 v[160:175], v[52:55], a[164:167], v[160:175]
    ds_read_b64_tr_b16 v[48:49], v17 offset:49152
    ds_read_b64_tr_b16 v[50:51], v17 offset:50176
    buffer_load_dwordx4 v2, s[4:7], s45 offen offset:1024 lds
    v_mfma_f32_32x32x16_bf16 v[112:127], v[56:59], a[168:171], v[112:127]
    ds_read_b64_tr_b16 v[52:53], v19 offset:49152
    ds_read_b64_tr_b16 v[54:55], v19 offset:50176
    s_waitcnt lgkmcnt(8)
    v_mfma_f32_32x32x16_bf16 v[128:143], v[60:63], a[168:171], v[128:143]
    ds_read_b64_tr_b16 v[56:57], v13 offset:53248
    ds_read_b64_tr_b16 v[58:59], v13 offset:54272
    ds_read_b128 a[112:115], v10 offset:49152
    buffer_load_dwordx4 v3, s[4:7], s45 offen offset:2048 lds
    v_mfma_f32_32x32x16_bf16 v[144:159], v[64:67], a[168:171], v[144:159]
    ds_read_b64_tr_b16 v[60:61], v15 offset:53248
    ds_read_b64_tr_b16 v[62:63], v15 offset:54272
    buffer_load_dwordx4 v4, s[4:7], s45 offen offset:3072 lds
    v_mfma_f32_32x32x16_bf16 v[160:175], v[68:71], a[168:171], v[160:175]
    ds_read_b64_tr_b16 v[64:65], v17 offset:53248
    ds_read_b64_tr_b16 v[66:67], v17 offset:54272
    s_waitcnt lgkmcnt(9)
    v_mfma_f32_32x32x16_bf16 v[112:127], v[40:43], a[108:111], v[112:127]
    ds_read_b64_tr_b16 v[68:69], v19 offset:53248
    ds_read_b64_tr_b16 v[70:71], v19 offset:54272
    s_mul_i32 s46, s97, 245760
    s_add_u32 m0, s51, 16384
    s_add_u32 s46, s46, s50
    buffer_load_dwordx4 v5, s[8:11], s46 offen offset:0 lds
    v_mfma_f32_16x16x32_bf16 v[26:29], v[40:43], a[252:255], v[26:29]
    v_mfma_f32_32x32x16_bf16 v[128:143], v[44:47], a[108:111], v[128:143]
    ds_read_b64_tr_b16 v[40:41], v14 offset:49152
    ds_read_b64_tr_b16 v[42:43], v14 offset:50176
    ds_read_b128 a[116:119], v11 offset:49152
    v_mfma_f32_32x32x16_bf16 v[144:159], v[48:51], a[108:111], v[144:159]
    ds_read_b64_tr_b16 v[44:45], v16 offset:49152
    s_waitcnt lgkmcnt(7)
    ds_read_b64_tr_b16 v[46:47], v16 offset:50176
    v_mfma_f32_16x16x32_bf16 v[80:83], v[48:51], a[252:255], v[80:83]
    v_mfma_f32_32x32x16_bf16 v[160:175], v[52:55], a[108:111], v[160:175]
    ds_read_b64_tr_b16 v[48:49], v18 offset:49152
    ds_read_b64_tr_b16 v[50:51], v18 offset:50176
    buffer_load_dwordx4 v6, s[8:11], s46 offen offset:1024 lds
    v_mfma_f32_32x32x16_bf16 v[112:127], v[56:59], a[112:115], v[112:127]
    ds_read_b64_tr_b16 v[52:53], v20 offset:49152
    ds_read_b64_tr_b16 v[54:55], v20 offset:50176
    buffer_load_dwordx4 v7, s[8:11], s46 offen offset:2048 lds
    s_waitcnt vmcnt(13)
    v_cmp_ne_u32 vcc, 0, v251
    s_nop 0
    s_cmp_eq_u64 vcc, -1
    s_cbranch_scc0 L_spin2
L_back2:
    buffer_store_dwordx2 v[84:85], v86, s[16:19], s86 offen sc1
    v_mfma_f32_16x16x32_bf16 v[26:29], v[56:59], a[252:255], v[26:29]
    v_mfma_f32_32x32x16_bf16 v[128:143], v[60:63], a[112:115], v[128:143]
    ds_read_b64_tr_b16 v[56:57], v14 offset:53248
    ds_read_b64_tr_b16 v[58:59], v14 offset:54272
    ds_read_b128 a[120:123], v12 offset:49152
    s_waitcnt lgkmcnt(6)
    v_mfma_f32_32x32x16_bf16 v[144:159], v[64:67], a[112:115], v[144:159]
    ds_read_b64_tr_b16 v[60:61], v16 offset:53248
    ds_read_b64_tr_b16 v[62:63], v16 offset:54272
    buffer_load_dwordx4 v8, s[8:11], s46 offen offset:3072 lds
    v_mfma_f32_16x16x32_bf16 v[80:83], v[64:67], a[252:255], v[80:83]
    v_mfma_f32_32x32x16_bf16 v[160:175], v[68:71], a[112:115], v[160:175]
    ds_read_b64_tr_b16 v[64:65], v18 offset:53248
    ds_read_b64_tr_b16 v[66:67], v18 offset:54272
    v_mfma_f32_32x32x16_bf16 v[112:127], v[40:43], a[116:119], v[112:127]
    ds_read_b64_tr_b16 v[68:69], v20 offset:53248
    ds_read_b64_tr_b16 v[70:71], v20 offset:54272
    s_waitcnt vmcnt(9)
    s_barrier
    v_mfma_f32_32x32x16_bf16 v[128:143], v[44:47], a[116:119], v[128:143]
    ds_read_b64_tr_b16 v[40:41], v13 offset:0
    ds_read_b64_tr_b16 v[42:43], v13 offset:1024
    ds_read_b128 a[188:191], v9 offset:0
    s_lshl_b32 s45, s94, 7
    s_add_u32 m0, s52, 32768
    s_add_u32 s45, s45, s98
    buffer_load_dwordx4 v1, s[4:7], s45 offen offset:0 lds
    s_waitcnt lgkmcnt(7)
    v_mfma_f32_32x32x16_bf16 v[144:159], v[48:51], a[116:119], v[144:159]
    ds_read_b64_tr_b16 v[44:45], v15 offset:0
    ds_read_b64_tr_b16 v[46:47], v15 offset:1024
    v_mfma_f32_32x32x16_bf16 v[160:175], v[52:55], a[116:119], v[160:175]
    ds_read_b64_tr_b16 v[48:49], v17 offset:0
    ds_read_b64_tr_b16 v[50:51], v17 offset:1024
    buffer_load_dwordx4 v2, s[4:7], s45 offen offset:1024 lds
    v_mfma_f32_32x32x16_bf16 v[112:127], v[56:59], a[120:123], v[112:127]
    ds_read_b64_tr_b16 v[52:53], v19 offset:0
    ds_read_b64_tr_b16 v[54:55], v19 offset:1024
    v_mfma_f32_32x32x16_bf16 v[128:143], v[60:63], a[120:123], v[128:143]
    ds_read_b64_tr_b16 v[56:57], v13 offset:4096
    ds_read_b64_tr_b16 v[58:59], v13 offset:5120
    s_waitcnt lgkmcnt(8)
    ds_read_b128 a[192:195], v10 offset:0
    buffer_load_dwordx4 v3, s[4:7], s45 offen offset:2048 lds
    s_mov_b32 s74, s59
    s_mov_b32 s75, s60
    s_mul_i32 s89, s36, 55296
    s_lshl_b32 s59, s59, 7
    s_lshl_b32 s60, s60, 7
    s_add_u32 s59, s59, s89
    s_add_u32 s60, s60, s89
    s_cmp_lt_u32 s38, 12
    s_cselect_b32 s60, s60, 2146435072
    v_mfma_f32_32x32x16_bf16 v[144:159], v[64:67], a[120:123], v[144:159]
    ds_read_b64_tr_b16 v[60:61], v15 offset:4096
    ds_read_b64_tr_b16 v[62:63], v15 offset:5120
    buffer_load_dwordx4 v4, s[4:7], s45 offen offset:3072 lds
    v_mfma_f32_32x32x16_bf16 v[160:175], v[68:71], a[120:123], v[160:175]
    ds_read_b64_tr_b16 v[64:65], v17 offset:4096
    ds_read_b64_tr_b16 v[66:67], v17 offset:5120
    v_mfma_f32_32x32x16_bf16 v[112:127], v[40:43], a[188:191], v[112:127]
    ds_read_b64_tr_b16 v[68:69], v19 offset:4096
    ds_read_b64_tr_b16 v[70:71], v19 offset:5120
    s_mul_i32 s46, s94, 245760
    s_add_u32 m0, s51, 32768
    s_add_u32 s46, s46, s99
    buffer_load_dwordx4 v5, s[8:11], s46 offen offset:0 lds
    v_mfma_f32_16x16x32_bf16 v[26:29], v[40:43], a[252:255], v[26:29]
    s_waitcnt lgkmcnt(6)
    v_mfma_f32_32x32x16_bf16 v[128:143], v[44:47], a[188:191], v[128:143]
    ds_read_b64_tr_b16 v[40:41], v14 offset:0
    ds_read_b64_tr_b16 v[42:43], v14 offset:1024
    ds_read_b128 a[196:199], v11 offset:0
    v_mfma_f32_32x32x16_bf16 v[144:159], v[48:51], a[188:191], v[144:159]
    ds_read_b64_tr_b16 v[44:45], v16 offset:0
    ds_read_b64_tr_b16 v[46:47], v16 offset:1024
    v_mfma_f32_16x16x32_bf16 v[80:83], v[48:51], a[252:255], v[80:83]
    v_mfma_f32_32x32x16_bf16 v[160:175], v[52:55], a[188:191], v[160:175]
    ds_read_b64_tr_b16 v[48:49], v18 offset:0
    ds_read_b64_tr_b16 v[50:51], v18 offset:1024
    buffer_load_dwordx4 v6, s[8:11], s46 offen offset:1024 lds
    s_lshl_b32 s47, s37, 2
    s_add_u32 s47, s47, s36
    s_lshl_b32 s47, s47, 8
    s_add_u32 s47, s47, 20643840
    v_and_b32 v30, 31, v0
    v_lshl_add_u32 v30, v30, 3, s47
    v_mfma_f32_32x32x16_bf16 v[112:127], v[56:59], a[192:195], v[112:127]
    ds_read_b64_tr_b16 v[52:53], v20 offset:0
    ds_read_b64_tr_b16 v[54:55], v20 offset:1024
    buffer_load_dwordx4 v7, s[8:11], s46 offen offset:2048 lds
    v_mfma_f32_16x16x32_bf16 v[26:29], v[56:59], a[252:255], v[26:29]
    v_lshrrev_b32 v37, 3, v0
    v_and_b32 v38, 7, v0
    s_waitcnt lgkmcnt(4)
    v_mfma_f32_32x32x16_bf16 v[128:143], v[60:63], a[192:195], v[128:143]
    ds_read_b64_tr_b16 v[56:57], v14 offset:4096
    ds_read_b64_tr_b16 v[58:59], v14 offset:5120
    ds_read_b128 a[200:203], v12 offset:0
    s_mul_i32 s47, s43, 6
    s_lshl_b32 s48, s39, 2
    v_mfma_f32_32x32x16_bf16 v[144:159], v[64:67], a[192:195], v[144:159]
    ds_read_b64_tr_b16 v[60:61], v16 offset:4096
    ds_read_b64_tr_b16 v[62:63], v16 offset:5120
    buffer_load_dwordx4 v8, s[8:11], s46 offen offset:3072 lds
    v_mfma_f32_16x16x32_bf16 v[80:83], v[64:67], a[252:255], v[80:83]
    s_add_u32 s47, s47, s48
    s_sub_u32 s47, s47, 8
    v_mfma_f32_32x32x16_bf16 v[160:175], v[68:71], a[192:195], v[160:175]
    ds_read_b64_tr_b16 v[64:65], v18 offset:4096
    ds_read_b64_tr_b16 v[66:67], v18 offset:5120
    s_add_u32 s48, s48, s36
    v_add_u32 v39, s47, v37
    v_mov_b32 v250, s48
    v_cmp_gt_u32 vcc, 6, v37
    v_mfma_f32_32x32x16_bf16 v[112:127], v[40:43], a[196:199], v[112:127]
    ds_read_b64_tr_b16 v[68:69], v20 offset:4096
    ds_read_b64_tr_b16 v[70:71], v20 offset:5120
    s_waitcnt vmcnt(8)
    s_barrier
    s_lshl_b32 s45, s95, 7
    s_add_u32 m0, s52, 49152
    s_add_u32 s45, s45, s98
    buffer_load_dwordx4 v1, s[4:7], s45 offen offset:0 lds
    v_mfma_f32_32x32x16_bf16 v[128:143], v[44:47], a[196:199], v[128:143]
    ds_read_b64_tr_b16 v[40:41], v13 offset:16384
    ds_read_b64_tr_b16 v[42:43], v13 offset:17408
    s_waitcnt lgkmcnt(6)
    ds_read_b128 a[220:223], v9 offset:16384
    v_cndmask_b32 v39, v250, v39, vcc
    s_mul_i32 s47, s44, 5
    v_mfma_f32_32x32x16_bf16 v[144:159], v[48:51], a[196:199], v[144:159]
    ds_read_b64_tr_b16 v[44:45], v15 offset:16384
    ds_read_b64_tr_b16 v[46:47], v15 offset:17408
    buffer_load_dwordx4 v2, s[4:7], s45 offen offset:1024 lds
    v_mfma_f32_32x32x16_bf16 v[160:175], v[52:55], a[196:199], v[160:175]
    ds_read_b64_tr_b16 v[48:49], v17 offset:16384
    ds_read_b64_tr_b16 v[50:51], v17 offset:17408
    buffer_load_dwordx4 v3, s[4:7], s45 offen offset:2048 lds
    v_mfma_f32_32x32x16_bf16 v[112:127], v[56:59], a[200:203], v[112:127]
    ds_read_b64_tr_b16 v[52:53], v19 offset:16384
    ds_read_b64_tr_b16 v[54:55], v19 offset:17408
    buffer_load_dwordx4 v4, s[4:7], s45 offen offset:3072 lds
    v_mfma_f32_32x32x16_bf16 v[128:143], v[60:63], a[200:203], v[128:143]
    ds_read_b64_tr_b16 v[56:57], v13 offset:20480
    ds_read_b64_tr_b16 v[58:59], v13 offset:21504
    s_waitcnt lgkmcnt(8)
    ds_read_b128 a[224:227], v10 offset:16384
    s_mul_i32 s46, s95, 245760
    s_add_u32 m0, s51, 49152
    s_add_u32 s46, s46, s99
    buffer_load_dwordx4 v5, s[8:11], s46 offen offset:0 lds
    v_mfma_f32_32x32x16_bf16 v[144:159], v[64:67], a[200:203], v[144:159]
    ds_read_b64_tr_b16 v[60:61], v15 offset:20480
    ds_read_b64_tr_b16 v[62:63], v15 offset:21504
    s_add_u32 s47, s47, 5
    v_mov_b32 v250, s47
    v_cndmask_b32_e64 v250, 0, v250, vcc
    v_add_u32 v250, v250, v38
    v_mfma_f32_32x32x16_bf16 v[160:175], v[68:71], a[200:203], v[160:175]
    ds_read_b64_tr_b16 v[64:65], v17 offset:20480
    ds_read_b64_tr_b16 v[66:67], v17 offset:21504
    buffer_load_dwordx4 v6, s[8:11], s46 offen offset:1024 lds
    v_mfma_f32_32x32x16_bf16 v[112:127], v[40:43], a[220:223], v[112:127]
    ds_read_b64_tr_b16 v[68:69], v19 offset:20480
    ds_read_b64_tr_b16 v[70:71], v19 offset:21504
    buffer_load_dwordx4 v7, s[8:11], s46 offen offset:2048 lds
    v_mfma_f32_16x16x32_bf16 v[26:29], v[40:43], a[252:255], v[26:29]
    v_lshlrev_b32 v250, 4, v250
    v_lshl_add_u32 v250, v39, 8, v250
    s_waitcnt lgkmcnt(6)
    v_mfma_f32_32x32x16_bf16 v[128:143], v[44:47], a[220:223], v[128:143]
    ds_read_b64_tr_b16 v[40:41], v14 offset:16384
    ds_read_b64_tr_b16 v[42:43], v14 offset:17408
    ds_read_b128 a[228:231], v11 offset:16384
    buffer_load_dwordx4 v8, s[8:11], s46 offen offset:3072 lds
    v_mfma_f32_32x32x16_bf16 v[144:159], v[48:51], a[220:223], v[144:159]
    ds_read_b64_tr_b16 v[44:45], v16 offset:16384
    ds_read_b64_tr_b16 v[46:47], v16 offset:17408
    s_mul_i32 s46, s93, 221184
    s_add_u32 m0, s51, 131072
    s_add_u32 s46, s46, s59
    buffer_load_dwordx4 v236, s[12:15], s46 offen offset:0 lds
    v_mfma_f32_16x16x32_bf16 v[80:83], v[48:51], a[252:255], v[80:83]
    v_add_u32 v250, 20594688, v250
    v_cmp_gt_i32 s[62:63], 0, v39
    v_mfma_f32_32x32x16_bf16 v[160:175], v[52:55], a[220:223], v[160:175]
    ds_read_b64_tr_b16 v[48:49], v18 offset:16384
    ds_read_b64_tr_b16 v[50:51], v18 offset:17408
    s_mul_i32 s47, s40, 40
    s_add_u32 s48, s47, 39
    s_lshr_b32 s47, s47, 7
    s_lshr_b32 s48, s48, 7
    v_mfma_f32_32x32x16_bf16 v[112:127], v[56:59], a[224:227], v[112:127]
    ds_read_b64_tr_b16 v[52:53], v20 offset:16384
    ds_read_b64_tr_b16 v[54:55], v20 offset:17408
    buffer_load_dwordx4 v237, s[12:15], s46 offen offset:1024 lds
    v_mfma_f32_16x16x32_bf16 v[26:29], v[56:59], a[252:255], v[26:29]
    v_cmp_gt_u32 vcc, s47, v38
    s_waitcnt lgkmcnt(4)
    v_mfma_f32_32x32x16_bf16 v[128:143], v[60:63], a[224:227], v[128:143]
    ds_read_b64_tr_b16 v[56:57], v14 offset:20480
    ds_read_b64_tr_b16 v[58:59], v14 offset:21504
    ds_read_b128 a[232:235], v12 offset:16384
    buffer_load_dwordx4 v238, s[12:15], s46 offen offset:2048 lds
    v_mfma_f32_32x32x16_bf16 v[144:159], v[64:67], a[224:227], v[144:159]
    ds_read_b64_tr_b16 v[60:61], v16 offset:20480
    ds_read_b64_tr_b16 v[62:63], v16 offset:21504
    buffer_load_dwordx4 v239, s[12:15], s46 offen offset:3072 lds
    v_mfma_f32_16x16x32_bf16 v[80:83], v[64:67], a[252:255], v[80:83]
    s_or_b64 s[62:63], s[62:63], vcc
    v_cmp_lt_u32 vcc, s48, v38
    v_mfma_f32_32x32x16_bf16 v[160:175], v[68:71], a[224:227], v[160:175]
    ds_read_b64_tr_b16 v[64:65], v18 offset:20480
    ds_read_b64_tr_b16 v[66:67], v18 offset:21504
    s_or_b64 s[62:63], s[62:63], vcc
    s_or_b32 s63, s63, 0xff000000
    v_cndmask_b32_e64 v250, v250, v252, s[62:63]
    v_mfma_f32_32x32x16_bf16 v[112:127], v[40:43], a[228:231], v[112:127]
    ds_read_b64_tr_b16 v[68:69], v20 offset:20480
    ds_read_b64_tr_b16 v[70:71], v20 offset:21504
    s_waitcnt vmcnt(12)
    s_barrier
    v_mfma_f32_32x32x16_bf16 v[128:143], v[44:47], a[228:231], v[128:143]
    ds_read_b64_tr_b16 v[40:41], v13 offset:32768
    ds_read_b64_tr_b16 v[42:43], v13 offset:33792
    s_waitcnt lgkmcnt(6)
    ds_read_b128 a[140:143], v9 offset:32768
    s_lshl_b32 s45, s96, 7
    s_add_u32 m0, s52, 0
    s_add_u32 s45, s45, s98
    buffer_load_dwordx4 v1, s[4:7], s45 offen offset:0 lds
    v_mfma_f32_32x32x16_bf16 v[144:159], v[48:51], a[228:231], v[144:159]
    ds_read_b64_tr_b16 v[44:45], v15 offset:32768
    ds_read_b64_tr_b16 v[46:47], v15 offset:33792
    v_mfma_f32_32x32x16_bf16 v[160:175], v[52:55], a[228:231], v[160:175]
    ds_read_b64_tr_b16 v[48:49], v17 offset:32768
    ds_read_b64_tr_b16 v[50:51], v17 offset:33792
    buffer_load_dwordx4 v2, s[4:7], s45 offen offset:1024 lds
    v_mfma_f32_32x32x16_bf16 v[112:127], v[56:59], a[232:235], v[112:127]
    ds_read_b64_tr_b16 v[52:53], v19 offset:32768
    ds_read_b64_tr_b16 v[54:55], v19 offset:33792
    v_mfma_f32_32x32x16_bf16 v[128:143], v[60:63], a[232:235], v[128:143]
    ds_read_b64_tr_b16 v[56:57], v13 offset:36864
    ds_read_b64_tr_b16 v[58:59], v13 offset:37888
    s_waitcnt lgkmcnt(8)
    ds_read_b128 a[144:147], v10 offset:32768
    buffer_load_dwordx4 v3, s[4:7], s45 offen offset:2048 lds
    v_mfma_f32_32x32x16_bf16 v[144:159], v[64:67], a[232:235], v[144:159]
    ds_read_b64_tr_b16 v[60:61], v15 offset:36864
    ds_read_b64_tr_b16 v[62:63], v15 offset:37888
    buffer_load_dwordx4 v4, s[4:7], s45 offen offset:3072 lds
    v_mfma_f32_32x32x16_bf16 v[160:175], v[68:71], a[232:235], v[160:175]
    ds_read_b64_tr_b16 v[64:65], v17 offset:36864
    ds_read_b64_tr_b16 v[66:67], v17 offset:37888
    v_mfma_f32_32x32x16_bf16 v[112:127], v[40:43], a[140:143], v[112:127]
    ds_read_b64_tr_b16 v[68:69], v19 offset:36864
    ds_read_b64_tr_b16 v[70:71], v19 offset:37888
    s_mul_i32 s46, s96, 245760
    s_add_u32 m0, s51, 0
    s_add_u32 s46, s46, s99
    buffer_load_dwordx4 v5, s[8:11], s46 offen offset:0 lds
    v_mfma_f32_16x16x32_bf16 v[26:29], v[40:43], a[252:255], v[26:29]
    s_waitcnt lgkmcnt(6)
    v_mfma_f32_32x32x16_bf16 v[128:143], v[44:47], a[140:143], v[128:143]
    ds_read_b64_tr_b16 v[40:41], v14 offset:32768
    ds_read_b64_tr_b16 v[42:43], v14 offset:33792
    ds_read_b128 a[148:151], v11 offset:32768
    v_mfma_f32_32x32x16_bf16 v[144:159], v[48:51], a[140:143], v[144:159]
    ds_read_b64_tr_b16 v[44:45], v16 offset:32768
    ds_read_b64_tr_b16 v[46:47], v16 offset:33792
    s_mul_i32 s76, s44, 1229
    s_add_u32 s76, s76, 410
    s_lshl_b32 s82, s44, 1
    s_lshr_b32 s77, 160, s82
    s_lshr_b32 s80, 2560, s82
    s_lshr_b32 s79, 163840, s44
    s_add_u32 s82, s82, s44
    s_lshr_b32 s78, 81920, s82
    s_mul_i32 s81, s44, 5201920
    s_add_u32 s81, s81, 40960
    s_mul_i32 s80, s80, s40
    s_add_u32 s81, s81, s80
    s_lshl_b32 s82, s39, 1
    s_mul_i32 s80, s43, 3
    s_add_u32 s82, s82, s80
    s_sub_u32 s82, s82, 4
    s_mul_i32 s80, s36, 15360
    s_add_u32 s80, s80, 65536
    v_mfma_f32_16x16x32_bf16 v[80:83], v[48:51], a[252:255], v[80:83]
    v_mfma_f32_32x32x16_bf16 v[160:175], v[52:55], a[140:143], v[160:175]
    ds_read_b64_tr_b16 v[48:49], v18 offset:32768
    ds_read_b64_tr_b16 v[50:51], v18 offset:33792
    buffer_load_dwordx4 v6, s[8:11], s46 offen offset:1024 lds
    v_mfma_f32_32x32x16_bf16 v[112:127], v[56:59], a[144:147], v[112:127]
    ds_read_b64_tr_b16 v[52:53], v20 offset:32768
    ds_read_b64_tr_b16 v[54:55], v20 offset:33792
    buffer_load_dwordx4 v7, s[8:11], s46 offen offset:2048 lds
    v_mfma_f32_16x16x32_bf16 v[26:29], v[56:59], a[252:255], v[26:29]
    s_waitcnt lgkmcnt(4)
    v_mfma_f32_32x32x16_bf16 v[128:143], v[60:63], a[144:147], v[128:143]
    ds_read_b64_tr_b16 v[56:57], v14 offset:36864
    ds_read_b64_tr_b16 v[58:59], v14 offset:37888
    ds_read_b128 a[152:155], v12 offset:32768
    v_mfma_f32_32x32x16_bf16 v[144:159], v[64:67], a[144:147], v[144:159]
    ds_read_b64_tr_b16 v[60:61], v16 offset:36864
    ds_read_b64_tr_b16 v[62:63], v16 offset:37888
    buffer_load_dwordx4 v8, s[8:11], s46 offen offset:3072 lds
    v_mfma_f32_16x16x32_bf16 v[80:83], v[64:67], a[252:255], v[80:83]
    v_mfma_f32_32x32x16_bf16 v[160:175], v[68:71], a[144:147], v[160:175]
    ds_read_b64_tr_b16 v[64:65], v18 offset:36864
    ds_read_b64_tr_b16 v[66:67], v18 offset:37888
    v_mfma_f32_32x32x16_bf16 v[112:127], v[40:43], a[148:151], v[112:127]
    ds_read_b64_tr_b16 v[68:69], v20 offset:36864
    ds_read_b64_tr_b16 v[70:71], v20 offset:37888
    s_waitcnt vmcnt(12)
    s_barrier
    v_mfma_f32_32x32x16_bf16 v[128:143], v[44:47], a[148:151], v[128:143]
    ds_read_b64_tr_b16 v[40:41], v13 offset:49152
    ds_read_b64_tr_b16 v[42:43], v13 offset:50176
    s_waitcnt lgkmcnt(8)
    ds_read_b128 a[172:175], v9 offset:49152
    s_lshl_b32 s45, s97, 7
    s_add_u32 m0, s52, 16384
    s_add_u32 s45, s45, s98
    buffer_load_dwordx4 v1, s[4:7], s45 offen offset:0 lds
    v_mfma_f32_32x32x16_bf16 v[144:159], v[48:51], a[148:151], v[144:159]
    ds_read_b64_tr_b16 v[44:45], v15 offset:49152
    ds_read_b64_tr_b16 v[46:47], v15 offset:50176
    v_mfma_f32_32x32x16_bf16 v[160:175], v[52:55], a[148:151], v[160:175]
    ds_read_b64_tr_b16 v[48:49], v17 offset:49152
    ds_read_b64_tr_b16 v[50:51], v17 offset:50176
    buffer_load_dwordx4 v2, s[4:7], s45 offen offset:1024 lds
    v_mfma_f32_32x32x16_bf16 v[112:127], v[56:59], a[152:155], v[112:127]
    ds_read_b64_tr_b16 v[52:53], v19 offset:49152
    ds_read_b64_tr_b16 v[54:55], v19 offset:50176
    s_waitcnt lgkmcnt(8)
    v_mfma_f32_32x32x16_bf16 v[128:143], v[60:63], a[152:155], v[128:143]
    ds_read_b64_tr_b16 v[56:57], v13 offset:53248
    ds_read_b64_tr_b16 v[58:59], v13 offset:54272
    ds_read_b128 a[176:179], v10 offset:49152
    buffer_load_dwordx4 v3, s[4:7], s45 offen offset:2048 lds
    v_mfma_f32_32x32x16_bf16 v[144:159], v[64:67], a[152:155], v[144:159]
    ds_read_b64_tr_b16 v[60:61], v15 offset:53248
    ds_read_b64_tr_b16 v[62:63], v15 offset:54272
    buffer_load_dwordx4 v4, s[4:7], s45 offen offset:3072 lds
    v_mfma_f32_32x32x16_bf16 v[160:175], v[68:71], a[152:155], v[160:175]
    ds_read_b64_tr_b16 v[64:65], v17 offset:53248
    ds_read_b64_tr_b16 v[66:67], v17 offset:54272
    s_waitcnt lgkmcnt(9)
    v_mfma_f32_32x32x16_bf16 v[112:127], v[40:43], a[172:175], v[112:127]
    ds_read_b64_tr_b16 v[68:69], v19 offset:53248
    ds_read_b64_tr_b16 v[70:71], v19 offset:54272
    s_mul_i32 s46, s97, 245760
    s_add_u32 m0, s51, 16384
    s_add_u32 s46, s46, s99
    buffer_load_dwordx4 v5, s[8:11], s46 offen offset:0 lds
    buffer_load_dwordx2 v[72:73], v30, s[16:19], 0 offen sc1
    v_mfma_f32_16x16x32_bf16 v[26:29], v[40:43], a[252:255], v[26:29]
    v_mfma_f32_32x32x16_bf16 v[128:143], v[44:47], a[172:175], v[128:143]
    ds_read_b64_tr_b16 v[40:41], v14 offset:49152
    ds_read_b64_tr_b16 v[42:43], v14 offset:50176
    ds_read_b128 a[180:183], v11 offset:49152
    v_mfma_f32_32x32x16_bf16 v[144:159], v[48:51], a[172:175], v[144:159]
    ds_read_b64_tr_b16 v[44:45], v16 offset:49152
    s_waitcnt lgkmcnt(6)
    ds_read_b64_tr_b16 v[46:47], v16 offset:50176
    v_mfma_f32_16x16x32_bf16 v[80:83], v[48:51], a[252:255], v[80:83]
    v_mfma_f32_32x32x16_bf16 v[160:175], v[52:55], a[172:175], v[160:175]
    ds_read_b64_tr_b16 v[48:49], v18 offset:49152
    ds_read_b64_tr_b16 v[50:51], v18 offset:50176
    buffer_load_dwordx4 v6, s[8:11], s46 offen offset:1024 lds
    v_mfma_f32_32x32x16_bf16 v[112:127], v[56:59], a[176:179], v[112:127]
    ds_read_b64_tr_b16 v[52:53], v20 offset:49152
    ds_read_b64_tr_b16 v[54:55], v20 offset:50176
    buffer_load_dwordx4 v7, s[8:11], s46 offen offset:2048 lds
    v_mfma_f32_16x16x32_bf16 v[26:29], v[56:59], a[252:255], v[26:29]
    v_mfma_f32_32x32x16_bf16 v[128:143], v[60:63], a[176:179], v[128:143]
    ds_read_b64_tr_b16 v[56:57], v14 offset:53248
    ds_read_b64_tr_b16 v[58:59], v14 offset:54272
    ds_read_b128 a[184:187], v12 offset:49152
    v_mfma_f32_32x32x16_bf16 v[144:159], v[64:67], a[176:179], v[144:159]
    ds_read_b64_tr_b16 v[60:61], v16 offset:53248
    s_waitcnt lgkmcnt(8)
    ds_read_b64_tr_b16 v[62:63], v16 offset:54272
    buffer_load_dwordx4 v8, s[8:11], s46 offen offset:3072 lds
    v_mfma_f32_16x16x32_bf16 v[80:83], v[64:67], a[252:255], v[80:83]
    v_mfma_f32_32x32x16_bf16 v[160:175], v[68:71], a[176:179], v[160:175]
    ds_read_b64_tr_b16 v[64:65], v18 offset:53248
    ds_read_b64_tr_b16 v[66:67], v18 offset:54272
    v_mfma_f32_32x32x16_bf16 v[112:127], v[40:43], a[180:183], v[112:127]
    ds_read_b64_tr_b16 v[68:69], v20 offset:53248
    ds_read_b64_tr_b16 v[70:71], v20 offset:54272
    s_waitcnt vmcnt(9)
    s_barrier
    v_add_u32 v105, 0, v0
    v_mfma_f32_32x32x16_bf16 v[128:143], v[44:47], a[180:183], v[128:143]
    ds_read_b64_tr_b16 v[40:41], v13 offset:0
    ds_read_b64_tr_b16 v[42:43], v13 offset:1024
    s_waitcnt lgkmcnt(7)
    ds_read_b128 a[204:207], v9 offset:0
    v_mul_u32_u24 v106, s76, v105
    v_lshrrev_b32 v106, 16, v106
    v_mfma_f32_32x32x16_bf16 v[144:159], v[48:51], a[180:183], v[144:159]
    ds_read_b64_tr_b16 v[44:45], v15 offset:0
    ds_read_b64_tr_b16 v[46:47], v15 offset:1024
    s_mul_i32 s46, s94, 221184
    s_add_u32 m0, s51, 32768
    s_add_u32 s46, s46, s59
    buffer_load_dwordx4 v236, s[12:15], s46 offen offset:0 lds
    v_mul_u32_u24 v107, s77, v106
    v_mfma_f32_32x32x16_bf16 v[160:175], v[52:55], a[180:183], v[160:175]
    ds_read_b64_tr_b16 v[48:49], v17 offset:0
    ds_read_b64_tr_b16 v[50:51], v17 offset:1024
    v_sub_u32 v105, v105, v107
    v_mul_u32_u24 v106, s78, v106
    v_lshl_add_u32 v1, v105, 4, v106
    v_add_u32 v105, 64, v0
    v_mfma_f32_32x32x16_bf16 v[112:127], v[56:59], a[184:187], v[112:127]
    ds_read_b64_tr_b16 v[52:53], v19 offset:0
    ds_read_b64_tr_b16 v[54:55], v19 offset:1024
    v_mul_u32_u24 v106, s76, v105
    v_lshrrev_b32 v106, 16, v106
    v_mul_u32_u24 v107, s77, v106
    v_sub_u32 v105, v105, v107
    s_waitcnt lgkmcnt(4)
    v_mfma_f32_32x32x16_bf16 v[128:143], v[60:63], a[184:187], v[128:143]
    ds_read_b64_tr_b16 v[56:57], v13 offset:4096
    ds_read_b64_tr_b16 v[58:59], v13 offset:5120
    ds_read_b128 a[208:211], v10 offset:0
    v_mul_u32_u24 v106, s78, v106
    v_lshl_add_u32 v2, v105, 4, v106
    v_mfma_f32_32x32x16_bf16 v[144:159], v[64:67], a[184:187], v[144:159]
    ds_read_b64_tr_b16 v[60:61], v15 offset:4096
    ds_read_b64_tr_b16 v[62:63], v15 offset:5120
    v_subrev_u32 v2, 1024, v2
    v_add_u32 v105, 128, v0
    v_mul_u32_u24 v106, s76, v105
    v_lshrrev_b32 v106, 16, v106
    v_mfma_f32_32x32x16_bf16 v[160:175], v[68:71], a[184:187], v[160:175]
    ds_read_b64_tr_b16 v[64:65], v17 offset:4096
    ds_read_b64_tr_b16 v[66:67], v17 offset:5120
    buffer_load_dwordx4 v237, s[12:15], s46 offen offset:1024 lds
    v_mul_u32_u24 v107, s77, v106
    v_mfma_f32_32x32x16_bf16 v[112:127], v[40:43], a[204:207], v[112:127]
    ds_read_b64_tr_b16 v[68:69], v19 offset:4096
    ds_read_b64_tr_b16 v[70:71], v19 offset:5120
    v_sub_u32 v105, v105, v107
    v_mul_u32_u24 v106, s78, v106
    v_lshl_add_u32 v3, v105, 4, v106
    v_subrev_u32 v3, 2048, v3
    v_mfma_f32_16x16x32_bf16 v[26:29], v[40:43], a[252:255], v[26:29]
    v_add_u32 v105, 192, v0
    v_mul_u32_u24 v106, s76, v105
    v_mfma_f32_32x32x16_bf16 v[128:143], v[44:47], a[204:207], v[128:143]
    ds_read_b64_tr_b16 v[40:41], v14 offset:0
    ds_read_b64_tr_b16 v[42:43], v14 offset:1024
    s_waitcnt lgkmcnt(6)
    ds_read_b128 a[212:215], v11 offset:0
    v_lshrrev_b32 v106, 16, v106
    v_mul_u32_u24 v107, s77, v106
    v_mfma_f32_32x32x16_bf16 v[144:159], v[48:51], a[204:207], v[144:159]
    ds_read_b64_tr_b16 v[44:45], v16 offset:0
    ds_read_b64_tr_b16 v[46:47], v16 offset:1024
    buffer_load_dwordx4 v238, s[12:15], s46 offen offset:2048 lds
    v_mfma_f32_16x16x32_bf16 v[80:83], v[48:51], a[252:255], v[80:83]
    v_sub_u32 v105, v105, v107
    v_mul_u32_u24 v106, s78, v106
    v_mfma_f32_32x32x16_bf16 v[160:175], v[52:55], a[204:207], v[160:175]
    ds_read_b64_tr_b16 v[48:49], v18 offset:0
    ds_read_b64_tr_b16 v[50:51], v18 offset:1024
    v_lshl_add_u32 v4, v105, 4, v106
    v_subrev_u32 v4, 3072, v4
    v_add_u32 v105, 256, v0
    v_mul_u32_u24 v106, s76, v105
    v_mfma_f32_32x32x16_bf16 v[112:127], v[56:59], a[208:211], v[112:127]
    ds_read_b64_tr_b16 v[52:53], v20 offset:0
    ds_read_b64_tr_b16 v[54:55], v20 offset:1024
    v_lshrrev_b32 v106, 16, v106
    v_mul_u32_u24 v107, s77, v106
    v_sub_u32 v105, v105, v107
    v_mul_u32_u24 v106, s78, v106
    v_mfma_f32_16x16x32_bf16 v[26:29], v[56:59], a[252:255], v[26:29]
    v_lshl_add_u32 v87, v105, 4, v106
    v_mfma_f32_32x32x16_bf16 v[128:143], v[60:63], a[208:211], v[128:143]
    ds_read_b64_tr_b16 v[56:57], v14 offset:4096
    ds_read_b64_tr_b16 v[58:59], v14 offset:5120
    s_waitcnt lgkmcnt(5)
    ds_read_b128 a[216:219], v12 offset:0
    buffer_load_dwordx4 v239, s[12:15], s46 offen offset:3072 lds
    v_mfma_f32_32x32x16_bf16 v[144:159], v[64:67], a[208:211], v[144:159]
    ds_read_b64_tr_b16 v[60:61], v16 offset:4096
    ds_read_b64_tr_b16 v[62:63], v16 offset:5120
    s_mul_i32 s65, s42, 74
    s_add_u32 s65, s65, s36
    s_mul_i32 s65, s65, 5120
    s_add_u32 s65, s65, 17563648
    v_mfma_f32_16x16x32_bf16 v[80:83], v[64:67], a[252:255], v[80:83]
    v_mfma_f32_32x32x16_bf16 v[160:175], v[68:71], a[208:211], v[160:175]
    ds_read_b64_tr_b16 v[64:65], v18 offset:4096
    ds_read_b64_tr_b16 v[66:67], v18 offset:5120
    v_mfma_f32_32x32x16_bf16 v[112:127], v[40:43], a[212:215], v[112:127]
    ds_read_b64_tr_b16 v[68:69], v20 offset:4096
    ds_read_b64_tr_b16 v[70:71], v20 offset:5120
    s_waitcnt vmcnt(4)
    s_barrier
    v_mfma_f32_32x32x16_bf16 v[128:143], v[44:47], a[212:215], v[128:143]
    ds_read_b64_tr_b16 v[40:41], v13 offset:16384
    ds_read_b64_tr_b16 v[42:43], v13 offset:17408
    ds_read_b128 a[236:239], v9 offset:16384
    s_waitcnt lgkmcnt(7)
    v_mfma_f32_32x32x16_bf16 v[144:159], v[48:51], a[212:215], v[144:159]
    ds_read_b64_tr_b16 v[44:45], v15 offset:16384
    ds_read_b64_tr_b16 v[46:47], v15 offset:17408
    s_mul_i32 s46, s95, 221184
    s_add_u32 m0, s51, 49152
    s_add_u32 s46, s46, s59
    buffer_load_dwordx4 v236, s[12:15], s46 offen offset:0 lds
    v_mfma_f32_32x32x16_bf16 v[160:175], v[52:55], a[212:215], v[160:175]
    ds_read_b64_tr_b16 v[48:49], v17 offset:16384
    ds_read_b64_tr_b16 v[50:51], v17 offset:17408
    v_mfma_f32_32x32x16_bf16 v[112:127], v[56:59], a[216:219], v[112:127]
    ds_read_b64_tr_b16 v[52:53], v19 offset:16384
    ds_read_b64_tr_b16 v[54:55], v19 offset:17408
    v_cmp_ne_u32 vcc, 0, v73
    s_nop 0
    s_cmp_eq_u64 vcc, -1
    s_cbranch_scc0 L_spin3
L_back3:
    v_mfma_f32_32x32x16_bf16 v[128:143], v[60:63], a[216:219], v[128:143]
    ds_read_b64_tr_b16 v[56:57], v13 offset:20480
    ds_read_b64_tr_b16 v[58:59], v13 offset:21504
    s_waitcnt lgkmcnt(6)
    ds_read_b128 a[240:243], v10 offset:16384
    v_rcp_f32 v39, v73
    v_mfma_f32_32x32x16_bf16 v[144:159], v[64:67], a[216:219], v[144:159]
    ds_read_b64_tr_b16 v[60:61], v15 offset:20480
    ds_read_b64_tr_b16 v[62:63], v15 offset:21504
    v_cmp_gt_u32 vcc, 32, v0
    v_mov_b32 v32, v73
    v_mul_f32 v31, s57, v39
    v_cndmask_b32_e64 v233, 0, v72, vcc
    v_mfma_f32_32x32x16_bf16 v[160:175], v[68:71], a[216:219], v[160:175]
    ds_read_b64_tr_b16 v[64:65], v17 offset:20480
    ds_read_b64_tr_b16 v[66:67], v17 offset:21504
    buffer_load_dwordx4 v237, s[12:15], s46 offen offset:1024 lds
    v_mfma_f32_32x32x16_bf16 v[112:127], v[40:43], a[236:239], v[112:127]
    ds_read_b64_tr_b16 v[68:69], v19 offset:20480
    ds_read_b64_tr_b16 v[70:71], v19 offset:21504
    v_mul_f32 v33, 0xbfb8aa3b, v39
    v_lshl_or_b32 v232, v233, 16, v233
    v_mfma_f32_16x16x32_bf16 v[26:29], v[40:43], a[252:255], v[26:29]
    v_mfma_f32_32x32x16_bf16 v[128:143], v[44:47], a[236:239], v[128:143]
    ds_read_b64_tr_b16 v[40:41], v14 offset:16384
    ds_read_b64_tr_b16 v[42:43], v14 offset:17408
    s_waitcnt lgkmcnt(6)
    ds_read_b128 a[244:247], v11 offset:16384
    v_mfma_f32_32x32x16_bf16 v[144:159], v[48:51], a[236:239], v[144:159]
    ds_read_b64_tr_b16 v[44:45], v16 offset:16384
    ds_read_b64_tr_b16 v[46:47], v16 offset:17408
    buffer_load_dwordx4 v238, s[12:15], s46 offen offset:2048 lds
    v_mfma_f32_16x16x32_bf16 v[80:83], v[48:51], a[252:255], v[80:83]
    v_mfma_f32_32x32x16_bf16 v[160:175], v[52:55], a[236:239], v[160:175]
    ds_read_b64_tr_b16 v[48:49], v18 offset:16384
    ds_read_b64_tr_b16 v[50:51], v18 offset:17408
    v_mfma_f32_32x32x16_bf16 v[112:127], v[56:59], a[240:243], v[112:127]
    ds_read_b64_tr_b16 v[52:53], v20 offset:16384
    ds_read_b64_tr_b16 v[54:55], v20 offset:17408
    v_mfma_f32_16x16x32_bf16 v[26:29], v[56:59], a[252:255], v[26:29]
    v_mfma_f32_32x32x16_bf16 v[128:143], v[60:63], a[240:243], v[128:143]
    ds_read_b64_tr_b16 v[56:57], v14 offset:20480
    ds_read_b64_tr_b16 v[58:59], v14 offset:21504
    s_waitcnt lgkmcnt(8)
    ds_read_b128 a[248:251], v12 offset:16384
    buffer_load_dwordx4 v239, s[12:15], s46 offen offset:3072 lds
    v_mfma_f32_32x32x16_bf16 v[144:159], v[64:67], a[240:243], v[144:159]
    ds_read_b64_tr_b16 v[60:61], v16 offset:20480
    ds_read_b64_tr_b16 v[62:63], v16 offset:21504
    v_add_u32 v72, 0x20000, v13
    v_add_u32 v73, 0x20000, v14
    v_add_u32 v74, 0x20000, v15
    v_add_u32 v75, 0x20000, v16
    v_mfma_f32_16x16x32_bf16 v[80:83], v[64:67], a[252:255], v[80:83]
    v_add_u32 v76, 0x20000, v17
    v_add_u32 v77, 0x20000, v18
    v_mfma_f32_32x32x16_bf16 v[160:175], v[68:71], a[240:243], v[160:175]
    ds_read_b64_tr_b16 v[64:65], v18 offset:20480
    ds_read_b64_tr_b16 v[66:67], v18 offset:21504
    v_add_u32 v78, 0x20000, v19
    v_add_u32 v79, 0x20000, v20
    v_mfma_f32_32x32x16_bf16 v[112:127], v[40:43], a[244:247], v[112:127]
    ds_read_b64_tr_b16 v[68:69], v20 offset:20480
    ds_read_b64_tr_b16 v[70:71], v20 offset:21504
    s_barrier
    s_mul_i32 s46, s96, 221184
    s_add_u32 m0, s51, 0
    s_add_u32 s46, s46, s59
    buffer_load_dwordx4 v236, s[12:15], s46 offen offset:0 lds
    s_waitcnt lgkmcnt(4)
    v_mfma_f32_32x32x16_bf16 v[128:143], v[44:47], a[244:247], v[128:143]
    ds_read_b64_tr_b16 v[40:41], v72 offset:0
    ds_read_b64_tr_b16 v[42:43], v72 offset:1024
    buffer_load_dwordx4 v237, s[12:15], s46 offen offset:1024 lds
    ds_write_b128 v25, v[26:29] offset:0
    v_mfma_f32_32x32x16_bf16 v[144:159], v[48:51], a[244:247], v[144:159]
    ds_read_b64_tr_b16 v[44:45], v74 offset:0
    ds_read_b64_tr_b16 v[46:47], v74 offset:1024
    buffer_load_dwordx4 v238, s[12:15], s46 offen offset:2048 lds
    ds_write_b128 v25, v[80:83] offset:256
    v_mfma_f32_32x32x16_bf16 v[160:175], v[52:55], a[244:247], v[160:175]
    ds_read_b64_tr_b16 v[48:49], v76 offset:0
    ds_read_b64_tr_b16 v[50:51], v76 offset:1024
    buffer_load_dwordx4 v239, s[12:15], s46 offen offset:3072 lds
    v_mfma_f32_32x32x16_bf16 v[112:127], v[56:59], a[248:251], v[112:127]
    ds_read_b64_tr_b16 v[52:53], v78 offset:0
    ds_read_b64_tr_b16 v[54:55], v78 offset:1024
    s_waitcnt lgkmcnt(4)
    s_barrier
    ds_read_b32 v224, v23 offset:0
    ds_read_b32 v225, v23 offset:1024
    ds_read_b32 v228, v24 offset:128
    ds_read_b32 v229, v24 offset:1152
    v_mfma_f32_32x32x16_bf16 v[128:143], v[60:63], a[248:251], v[128:143]
    ds_read_b64_tr_b16 v[56:57], v72 offset:4096
    ds_read_b64_tr_b16 v[58:59], v72 offset:5120
    v_mfma_f32_32x32x16_bf16 v[144:159], v[64:67], a[248:251], v[144:159]
    ds_read_b64_tr_b16 v[60:61], v74 offset:4096
    ds_read_b64_tr_b16 v[62:63], v74 offset:5120
    v_mfma_f32_32x32x16_bf16 v[160:175], v[68:71], a[248:251], v[160:175]
    ds_read_b64_tr_b16 v[64:65], v76 offset:4096
    ds_read_b64_tr_b16 v[66:67], v76 offset:5120
    s_mul_i32 s46, s93, 221184
    s_add_u32 m0, s51, 65536
    s_add_u32 s46, s46, s60
    buffer_load_dwordx4 v236, s[12:15], s46 offen offset:0 lds
    s_waitcnt lgkmcnt(8)
    v_add_f32 v224, v224, v225
    v_and_b32 v35, 0xffff0000, v224
    v_mfma_f32_32x32x16_bf16 v[176:191], v[40:43], a[92:95], 0
    ds_read_b64_tr_b16 v[68:69], v78 offset:4096
    ds_read_b64_tr_b16 v[70:71], v78 offset:5120
    v_sub_f32 v225, v224, v35
    v_and_b32 v35, 0xffff0000, v225
    v_alignbit_b32 v224, v35, v224, 16
    v_sub_f32 v225, v225, v35
    v_mfma_f32_16x16x32_bf16 v[26:29], v[40:43], a[252:255], 0
    v_or_b32 v224, v224, v35
    v_lshrrev_b32 v225, 16, v225
    v_mfma_f32_32x32x16_bf16 v[192:207], v[44:47], a[92:95], 0
    ds_read_b64_tr_b16 v[40:41], v73 offset:0
    ds_read_b64_tr_b16 v[42:43], v73 offset:1024
    s_waitcnt lgkmcnt(4)
    v_add_f32 v228, v228, v229
    v_and_b32 v36, 0xffff0000, v228
    v_sub_f32 v229, v228, v36
    v_and_b32 v36, 0xffff0000, v229
    v_mfma_f32_32x32x16_bf16 v[176:191], v[48:51], a[108:111], v[176:191]
    ds_read_b64_tr_b16 v[44:45], v75 offset:0
    ds_read_b64_tr_b16 v[46:47], v75 offset:1024
    buffer_load_dwordx4 v237, s[12:15], s46 offen offset:1024 lds
    v_alignbit_b32 v228, v36, v228, 16
    v_sub_f32 v229, v229, v36
    v_mfma_f32_16x16x32_bf16 v[26:29], v[48:51], a[252:255], v[26:29]
    v_or_b32 v228, v228, v36
    v_lshrrev_b32 v229, 16, v229
    v_mfma_f32_32x32x16_bf16 v[192:207], v[52:55], a[108:111], v[192:207]
    ds_read_b64_tr_b16 v[48:49], v77 offset:0
    ds_read_b64_tr_b16 v[50:51], v77 offset:1024
    v_mfma_f32_32x32x16_bf16 v[176:191], v[56:59], a[96:99], v[176:191]
    ds_read_b64_tr_b16 v[52:53], v79 offset:0
    ds_read_b64_tr_b16 v[54:55], v79 offset:1024
    buffer_load_dwordx4 v238, s[12:15], s46 offen offset:2048 lds
    v_add_u32 v248, 20660224, v21
    buffer_load_dword v249, v248, s[16:19], 0 offen sc1
    v_mfma_f32_32x32x16_bf16 v[112:127], v[224:227], v[232:235], v[112:127]
    ds_read_b32 v224, v23 offset:256
    ds_read_b32 v225, v23 offset:1280
    v_mfma_f32_16x16x32_bf16 v[26:29], v[56:59], a[252:255], v[26:29]
    v_mfma_f32_32x32x16_bf16 v[192:207], v[60:63], a[96:99], v[192:207]
    ds_read_b64_tr_b16 v[56:57], v73 offset:4096
    ds_read_b64_tr_b16 v[58:59], v73 offset:5120
    v_mfma_f32_32x32x16_bf16 v[128:143], v[228:231], v[232:235], v[128:143]
    ds_read_b32 v228, v24 offset:384
    s_waitcnt lgkmcnt(7)
    ds_read_b32 v229, v24 offset:1408
    v_mfma_f32_32x32x16_bf16 v[176:191], v[64:67], a[112:115], v[176:191]
    ds_read_b64_tr_b16 v[60:61], v75 offset:4096
    ds_read_b64_tr_b16 v[62:63], v75 offset:5120
    buffer_load_dwordx4 v239, s[12:15], s46 offen offset:3072 lds
    v_mul_f32 v112, v31, v112
    v_mul_f32 v113, v31, v113
    v_mul_f32 v114, v31, v114
    v_mul_f32 v115, v31, v115
    v_mfma_f32_16x16x32_bf16 v[26:29], v[64:67], a[252:255], v[26:29]
    v_mul_f32 v116, v31, v116
    v_mul_f32 v117, v31, v117
    v_mfma_f32_32x32x16_bf16 v[192:207], v[68:71], a[112:115], v[192:207]
    ds_read_b64_tr_b16 v[64:65], v77 offset:4096
    ds_read_b64_tr_b16 v[66:67], v77 offset:5120
    v_mul_f32 v118, v31, v118
    v_mul_f32 v119, v31, v119
    v_mul_f32 v120, v31, v120
    v_mul_f32 v121, v31, v121
    v_mfma_f32_32x32x16_bf16 v[176:191], v[40:43], a[100:103], v[176:191]
    ds_read_b64_tr_b16 v[68:69], v79 offset:4096
    ds_read_b64_tr_b16 v[70:71], v79 offset:5120
    s_waitcnt vmcnt(13)
    s_barrier
    s_mul_i32 s46, s97, 221184
    s_add_u32 m0, s51, 16384
    s_add_u32 s46, s46, s59
    buffer_load_dwordx4 v236, s[12:15], s46 offen offset:0 lds
    v_mul_f32 v122, v31, v122
    v_mul_f32 v123, v31, v123
    v_mul_f32 v124, v31, v124
    v_mul_f32 v125, v31, v125
    v_mfma_f32_32x32x16_bf16 v[192:207], v[44:47], a[100:103], v[192:207]
    ds_read_b64_tr_b16 v[40:41], v13 offset:32768
    s_waitcnt lgkmcnt(3)
    ds_read_b64_tr_b16 v[42:43], v13 offset:33792
    buffer_load_dwordx4 v237, s[12:15], s46 offen offset:1024 lds
    v_mul_f32 v126, v31, v126
    v_mul_f32 v127, v31, v127
    v_add_f32 v224, v224, v225
    v_and_b32 v35, 0xffff0000, v224
    v_mfma_f32_32x32x16_bf16 v[176:191], v[48:51], a[116:119], v[176:191]
    ds_read_b64_tr_b16 v[44:45], v15 offset:32768
    ds_read_b64_tr_b16 v[46:47], v15 offset:33792
    buffer_load_dwordx4 v238, s[12:15], s46 offen offset:2048 lds
    v_sub_f32 v225, v224, v35
    v_and_b32 v35, 0xffff0000, v225
    v_alignbit_b32 v224, v35, v224, 16
    v_sub_f32 v225, v225, v35
    v_mfma_f32_32x32x16_bf16 v[192:207], v[52:55], a[116:119], v[192:207]
    ds_read_b64_tr_b16 v[48:49], v17 offset:32768
    ds_read_b64_tr_b16 v[50:51], v17 offset:33792
    buffer_load_dwordx4 v239, s[12:15], s46 offen offset:3072 lds
    v_or_b32 v224, v224, v35
    v_lshrrev_b32 v225, 16, v225
    v_add_f32 v228, v228, v229
    v_and_b32 v36, 0xffff0000, v228
    v_mfma_f32_32x32x16_bf16 v[176:191], v[56:59], a[104:107], v[176:191]
    ds_read_b64_tr_b16 v[52:53], v19 offset:32768
    ds_read_b64_tr_b16 v[54:55], v19 offset:33792
    v_sub_f32 v229, v228, v36
    v_and_b32 v36, 0xffff0000, v229
    v_alignbit_b32 v228, v36, v228, 16
    v_sub_f32 v229, v229, v36
    v_mfma_f32_32x32x16_bf16 v[192:207], v[60:63], a[104:107], v[192:207]
    ds_read_b64_tr_b16 v[56:57], v13 offset:36864
    ds_read_b64_tr_b16 v[58:59], v13 offset:37888
    v_or_b32 v228, v228, v36
    v_lshrrev_b32 v229, 16, v229
    v_mfma_f32_32x32x16_bf16 v[176:191], v[64:67], a[120:123], v[176:191]
    ds_read_b64_tr_b16 v[60:61], v15 offset:36864
    ds_read_b64_tr_b16 v[62:63], v15 offset:37888
    s_waitcnt lgkmcnt(6)
    v_mfma_f32_32x32x16_bf16 v[192:207], v[68:71], a[120:123], v[192:207]
    ds_read_b64_tr_b16 v[64:65], v17 offset:36864
    ds_read_b64_tr_b16 v[66:67], v17 offset:37888
    v_mfma_f32_32x32x16_bf16 v[176:191], v[40:43], a[124:127], v[176:191]
    ds_read_b64_tr_b16 v[68:69], v19 offset:36864
    ds_read_b64_tr_b16 v[70:71], v19 offset:37888
    v_add_u32 v72, 0x10000, v13
    v_add_u32 v73, 0x10000, v14
    v_add_u32 v74, 0x10000, v15
    v_mfma_f32_32x32x16_bf16 v[144:159], v[224:227], v[232:235], v[144:159]
    v_cvt_pk_bf16_f32 v104, v112, v113
    v_cvt_pk_bf16_f32 v105, v114, v115
    v_cvt_pk_bf16_f32 v106, v116, v117
    v_cvt_pk_bf16_f32 v107, v118, v119
    v_add_u32 v75, 0x10000, v16
    v_add_u32 v76, 0x10000, v17
    v_mfma_f32_16x16x32_bf16 v[26:29], v[40:43], a[252:255], v[26:29]
    v_add_u32 v77, 0x10000, v18
    v_add_u32 v78, 0x10000, v19
    v_mfma_f32_32x32x16_bf16 v[192:207], v[44:47], a[124:127], v[192:207]
    ds_read_b64_tr_b16 v[40:41], v14 offset:32768
    ds_read_b64_tr_b16 v[42:43], v14 offset:33792
    buffer_store_dwordx4 v[104:107], v21, s[16:19], s53 offen offset:0 sc1
    v_mfma_f32_32x32x16_bf16 v[160:175], v[228:231], v[232:235], v[160:175]
    v_cvt_pk_bf16_f32 v108, v120, v121
    v_cvt_pk_bf16_f32 v109, v122, v123
    v_cvt_pk_bf16_f32 v110, v124, v125
    v_cvt_pk_bf16_f32 v111, v126, v127
    v_add_u32 v79, 0x10000, v20
    v_mfma_f32_32x32x16_bf16 v[176:191], v[48:51], a[140:143], v[176:191]
    ds_read_b64_tr_b16 v[44:45], v16 offset:32768
    ds_read_b64_tr_b16 v[46:47], v16 offset:33792
    buffer_store_dwordx4 v[108:111], v21, s[16:19], s53 offen offset:1024 sc1
    v_mul_f32 v128, v31, v128
    v_mfma_f32_16x16x32_bf16 v[26:29], v[48:51], a[252:255], v[26:29]
    v_mul_f32 v129, v31, v129
    v_mul_f32 v130, v31, v130
    s_waitcnt lgkmcnt(4)
    v_mfma_f32_32x32x16_bf16 v[192:207], v[52:55], a[140:143], v[192:207]
    ds_read_b64_tr_b16 v[48:49], v18 offset:32768
    ds_read_b64_tr_b16 v[50:51], v18 offset:33792
    v_mul_f32 v131, v31, v131
    v_mul_f32 v132, v31, v132
    v_mul_f32 v133, v31, v133
    v_mul_f32 v134, v31, v134
    v_mul_f32 v135, v31, v135
    v_mfma_f32_32x32x16_bf16 v[176:191], v[56:59], a[128:131], v[176:191]
    ds_read_b64_tr_b16 v[52:53], v20 offset:32768
    ds_read_b64_tr_b16 v[54:55], v20 offset:33792
    v_mul_f32 v136, v31, v136
    v_mul_f32 v137, v31, v137
    v_mul_f32 v138, v31, v138
    v_mul_f32 v139, v31, v139
    v_mul_f32 v140, v31, v140
    v_mfma_f32_16x16x32_bf16 v[26:29], v[56:59], a[252:255], v[26:29]
    v_mul_f32 v141, v31, v141
    v_mul_f32 v142, v31, v142
    v_mfma_f32_32x32x16_bf16 v[192:207], v[60:63], a[128:131], v[192:207]
    ds_read_b64_tr_b16 v[56:57], v14 offset:36864
    ds_read_b64_tr_b16 v[58:59], v14 offset:37888
    v_mul_f32 v143, v31, v143
    v_cvt_pk_bf16_f32 v104, v128, v129
    v_cvt_pk_bf16_f32 v105, v130, v131
    v_cvt_pk_bf16_f32 v106, v132, v133
    v_cvt_pk_bf16_f32 v107, v134, v135
    buffer_store_dwordx4 v[104:107], v21, s[16:19], s54 offen offset:0 sc1
    v_mfma_f32_32x32x16_bf16 v[176:191], v[64:67], a[144:147], v[176:191]
    ds_read_b64_tr_b16 v[60:61], v16 offset:36864
    ds_read_b64_tr_b16 v[62:63], v16 offset:37888
    v_cvt_pk_bf16_f32 v108, v136, v137
    v_cvt_pk_bf16_f32 v109, v138, v139
    v_cvt_pk_bf16_f32 v110, v140, v141
    v_cvt_pk_bf16_f32 v111, v142, v143
    buffer_store_dwordx4 v[108:111], v21, s[16:19], s54 offen offset:1024 sc1
    v_mfma_f32_16x16x32_bf16 v[26:29], v[64:67], a[252:255], v[26:29]
    v_mul_f32 v144, v31, v144
    v_mul_f32 v145, v31, v145
    v_mfma_f32_32x32x16_bf16 v[192:207], v[68:71], a[144:147], v[192:207]
    ds_read_b64_tr_b16 v[64:65], v18 offset:36864
    ds_read_b64_tr_b16 v[66:67], v18 offset:37888
    v_mul_f32 v146, v31, v146
    v_mul_f32 v147, v31, v147
    v_mul_f32 v148, v31, v148
    v_mul_f32 v149, v31, v149
    v_mul_f32 v150, v31, v150
    s_waitcnt lgkmcnt(4)
    v_mfma_f32_32x32x16_bf16 v[176:191], v[40:43], a[132:135], v[176:191]
    ds_read_b64_tr_b16 v[68:69], v20 offset:36864
    ds_read_b64_tr_b16 v[70:71], v20 offset:37888
    s_waitcnt vmcnt(17)
    s_barrier
    v_mul_f32 v151, v31, v151
    v_mul_f32 v152, v31, v152
    v_mul_f32 v153, v31, v153
    v_mul_f32 v154, v31, v154
    v_mul_f32 v155, v31, v155
    v_mul_f32 v156, v31, v156
    v_mfma_f32_32x32x16_bf16 v[192:207], v[44:47], a[132:135], v[192:207]
    ds_read_b64_tr_b16 v[40:41], v13 offset:49152
    ds_read_b64_tr_b16 v[42:43], v13 offset:50176
    v_mul_f32 v157, v31, v157
    v_mul_f32 v158, v31, v158
    v_mul_f32 v159, v31, v159
    v_cvt_pk_bf16_f32 v104, v144, v145
    v_cvt_pk_bf16_f32 v105, v146, v147
    v_cvt_pk_bf16_f32 v106, v148, v149
    v_mfma_f32_32x32x16_bf16 v[176:191], v[48:51], a[148:151], v[176:191]
    ds_read_b64_tr_b16 v[44:45], v15 offset:49152
    ds_read_b64_tr_b16 v[46:47], v15 offset:50176
    v_cvt_pk_bf16_f32 v107, v150, v151
    buffer_store_dwordx4 v[104:107], v21, s[16:19], s55 offen offset:0 sc1
    v_cvt_pk_bf16_f32 v108, v152, v153
    v_mfma_f32_32x32x16_bf16 v[192:207], v[52:55], a[148:151], v[192:207]
    ds_read_b64_tr_b16 v[48:49], v17 offset:49152
    ds_read_b64_tr_b16 v[50:51], v17 offset:50176
    v_cvt_pk_bf16_f32 v109, v154, v155
    v_cvt_pk_bf16_f32 v110, v156, v157
    v_cvt_pk_bf16_f32 v111, v158, v159
    buffer_store_dwordx4 v[108:111], v21, s[16:19], s55 offen offset:1024 sc1
    v_mfma_f32_32x32x16_bf16 v[176:191], v[56:59], a[136:139], v[176:191]
    ds_read_b64_tr_b16 v[52:53], v19 offset:49152
    ds_read_b64_tr_b16 v[54:55], v19 offset:50176
    v_mul_f32 v160, v31, v160
    v_mul_f32 v161, v31, v161
    v_mul_f32 v162, v31, v162
    v_mul_f32 v163, v31, v163
    v_mul_f32 v164, v31, v164
    v_mul_f32 v165, v31, v165
    v_mul_f32 v166, v31, v166
    s_waitcnt lgkmcnt(4)
    v_mfma_f32_32x32x16_bf16 v[192:207], v[60:63], a[136:139], v[192:207]
    ds_read_b64_tr_b16 v[56:57], v13 offset:53248
    ds_read_b64_tr_b16 v[58:59], v13 offset:54272
    v_mul_f32 v167, v31, v167
    v_mul_f32 v168, v31, v168
    v_mul_f32 v169, v31, v169
    v_mul_f32 v170, v31, v170
    v_mul_f32 v171, v31, v171
    v_mul_f32 v172, v31, v172
    v_mul_f32 v173, v31, v173
    v_mfma_f32_32x32x16_bf16 v[176:191], v[64:67], a[152:155], v[176:191]
    ds_read_b64_tr_b16 v[60:61], v15 offset:53248
    ds_read_b64_tr_b16 v[62:63], v15 offset:54272
    v_mul_f32 v174, v31, v174
    v_mul_f32 v175, v31, v175
    v_cvt_pk_bf16_f32 v104, v160, v161
    v_cvt_pk_bf16_f32 v105, v162, v163
    v_cvt_pk_bf16_f32 v106, v164, v165
    v_cvt_pk_bf16_f32 v107, v166, v167
    buffer_store_dwordx4 v[104:107], v21, s[16:19], s56 offen offset:0 sc1
    v_mfma_f32_32x32x16_bf16 v[192:207], v[68:71], a[152:155], v[192:207]
    ds_read_b64_tr_b16 v[64:65], v17 offset:53248
    ds_read_b64_tr_b16 v[66:67], v17 offset:54272
    v_cvt_pk_bf16_f32 v108, v168, v169
    v_cvt_pk_bf16_f32 v109, v170, v171
    v_cvt_pk_bf16_f32 v110, v172, v173
    v_cvt_pk_bf16_f32 v111, v174, v175
    buffer_store_dwordx4 v[108:111], v21, s[16:19], s56 offen offset:1024 sc1
    v_mfma_f32_32x32x16_bf16 v[176:191], v[40:43], a[156:159], v[176:191]
    ds_read_b64_tr_b16 v[68:69], v19 offset:53248
    ds_read_b64_tr_b16 v[70:71], v19 offset:54272
    s_waitcnt vmcnt(13)
    v_cmp_ne_u32 vcc, 0, v249
    s_nop 0
    s_cmp_eq_u64 vcc, -1
    s_cbranch_scc0 L_spin5
L_back5:
    v_mfma_f32_16x16x32_bf16 v[26:29], v[40:43], a[252:255], v[26:29]
    v_mfma_f32_32x32x16_bf16 v[192:207], v[44:47], a[156:159], v[192:207]
    ds_read_b64_tr_b16 v[40:41], v14 offset:49152
    ds_read_b64_tr_b16 v[42:43], v14 offset:50176
    s_waitcnt lgkmcnt(4)
    v_mfma_f32_32x32x16_bf16 v[176:191], v[48:51], a[172:175], v[176:191]
    ds_read_b64_tr_b16 v[44:45], v16 offset:49152
    ds_read_b64_tr_b16 v[46:47], v16 offset:50176
    v_mfma_f32_16x16x32_bf16 v[26:29], v[48:51], a[252:255], v[26:29]
    v_mfma_f32_32x32x16_bf16 v[192:207], v[52:55], a[172:175], v[192:207]
    ds_read_b64_tr_b16 v[48:49], v18 offset:49152
    ds_read_b64_tr_b16 v[50:51], v18 offset:50176
    s_add_u32 s67, s65, 0
    buffer_load_dwordx4 a[0:3], v21, s[16:19], s67 offen offset:0 sc1
    v_mfma_f32_32x32x16_bf16 v[176:191], v[56:59], a[160:163], v[176:191]
    ds_read_b64_tr_b16 v[52:53], v20 offset:49152
    ds_read_b64_tr_b16 v[54:55], v20 offset:50176
    v_mfma_f32_16x16x32_bf16 v[26:29], v[56:59], a[252:255], v[26:29]
    v_mfma_f32_32x32x16_bf16 v[192:207], v[60:63], a[160:163], v[192:207]
    ds_read_b64_tr_b16 v[56:57], v14 offset:53248
    ds_read_b64_tr_b16 v[58:59], v14 offset:54272
    v_mfma_f32_32x32x16_bf16 v[176:191], v[64:67], a[176:179], v[176:191]
    ds_read_b64_tr_b16 v[60:61], v16 offset:53248
    ds_read_b64_tr_b16 v[62:63], v16 offset:54272
    v_mfma_f32_16x16x32_bf16 v[26:29], v[64:67], a[252:255], v[26:29]
    s_waitcnt lgkmcnt(8)
    v_mfma_f32_32x32x16_bf16 v[192:207], v[68:71], a[176:179], v[192:207]
    ds_read_b64_tr_b16 v[64:65], v18 offset:53248
    ds_read_b64_tr_b16 v[66:67], v18 offset:54272
    v_mfma_f32_32x32x16_bf16 v[176:191], v[40:43], a[164:167], v[176:191]
    ds_read_b64_tr_b16 v[68:69], v20 offset:53248
    ds_read_b64_tr_b16 v[70:71], v20 offset:54272
    s_barrier
    v_mfma_f32_32x32x16_bf16 v[192:207], v[44:47], a[164:167], v[192:207]
    ds_read_b64_tr_b16 v[40:41], v13 offset:0
    ds_read_b64_tr_b16 v[42:43], v13 offset:1024
    buffer_load_dwordx4 a[4:7], v21, s[16:19], s67 offen offset:1024 sc1
    s_waitcnt lgkmcnt(8)
    v_mfma_f32_32x32x16_bf16 v[176:191], v[48:51], a[180:183], v[176:191]
    ds_read_b64_tr_b16 v[44:45], v15 offset:0
    ds_read_b64_tr_b16 v[46:47], v15 offset:1024
    s_mul_i32 s46, s94, 221184
    s_add_u32 m0, s51, 32768
    s_add_u32 s46, s46, s60
    buffer_load_dwordx4 v236, s[12:15], s46 offen offset:0 lds
    v_mfma_f32_32x32x16_bf16 v[192:207], v[52:55], a[180:183], v[192:207]
    ds_read_b64_tr_b16 v[48:49], v17 offset:0
    ds_read_b64_tr_b16 v[50:51], v17 offset:1024
    v_mfma_f32_32x32x16_bf16 v[176:191], v[56:59], a[168:171], v[176:191]
    ds_read_b64_tr_b16 v[52:53], v19 offset:0
    ds_read_b64_tr_b16 v[54:55], v19 offset:1024
    s_waitcnt lgkmcnt(8)
    v_mfma_f32_32x32x16_bf16 v[192:207], v[60:63], a[168:171], v[192:207]
    ds_read_b64_tr_b16 v[56:57], v13 offset:4096
    ds_read_b64_tr_b16 v[58:59], v13 offset:5120
    buffer_load_dwordx4 a[8:11], v21, s[16:19], s67 offen offset:2048 sc1
    v_mfma_f32_32x32x16_bf16 v[176:191], v[64:67], a[184:187], v[176:191]
    ds_read_b64_tr_b16 v[60:61], v15 offset:4096
    ds_read_b64_tr_b16 v[62:63], v15 offset:5120
    v_mfma_f32_32x32x16_bf16 v[192:207], v[68:71], a[184:187], v[192:207]
    ds_read_b64_tr_b16 v[64:65], v17 offset:4096
    ds_read_b64_tr_b16 v[66:67], v17 offset:5120
    buffer_load_dwordx4 v237, s[12:15], s46 offen offset:1024 lds
    s_waitcnt lgkmcnt(9)
    v_mfma_f32_32x32x16_bf16 v[176:191], v[40:43], a[188:191], v[176:191]
    ds_read_b64_tr_b16 v[68:69], v19 offset:4096
    ds_read_b64_tr_b16 v[70:71], v19 offset:5120
    v_mfma_f32_16x16x32_bf16 v[26:29], v[40:43], a[252:255], v[26:29]
    v_mfma_f32_32x32x16_bf16 v[192:207], v[44:47], a[188:191], v[192:207]
    ds_read_b64_tr_b16 v[40:41], v14 offset:0
    ds_read_b64_tr_b16 v[42:43], v14 offset:1024
    s_waitcnt lgkmcnt(8)
    v_mfma_f32_32x32x16_bf16 v[176:191], v[48:51], a[204:207], v[176:191]
    ds_read_b64_tr_b16 v[44:45], v16 offset:0
    ds_read_b64_tr_b16 v[46:47], v16 offset:1024
    buffer_load_dwordx4 v238, s[12:15], s46 offen offset:2048 lds
    buffer_load_dwordx4 a[12:15], v21, s[16:19], s67 offen offset:3072 sc1
    s_lshl_b32 s47, s37, 2
    s_add_u32 s47, s47, s36
    s_mul_i32 s47, s47, 151552
    s_add_u32 s47, s47, 7864320
    s_lshl_b32 s48, s43, 11
    s_lshl_b32 s74, s74, 12
    s_lshl_b32 s75, s75, 12
    s_add_u32 s74, s74, s47
    s_add_u32 s75, s75, s47
    s_cmp_lt_u32 s38, 12
    s_cselect_b32 s75, s75, 2146435072
    s_add_u32 s53, s74, s48
    s_add_u32 s55, s75, s48
    s_xor_b32 s48, s48, 0x800
    s_add_u32 s54, s74, s48
    s_add_u32 s56, s75, s48
    v_mfma_f32_16x16x32_bf16 v[26:29], v[48:51], a[252:255], v[26:29]
    v_lshrrev_b32 v37, 1, v0
    v_min_u32 v37, 11, v37
    v_mfma_f32_32x32x16_bf16 v[192:207], v[52:55], a[204:207], v[192:207]
    ds_read_b64_tr_b16 v[48:49], v18 offset:0
    ds_read_b64_tr_b16 v[50:51], v18 offset:1024
    v_mul_u32_u24 v37, 2560, v37
    v_and_b32 v38, 1, v0
    v_mul_u32_u24 v38, 1280, v38
    s_mov_b32 s47, 126992
    v_mfma_f32_32x32x16_bf16 v[176:191], v[56:59], a[192:195], v[176:191]
    ds_read_b64_tr_b16 v[52:53], v20 offset:0
    ds_read_b64_tr_b16 v[54:55], v20 offset:1024
    v_add3_u32 v37, v37, v38, s47
    v_mov_b32 v100, s58
    v_mov_b32 v101, s58
    v_mov_b32 v102, s58
    v_mfma_f32_16x16x32_bf16 v[26:29], v[56:59], a[252:255], v[26:29]
    v_mov_b32 v103, s58
    ds_write_b128 v37, v[100:103]
    s_waitcnt lgkmcnt(5)
    v_mfma_f32_32x32x16_bf16 v[192:207], v[60:63], a[192:195], v[192:207]
    ds_read_b64_tr_b16 v[56:57], v14 offset:4096
    ds_read_b64_tr_b16 v[58:59], v14 offset:5120
    buffer_load_dwordx4 v239, s[12:15], s46 offen offset:3072 lds
    v_mfma_f32_32x32x16_bf16 v[176:191], v[64:67], a[208:211], v[176:191]
    ds_read_b64_tr_b16 v[60:61], v16 offset:4096
    ds_read_b64_tr_b16 v[62:63], v16 offset:5120
    s_getreg_b32 s86, hwreg(HW_REG_IB_STS, 30, 2)
    s_getreg_b32 s87, hwreg(HW_REG_IB_STS, 0, 4)
    s_mov_b32 s3, 0
    s_lshl4_add_u32 s86, s86, s87
    s_cmp_le_u32 s86, 7
    s_cbranch_scc0 L_tf1
    buffer_store_dword v253, v252, s[16:19], s92 offen sc1
    s_mov_b32 s3, 0x100
L_tf1:
    v_mfma_f32_16x16x32_bf16 v[26:29], v[64:67], a[252:255], v[26:29]
    s_lshl_b32 s47, s39, 2
    v_min_u32 v38, 11, v0
    v_mfma_f32_32x32x16_bf16 v[192:207], v[68:71], a[208:211], v[192:207]
    ds_read_b64_tr_b16 v[64:65], v18 offset:4096
    ds_read_b64_tr_b16 v[66:67], v18 offset:5120
    s_add_u32 s67, s67, 4096
    buffer_load_dwordx4 a[16:19], v21, s[16:19], s67 offen offset:0 sc1
    v_mfma_f32_32x32x16_bf16 v[176:191], v[40:43], a[196:199], v[176:191]
    ds_read_b64_tr_b16 v[68:69], v20 offset:4096
    ds_read_b64_tr_b16 v[70:71], v20 offset:5120
    s_waitcnt vmcnt(17)
    s_barrier
    v_add_u32 v39, s47, v38
    v_mfma_f32_32x32x16_bf16 v[192:207], v[44:47], a[196:199], v[192:207]
    ds_read_b64_tr_b16 v[40:41], v13 offset:16384
    ds_read_b64_tr_b16 v[42:43], v13 offset:17408
    v_cmp_gt_u32 s[90:91], 8, v39
    v_mul_u32_u24 v38, 2560, v38
    v_add_u32 v38, 126976, v38
    v_mov_b32 v39, 0xf149
    s_waitcnt lgkmcnt(6)
    v_mfma_f32_32x32x16_bf16 v[176:191], v[48:51], a[212:215], v[176:191]
    ds_read_b64_tr_b16 v[44:45], v15 offset:16384
    ds_read_b64_tr_b16 v[46:47], v15 offset:17408
    s_mul_i32 s46, s95, 221184
    s_add_u32 m0, s51, 49152
    s_add_u32 s46, s46, s60
    buffer_load_dwordx4 v236, s[12:15], s46 offen offset:0 lds
    v_mfma_f32_32x32x16_bf16 v[192:207], v[52:55], a[212:215], v[192:207]
    ds_read_b64_tr_b16 v[48:49], v17 offset:16384
    ds_read_b64_tr_b16 v[50:51], v17 offset:17408
    v_cndmask_b32_e64 v96, 0, v39, s[90:91]
    v_mov_b32 v97, 0
    v_mov_b32 v98, 0
    v_mov_b32 v99, 0
    v_mfma_f32_32x32x16_bf16 v[176:191], v[56:59], a[200:203], v[176:191]
    ds_read_b64_tr_b16 v[52:53], v19 offset:16384
    ds_read_b64_tr_b16 v[54:55], v19 offset:17408
    ds_write_b128 v38, v[96:99]
    v_mfma_f32_32x32x16_bf16 v[192:207], v[60:63], a[200:203], v[192:207]
    ds_read_b64_tr_b16 v[56:57], v13 offset:20480
    ds_read_b64_tr_b16 v[58:59], v13 offset:21504
    s_add_u32 s67, s65, 20480
    buffer_load_dwordx4 a[20:23], v21, s[16:19], s67 offen offset:0 sc1
    s_waitcnt lgkmcnt(7)
    v_mfma_f32_32x32x16_bf16 v[176:191], v[64:67], a[216:219], v[176:191]
    ds_read_b64_tr_b16 v[60:61], v15 offset:20480
    ds_read_b64_tr_b16 v[62:63], v15 offset:21504
    v_mfma_f32_32x32x16_bf16 v[192:207], v[68:71], a[216:219], v[192:207]
    ds_read_b64_tr_b16 v[64:65], v17 offset:20480
    ds_read_b64_tr_b16 v[66:67], v17 offset:21504
    buffer_load_dwordx4 v237, s[12:15], s46 offen offset:1024 lds
    v_mfma_f32_32x32x16_bf16 v[176:191], v[40:43], a[220:223], v[176:191]
    ds_read_b64_tr_b16 v[68:69], v19 offset:20480
    ds_read_b64_tr_b16 v[70:71], v19 offset:21504
    v_mfma_f32_16x16x32_bf16 v[26:29], v[40:43], a[252:255], v[26:29]
    v_mfma_f32_32x32x16_bf16 v[192:207], v[44:47], a[220:223], v[192:207]
    ds_read_b64_tr_b16 v[40:41], v14 offset:16384
    ds_read_b64_tr_b16 v[42:43], v14 offset:17408
    s_waitcnt lgkmcnt(8)
    v_mfma_f32_32x32x16_bf16 v[176:191], v[48:51], a[236:239], v[176:191]
    ds_read_b64_tr_b16 v[44:45], v16 offset:16384
    ds_read_b64_tr_b16 v[46:47], v16 offset:17408
    buffer_load_dwordx4 v238, s[12:15], s46 offen offset:2048 lds
    s_getreg_b32 s86, hwreg(HW_REG_IB_STS, 30, 2)
    s_getreg_b32 s87, hwreg(HW_REG_IB_STS, 0, 4)
    s_lshl4_add_u32 s86, s86, s87
    s_or_b32 s86, s86, s3
    s_cmp_le_u32 s86, 12
    s_cbranch_scc0 L_tf2
    buffer_store_dword v253, v252, s[16:19], s92 offen sc1
    s_mov_b32 s3, 0x100
L_tf2:
    buffer_load_dwordx4 a[24:27], v21, s[16:19], s67 offen offset:1024 sc1
    v_mfma_f32_16x16x32_bf16 v[26:29], v[48:51], a[252:255], v[26:29]
    v_mfma_f32_32x32x16_bf16 v[192:207], v[52:55], a[236:239], v[192:207]
    ds_read_b64_tr_b16 v[48:49], v18 offset:16384
    ds_read_b64_tr_b16 v[50:51], v18 offset:17408
    v_mfma_f32_32x32x16_bf16 v[176:191], v[56:59], a[224:227], v[176:191]
    ds_read_b64_tr_b16 v[52:53], v20 offset:16384
    ds_read_b64_tr_b16 v[54:55], v20 offset:17408
    v_mfma_f32_16x16x32_bf16 v[26:29], v[56:59], a[252:255], v[26:29]
    s_waitcnt lgkmcnt(4)
    v_mfma_f32_32x32x16_bf16 v[192:207], v[60:63], a[224:227], v[192:207]
    ds_read_b64_tr_b16 v[56:57], v14 offset:20480
    ds_read_b64_tr_b16 v[58:59], v14 offset:21504
    buffer_load_dwordx4 v239, s[12:15], s46 offen offset:3072 lds
    v_mfma_f32_32x32x16_bf16 v[176:191], v[64:67], a[240:243], v[176:191]
    ds_read_b64_tr_b16 v[60:61], v16 offset:20480
    ds_read_b64_tr_b16 v[62:63], v16 offset:21504
    v_mfma_f32_16x16x32_bf16 v[26:29], v[64:67], a[252:255], v[26:29]
    v_mfma_f32_32x32x16_bf16 v[192:207], v[68:71], a[240:243], v[192:207]
    ds_read_b64_tr_b16 v[64:65], v18 offset:20480
    ds_read_b64_tr_b16 v[66:67], v18 offset:21504
    buffer_load_dwordx4 a[28:31], v21, s[16:19], s67 offen offset:2048 sc1
    v_mfma_f32_32x32x16_bf16 v[176:191], v[40:43], a[228:231], v[176:191]
    ds_read_b64_tr_b16 v[68:69], v20 offset:20480
    ds_read_b64_tr_b16 v[70:71], v20 offset:21504
    s_barrier
    v_mfma_f32_32x32x16_bf16 v[192:207], v[44:47], a[228:231], v[192:207]
    ds_read_b64_tr_b16 v[40:41], v72 offset:0
    ds_read_b64_tr_b16 v[42:43], v72 offset:1024
    ds_write_b128 v25, v[26:29] offset:512
    s_waitcnt lgkmcnt(9)
    v_mfma_f32_32x32x16_bf16 v[176:191], v[48:51], a[244:247], v[176:191]
    ds_read_b64_tr_b16 v[44:45], v74 offset:0
    ds_read_b64_tr_b16 v[46:47], v74 offset:1024
    s_mul_i32 s46, s96, 221184
    s_add_u32 m0, s51, 0
    s_add_u32 s46, s46, s60
    buffer_load_dwordx4 v236, s[12:15], s46 offen offset:0 lds
    v_mfma_f32_32x32x16_bf16 v[192:207], v[52:55], a[244:247], v[192:207]
    ds_read_b64_tr_b16 v[48:49], v76 offset:0
    ds_read_b64_tr_b16 v[50:51], v76 offset:1024
    v_mfma_f32_32x32x16_bf16 v[176:191], v[56:59], a[232:235], v[176:191]
    ds_read_b64_tr_b16 v[52:53], v78 offset:0
    ds_read_b64_tr_b16 v[54:55], v78 offset:1024
    s_waitcnt lgkmcnt(6)
    s_barrier
    ds_read_b32 v224, v23 offset:512
    ds_read_b32 v225, v23 offset:1536
    ds_read_b32 v228, v24 offset:640
    ds_read_b32 v229, v24 offset:1664
    buffer_load_dwordx4 a[32:35], v21, s[16:19], s67 offen offset:3072 sc1
    v_mfma_f32_32x32x16_bf16 v[192:207], v[60:63], a[232:235], v[192:207]
    ds_read_b64_tr_b16 v[56:57], v72 offset:4096
    ds_read_b64_tr_b16 v[58:59], v72 offset:5120
    v_mfma_f32_32x32x16_bf16 v[176:191], v[64:67], a[248:251], v[176:191]
    ds_read_b64_tr_b16 v[60:61], v74 offset:4096
    ds_read_b64_tr_b16 v[62:63], v74 offset:5120
    s_getreg_b32 s86, hwreg(HW_REG_IB_STS, 30, 2)
    s_getreg_b32 s87, hwreg(HW_REG_IB_STS, 0, 4)
    s_lshl4_add_u32 s86, s86, s87
    s_or_b32 s86, s86, s3
    s_cmp_le_u32 s86, 17
    s_cbranch_scc0 L_tf3
    buffer_store_dword v253, v252, s[16:19], s92 offen sc1
    s_mov_b32 s3, 0x100
L_tf3:
    v_mfma_f32_32x32x16_bf16 v[192:207], v[68:71], a[248:251], v[192:207]
    ds_read_b64_tr_b16 v[64:65], v76 offset:4096
    s_waitcnt lgkmcnt(5)
    ds_read_b64_tr_b16 v[66:67], v76 offset:5120
    buffer_load_dwordx4 v237, s[12:15], s46 offen offset:1024 lds
    v_add_f32 v224, v224, v225
    v_and_b32 v35, 0xffff0000, v224
    v_mfma_f32_32x32x16_bf16 v[112:127], v[40:43], a[92:95], 0
    ds_read_b64_tr_b16 v[68:69], v78 offset:4096
    ds_read_b64_tr_b16 v[70:71], v78 offset:5120
    v_sub_f32 v225, v224, v35
    v_and_b32 v35, 0xffff0000, v225
    v_alignbit_b32 v224, v35, v224, 16
    v_sub_f32 v225, v225, v35
    v_mfma_f32_16x16x32_bf16 v[26:29], v[40:43], a[252:255], 0
    v_or_b32 v224, v224, v35
    v_lshrrev_b32 v225, 16, v225
    v_mfma_f32_32x32x16_bf16 v[128:143], v[44:47], a[92:95], 0
    ds_read_b64_tr_b16 v[40:41], v73 offset:0
    ds_read_b64_tr_b16 v[42:43], v73 offset:1024
    s_add_u32 s67, s67, 4096
    buffer_load_dwordx4 a[36:39], v21, s[16:19], s67 offen offset:0 sc1
    v_add_f32 v228, v228, v229
    v_and_b32 v36, 0xffff0000, v228
    v_mfma_f32_32x32x16_bf16 v[112:127], v[48:51], a[108:111], v[112:127]
    ds_read_b64_tr_b16 v[44:45], v75 offset:0
    ds_read_b64_tr_b16 v[46:47], v75 offset:1024
    buffer_load_dwordx4 v238, s[12:15], s46 offen offset:2048 lds
    v_sub_f32 v229, v228, v36
    v_and_b32 v36, 0xffff0000, v229
    v_mfma_f32_16x16x32_bf16 v[26:29], v[48:51], a[252:255], v[26:29]
    v_alignbit_b32 v228, v36, v228, 16
    v_sub_f32 v229, v229, v36
    v_mfma_f32_32x32x16_bf16 v[128:143], v[52:55], a[108:111], v[128:143]
    ds_read_b64_tr_b16 v[48:49], v77 offset:0
    ds_read_b64_tr_b16 v[50:51], v77 offset:1024
    v_or_b32 v228, v228, v36
    v_lshrrev_b32 v229, 16, v229
    s_waitcnt lgkmcnt(4)
    v_mfma_f32_32x32x16_bf16 v[112:127], v[56:59], a[96:99], v[112:127]
    ds_read_b64_tr_b16 v[52:53], v79 offset:0
    ds_read_b64_tr_b16 v[54:55], v79 offset:1024
    v_mfma_f32_16x16x32_bf16 v[26:29], v[56:59], a[252:255], v[26:29]
    v_mfma_f32_32x32x16_bf16 v[128:143], v[60:63], a[96:99], v[128:143]
    ds_read_b64_tr_b16 v[56:57], v73 offset:4096
    ds_read_b64_tr_b16 v[58:59], v73 offset:5120
    buffer_load_dwordx4 v239, s[12:15], s46 offen offset:3072 lds
    v_mfma_f32_32x32x16_bf16 v[176:191], v[224:227], v[232:235], v[176:191]
    v_mfma_f32_32x32x16_bf16 v[112:127], v[64:67], a[112:115], v[112:127]
    ds_read_b64_tr_b16 v[60:61], v75 offset:4096
    ds_read_b64_tr_b16 v[62:63], v75 offset:5120
    v_mfma_f32_16x16x32_bf16 v[26:29], v[64:67], a[252:255], v[26:29]
    v_mfma_f32_32x32x16_bf16 v[128:143], v[68:71], a[112:115], v[128:143]
    ds_read_b64_tr_b16 v[64:65], v77 offset:4096
    ds_read_b64_tr_b16 v[66:67], v77 offset:5120
    s_add_u32 s67, s65, 40960
    buffer_load_dwordx4 a[40:43], v21, s[16:19], s67 offen offset:0 sc1
    v_mfma_f32_32x32x16_bf16 v[192:207], v[228:231], v[232:235], v[192:207]
    s_nop 1
    v_mul_f32 v88, v33, v176
    v_mul_f32 v89, v33, v177
    v_mul_f32 v90, v33, v178
    v_mul_f32 v91, v33, v179
    v_mul_f32 v92, v33, v180
    v_mul_f32 v93, v33, v181
    v_mfma_f32_32x32x16_bf16 v[112:127], v[40:43], a[100:103], v[112:127]
    ds_read_b64_tr_b16 v[68:69], v79 offset:4096
    ds_read_b64_tr_b16 v[70:71], v79 offset:5120
    s_waitcnt vmcnt(15)
    s_barrier
    v_mul_f32 v94, v33, v182
    v_mul_f32 v95, v33, v183
    s_waitcnt lgkmcnt(2)
    v_mfma_f32_32x32x16_bf16 v[128:143], v[44:47], a[100:103], v[128:143]
    ds_read_b64_tr_b16 v[40:41], v13 offset:32768
    ds_read_b64_tr_b16 v[42:43], v13 offset:33792
    v_exp_f32 v88, v88
    v_exp_f32 v89, v89
    v_mfma_f32_32x32x16_bf16 v[112:127], v[48:51], a[116:119], v[112:127]
    ds_read_b64_tr_b16 v[44:45], v15 offset:32768
    ds_read_b64_tr_b16 v[46:47], v15 offset:33792
    s_mul_i32 s46, s97, 221184
    s_add_u32 m0, s51, 16384
    s_add_u32 s46, s46, s60
    buffer_load_dwordx4 v236, s[12:15], s46 offen offset:0 lds
    s_cmp_lg_u32 s3, 0
    s_cbranch_scc1 L_tf4
    buffer_store_dword v253, v252, s[16:19], s92 offen sc1
    s_mov_b32 s3, 0x100
L_tf4:
    v_exp_f32 v90, v90
    v_mfma_f32_32x32x16_bf16 v[128:143], v[52:55], a[116:119], v[128:143]
    ds_read_b64_tr_b16 v[48:49], v17 offset:32768
    ds_read_b64_tr_b16 v[50:51], v17 offset:33792
    v_exp_f32 v91, v91
    v_exp_f32 v92, v92
    v_mfma_f32_32x32x16_bf16 v[112:127], v[56:59], a[104:107], v[112:127]
    ds_read_b64_tr_b16 v[52:53], v19 offset:32768
    ds_read_b64_tr_b16 v[54:55], v19 offset:33792
    buffer_load_dwordx4 a[44:47], v21, s[16:19], s67 offen offset:1024 sc1
    v_exp_f32 v93, v93
    v_mfma_f32_32x32x16_bf16 v[128:143], v[60:63], a[104:107], v[128:143]
    ds_read_b64_tr_b16 v[56:57], v13 offset:36864
    ds_read_b64_tr_b16 v[58:59], v13 offset:37888
    v_exp_f32 v94, v94
    v_exp_f32 v95, v95
    v_mfma_f32_32x32x16_bf16 v[112:127], v[64:67], a[120:123], v[112:127]
    ds_read_b64_tr_b16 v[60:61], v15 offset:36864
    ds_read_b64_tr_b16 v[62:63], v15 offset:37888
    v_fma_f32 v88, v88, v32, v32
    v_fma_f32 v89, v89, v32, v32
    v_fma_f32 v90, v90, v32, v32
    v_fma_f32 v91, v91, v32, v32
    s_waitcnt lgkmcnt(5)
    v_mfma_f32_32x32x16_bf16 v[128:143], v[68:71], a[120:123], v[128:143]
    ds_read_b64_tr_b16 v[64:65], v17 offset:36864
    ds_read_b64_tr_b16 v[66:67], v17 offset:37888
    buffer_load_dwordx4 v237, s[12:15], s46 offen offset:1024 lds
    v_fma_f32 v92, v92, v32, v32
    v_fma_f32 v93, v93, v32, v32
    v_mfma_f32_32x32x16_bf16 v[112:127], v[40:43], a[124:127], v[112:127]
    ds_read_b64_tr_b16 v[68:69], v19 offset:36864
    ds_read_b64_tr_b16 v[70:71], v19 offset:37888
    v_fma_f32 v94, v94, v32, v32
    v_fma_f32 v95, v95, v32, v32
    v_rcp_f32 v88, v88
    v_mfma_f32_16x16x32_bf16 v[26:29], v[40:43], a[252:255], v[26:29]
    v_rcp_f32 v89, v89
    v_mfma_f32_32x32x16_bf16 v[128:143], v[44:47], a[124:127], v[128:143]
    ds_read_b64_tr_b16 v[40:41], v14 offset:32768
    ds_read_b64_tr_b16 v[42:43], v14 offset:33792
    buffer_load_dwordx4 a[48:51], v21, s[16:19], s67 offen offset:2048 sc1
    v_rcp_f32 v90, v90
    v_rcp_f32 v91, v91
    v_mfma_f32_32x32x16_bf16 v[112:127], v[48:51], a[140:143], v[112:127]
    ds_read_b64_tr_b16 v[44:45], v16 offset:32768
    ds_read_b64_tr_b16 v[46:47], v16 offset:33792
    buffer_load_dwordx4 v238, s[12:15], s46 offen offset:2048 lds
    v_rcp_f32 v92, v92
    v_mfma_f32_16x16x32_bf16 v[26:29], v[48:51], a[252:255], v[26:29]
    v_rcp_f32 v93, v93
    s_waitcnt lgkmcnt(4)
    v_mfma_f32_32x32x16_bf16 v[128:143], v[52:55], a[140:143], v[128:143]
    ds_read_b64_tr_b16 v[48:49], v18 offset:32768
    ds_read_b64_tr_b16 v[50:51], v18 offset:33792
    v_rcp_f32 v94, v94
    v_rcp_f32 v95, v95
    v_mfma_f32_32x32x16_bf16 v[112:127], v[56:59], a[128:131], v[112:127]
    ds_read_b64_tr_b16 v[52:53], v20 offset:32768
    ds_read_b64_tr_b16 v[54:55], v20 offset:33792
    v_mul_f32 v176, v176, v88
    v_mul_f32 v177, v177, v89
    v_mul_f32 v178, v178, v90
    v_mul_f32 v179, v179, v91
    v_mfma_f32_16x16x32_bf16 v[26:29], v[56:59], a[252:255], v[26:29]
    v_mul_f32 v180, v180, v92
    v_mul_f32 v181, v181, v93
    v_mfma_f32_32x32x16_bf16 v[128:143], v[60:63], a[128:131], v[128:143]
    ds_read_b64_tr_b16 v[56:57], v14 offset:36864
    ds_read_b64_tr_b16 v[58:59], v14 offset:37888
    buffer_load_dwordx4 v239, s[12:15], s46 offen offset:3072 lds
    v_mul_f32 v182, v182, v94
    v_mul_f32 v183, v183, v95
    v_mfma_f32_32x32x16_bf16 v[112:127], v[64:67], a[144:147], v[112:127]
    ds_read_b64_tr_b16 v[60:61], v16 offset:36864
    ds_read_b64_tr_b16 v[62:63], v16 offset:37888
    buffer_load_dwordx4 a[52:55], v21, s[16:19], s67 offen offset:3072 sc1
    v_cvt_pk_bf16_f32 v104, v176, v177
    v_cvt_pk_bf16_f32 v105, v178, v179
    v_mfma_f32_16x16x32_bf16 v[26:29], v[64:67], a[252:255], v[26:29]
    v_cvt_pk_bf16_f32 v106, v180, v181
    v_cvt_pk_bf16_f32 v107, v182, v183
    v_mfma_f32_32x32x16_bf16 v[128:143], v[68:71], a[144:147], v[128:143]
    ds_read_b64_tr_b16 v[64:65], v18 offset:36864
    ds_read_b64_tr_b16 v[66:67], v18 offset:37888
    buffer_store_dwordx4 v[104:107], v21, s[16:19], s53 offen offset:0 sc1
    s_waitcnt lgkmcnt(5)
    v_mfma_f32_32x32x16_bf16 v[112:127], v[40:43], a[132:135], v[112:127]
    ds_read_b64_tr_b16 v[68:69], v20 offset:36864
    ds_read_b64_tr_b16 v[70:71], v20 offset:37888
    s_waitcnt vmcnt(16)
    s_barrier
    v_mul_f32 v96, v33, v184
    v_mul_f32 v97, v33, v185
    v_mfma_f32_32x32x16_bf16 v[128:143], v[44:47], a[132:135], v[128:143]
    ds_read_b64_tr_b16 v[40:41], v13 offset:49152
    ds_read_b64_tr_b16 v[42:43], v13 offset:50176
    v_mul_f32 v98, v33, v186
    v_mul_f32 v99, v33, v187
    v_mul_f32 v100, v33, v188
    v_mul_f32 v101, v33, v189
    v_mfma_f32_32x32x16_bf16 v[112:127], v[48:51], a[148:151], v[112:127]
    ds_read_b64_tr_b16 v[44:45], v15 offset:49152
    ds_read_b64_tr_b16 v[46:47], v15 offset:50176
    v_mul_f32 v102, v33, v190
    v_mul_f32 v103, v33, v191
    v_exp_f32 v96, v96
    v_mfma_f32_32x32x16_bf16 v[128:143], v[52:55], a[148:151], v[128:143]
    ds_read_b64_tr_b16 v[48:49], v17 offset:49152
    ds_read_b64_tr_b16 v[50:51], v17 offset:50176
    s_add_u32 s67, s67, 4096
    buffer_load_dwordx4 a[56:59], v21, s[16:19], s67 offen offset:0 sc1
    v_exp_f32 v97, v97
    v_exp_f32 v98, v98
    s_waitcnt lgkmcnt(4)
    v_mfma_f32_32x32x16_bf16 v[112:127], v[56:59], a[136:139], v[112:127]
    ds_read_b64_tr_b16 v[52:53], v19 offset:49152
    ds_read_b64_tr_b16 v[54:55], v19 offset:50176
    v_exp_f32 v99, v99
    v_exp_f32 v100, v100
    v_mfma_f32_32x32x16_bf16 v[128:143], v[60:63], a[136:139], v[128:143]
    ds_read_b64_tr_b16 v[56:57], v13 offset:53248
    ds_read_b64_tr_b16 v[58:59], v13 offset:54272
    v_exp_f32 v101, v101
    v_exp_f32 v102, v102
    v_mfma_f32_32x32x16_bf16 v[112:127], v[64:67], a[152:155], v[112:127]
    ds_read_b64_tr_b16 v[60:61], v15 offset:53248
    ds_read_b64_tr_b16 v[62:63], v15 offset:54272
    v_exp_f32 v103, v103
    v_fma_f32 v96, v96, v32, v32
    v_fma_f32 v97, v97, v32, v32
    v_mfma_f32_32x32x16_bf16 v[128:143], v[68:71], a[152:155], v[128:143]
    ds_read_b64_tr_b16 v[64:65], v17 offset:53248
    ds_read_b64_tr_b16 v[66:67], v17 offset:54272
    v_fma_f32 v98, v98, v32, v32
    v_fma_f32 v99, v99, v32, v32
    v_fma_f32 v100, v100, v32, v32
    v_fma_f32 v101, v101, v32, v32
    v_mfma_f32_32x32x16_bf16 v[112:127], v[40:43], a[156:159], v[112:127]
    ds_read_b64_tr_b16 v[68:69], v19 offset:53248
    ds_read_b64_tr_b16 v[70:71], v19 offset:54272
    v_fma_f32 v102, v102, v32, v32
    v_fma_f32 v103, v103, v32, v32
    v_rcp_f32 v96, v96
    v_mfma_f32_16x16x32_bf16 v[26:29], v[40:43], a[252:255], v[26:29]
    v_rcp_f32 v97, v97
    s_waitcnt lgkmcnt(4)
    v_mfma_f32_32x32x16_bf16 v[128:143], v[44:47], a[156:159], v[128:143]
    ds_read_b64_tr_b16 v[40:41], v14 offset:49152
    ds_read_b64_tr_b16 v[42:43], v14 offset:50176
    s_add_u32 s67, s65, 61440
    buffer_load_dwordx4 a[60:63], v21, s[16:19], s67 offen offset:0 sc1
    v_rcp_f32 v98, v98
    v_rcp_f32 v99, v99
    v_mfma_f32_32x32x16_bf16 v[112:127], v[48:51], a[172:175], v[112:127]
    ds_read_b64_tr_b16 v[44:45], v16 offset:49152
    ds_read_b64_tr_b16 v[46:47], v16 offset:50176
    v_rcp_f32 v100, v100
    v_rcp_f32 v101, v101
    v_mfma_f32_16x16x32_bf16 v[26:29], v[48:51], a[252:255], v[26:29]
    v_rcp_f32 v102, v102
    v_mfma_f32_32x32x16_bf16 v[128:143], v[52:55], a[172:175], v[128:143]
    ds_read_b64_tr_b16 v[48:49], v18 offset:49152
    ds_read_b64_tr_b16 v[50:51], v18 offset:50176
    v_rcp_f32 v103, v103
    v_mul_f32 v184, v184, v96
    v_mul_f32 v185, v185, v97
    v_mfma_f32_32x32x16_bf16 v[112:127], v[56:59], a[160:163], v[112:127]
    ds_read_b64_tr_b16 v[52:53], v20 offset:49152
    ds_read_b64_tr_b16 v[54:55], v20 offset:50176
    buffer_load_dword v251, v250, s[16:19], 0 offen sc1
    v_mul_f32 v186, v186, v98
    v_mul_f32 v187, v187, v99
    v_mfma_f32_16x16x32_bf16 v[26:29], v[56:59], a[252:255], v[26:29]
    v_mul_f32 v188, v188, v100
    v_mul_f32 v189, v189, v101
    v_mfma_f32_32x32x16_bf16 v[128:143], v[60:63], a[160:163], v[128:143]
    ds_read_b64_tr_b16 v[56:57], v14 offset:53248
    ds_read_b64_tr_b16 v[58:59], v14 offset:54272
    v_mul_f32 v190, v190, v102
    v_mul_f32 v191, v191, v103
    v_cvt_pk_bf16_f32 v108, v184, v185
    v_cvt_pk_bf16_f32 v109, v186, v187
    s_waitcnt lgkmcnt(4)
    v_mfma_f32_32x32x16_bf16 v[112:127], v[64:67], a[176:179], v[112:127]
    ds_read_b64_tr_b16 v[60:61], v16 offset:53248
    ds_read_b64_tr_b16 v[62:63], v16 offset:54272
    buffer_load_dwordx4 a[64:67], v21, s[16:19], s67 offen offset:1024 sc1
    v_cvt_pk_bf16_f32 v110, v188, v189
    v_cvt_pk_bf16_f32 v111, v190, v191
    v_mfma_f32_16x16x32_bf16 v[26:29], v[64:67], a[252:255], v[26:29]
    v_mfma_f32_32x32x16_bf16 v[128:143], v[68:71], a[176:179], v[128:143]
    ds_read_b64_tr_b16 v[64:65], v18 offset:53248
    ds_read_b64_tr_b16 v[66:67], v18 offset:54272
    buffer_store_dwordx4 v[108:111], v21, s[16:19], s53 offen offset:1024 sc1
    v_mfma_f32_32x32x16_bf16 v[112:127], v[40:43], a[164:167], v[112:127]
    ds_read_b64_tr_b16 v[68:69], v20 offset:53248
    ds_read_b64_tr_b16 v[70:71], v20 offset:54272
    s_waitcnt vmcnt(14)
    s_barrier
    v_mul_f32 v88, v33, v192
    v_mul_f32 v89, v33, v193
    v_mul_f32 v90, v33, v194
    v_mfma_f32_32x32x16_bf16 v[128:143], v[44:47], a[164:167], v[128:143]
    ds_read_b64_tr_b16 v[40:41], v13 offset:0
    ds_read_b64_tr_b16 v[42:43], v13 offset:1024
    v_mul_f32 v91, v33, v195
    v_mul_f32 v92, v33, v196
    v_mul_f32 v93, v33, v197
    v_mul_f32 v94, v33, v198
    v_mfma_f32_32x32x16_bf16 v[112:127], v[48:51], a[180:183], v[112:127]
    ds_read_b64_tr_b16 v[44:45], v15 offset:0
    ds_read_b64_tr_b16 v[46:47], v15 offset:1024
    v_mul_f32 v95, v33, v199
    v_exp_f32 v88, v88
    s_waitcnt lgkmcnt(4)
    v_mfma_f32_32x32x16_bf16 v[128:143], v[52:55], a[180:183], v[128:143]
    ds_read_b64_tr_b16 v[48:49], v17 offset:0
    ds_read_b64_tr_b16 v[50:51], v17 offset:1024
    buffer_load_dwordx4 a[68:71], v21, s[16:19], s67 offen offset:2048 sc1
    v_exp_f32 v89, v89
    v_exp_f32 v90, v90
    v_mfma_f32_32x32x16_bf16 v[112:127], v[56:59], a[168:171], v[112:127]
    ds_read_b64_tr_b16 v[52:53], v19 offset:0
    ds_read_b64_tr_b16 v[54:55], v19 offset:1024
    v_exp_f32 v91, v91
    v_exp_f32 v92, v92
    v_mfma_f32_32x32x16_bf16 v[128:143], v[60:63], a[168:171], v[128:143]
    ds_read_b64_tr_b16 v[56:57], v13 offset:4096
    ds_read_b64_tr_b16 v[58:59], v13 offset:5120
    v_exp_f32 v93, v93
    v_exp_f32 v94, v94
    v_mfma_f32_32x32x16_bf16 v[112:127], v[64:67], a[184:187], v[112:127]
    ds_read_b64_tr_b16 v[60:61], v15 offset:4096
    ds_read_b64_tr_b16 v[62:63], v15 offset:5120
    v_exp_f32 v95, v95
    v_fma_f32 v88, v88, v32, v32
    v_fma_f32 v89, v89, v32, v32
    v_mfma_f32_32x32x16_bf16 v[128:143], v[68:71], a[184:187], v[128:143]
    ds_read_b64_tr_b16 v[64:65], v17 offset:4096
    ds_read_b64_tr_b16 v[66:67], v17 offset:5120
    buffer_load_dwordx4 a[72:75], v21, s[16:19], s67 offen offset:3072 sc1
    v_fma_f32 v90, v90, v32, v32
    v_fma_f32 v91, v91, v32, v32
    v_fma_f32 v92, v92, v32, v32
    s_waitcnt lgkmcnt(4)
    v_mfma_f32_32x32x16_bf16 v[112:127], v[40:43], a[188:191], v[112:127]
    ds_read_b64_tr_b16 v[68:69], v19 offset:4096
    ds_read_b64_tr_b16 v[70:71], v19 offset:5120
    v_fma_f32 v93, v93, v32, v32
    v_fma_f32 v94, v94, v32, v32
    v_fma_f32 v95, v95, v32, v32
    v_mfma_f32_16x16x32_bf16 v[26:29], v[40:43], a[252:255], v[26:29]
    v_rcp_f32 v88, v88
    v_mfma_f32_32x32x16_bf16 v[128:143], v[44:47], a[188:191], v[128:143]
    ds_read_b64_tr_b16 v[40:41], v14 offset:0
    ds_read_b64_tr_b16 v[42:43], v14 offset:1024
    v_rcp_f32 v89, v89
    v_rcp_f32 v90, v90
    v_mfma_f32_32x32x16_bf16 v[112:127], v[48:51], a[204:207], v[112:127]
    ds_read_b64_tr_b16 v[44:45], v16 offset:0
    ds_read_b64_tr_b16 v[46:47], v16 offset:1024
    v_rcp_f32 v91, v91
    v_rcp_f32 v92, v92
    v_mfma_f32_16x16x32_bf16 v[26:29], v[48:51], a[252:255], v[26:29]
    v_rcp_f32 v93, v93
    v_mfma_f32_32x32x16_bf16 v[128:143], v[52:55], a[204:207], v[128:143]
    ds_read_b64_tr_b16 v[48:49], v18 offset:0
    ds_read_b64_tr_b16 v[50:51], v18 offset:1024
    v_rcp_f32 v94, v94
    v_rcp_f32 v95, v95
    v_mfma_f32_32x32x16_bf16 v[112:127], v[56:59], a[192:195], v[112:127]
    ds_read_b64_tr_b16 v[52:53], v20 offset:0
    ds_read_b64_tr_b16 v[54:55], v20 offset:1024
    v_mul_f32 v192, v192, v88
    v_mul_f32 v193, v193, v89
    v_mul_f32 v194, v194, v90
    v_mul_f32 v195, v195, v91
    v_mfma_f32_16x16x32_bf16 v[26:29], v[56:59], a[252:255], v[26:29]
    v_mul_f32 v196, v196, v92
    v_mul_f32 v197, v197, v93
    s_waitcnt lgkmcnt(4)
    v_mfma_f32_32x32x16_bf16 v[128:143], v[60:63], a[192:195], v[128:143]
    ds_read_b64_tr_b16 v[56:57], v14 offset:4096
    ds_read_b64_tr_b16 v[58:59], v14 offset:5120
    s_add_u32 s67, s67, 4096
    buffer_load_dwordx4 a[76:79], v21, s[16:19], s67 offen offset:0 sc1
    v_mul_f32 v198, v198, v94
    v_mul_f32 v199, v199, v95
    v_cvt_pk_bf16_f32 v104, v192, v193
    v_mfma_f32_32x32x16_bf16 v[112:127], v[64:67], a[208:211], v[112:127]
    ds_read_b64_tr_b16 v[60:61], v16 offset:4096
    ds_read_b64_tr_b16 v[62:63], v16 offset:5120
    v_cvt_pk_bf16_f32 v105, v194, v195
    v_cvt_pk_bf16_f32 v106, v196, v197
    v_cvt_pk_bf16_f32 v107, v198, v199
    v_mfma_f32_16x16x32_bf16 v[26:29], v[64:67], a[252:255], v[26:29]
    v_mfma_f32_32x32x16_bf16 v[128:143], v[68:71], a[208:211], v[128:143]
    ds_read_b64_tr_b16 v[64:65], v18 offset:4096
    ds_read_b64_tr_b16 v[66:67], v18 offset:5120
    buffer_store_dwordx4 v[104:107], v21, s[16:19], s54 offen offset:0 sc1
    v_mfma_f32_32x32x16_bf16 v[112:127], v[40:43], a[196:199], v[112:127]
    ds_read_b64_tr_b16 v[68:69], v20 offset:4096
    ds_read_b64_tr_b16 v[70:71], v20 offset:5120
    s_waitcnt vmcnt(11)
    s_barrier
    s_waitcnt vmcnt(6)
    v_cmp_ne_u32 vcc, 0, v251
    s_nop 0
    s_or_b64 vcc, vcc, s[62:63]
    s_cmp_eq_u64 vcc, -1
    s_cbranch_scc0 L_spin4
L_back4:
    v_mul_f32 v96, v33, v200
    v_mul_f32 v97, v33, v201
    v_mul_f32 v98, v33, v202
    v_mfma_f32_32x32x16_bf16 v[128:143], v[44:47], a[196:199], v[128:143]
    ds_read_b64_tr_b16 v[40:41], v13 offset:16384
    ds_read_b64_tr_b16 v[42:43], v13 offset:17408
    v_mul_f32 v99, v33, v203
    v_mul_f32 v100, v33, v204
    v_mul_f32 v101, v33, v205
    v_mul_f32 v102, v33, v206
    s_waitcnt lgkmcnt(3)
    v_mfma_f32_32x32x16_bf16 v[112:127], v[48:51], a[212:215], v[112:127]
    ds_read_b64_tr_b16 v[44:45], v15 offset:16384
    ds_read_b64_tr_b16 v[46:47], v15 offset:17408
    s_lshl_b32 s83, s39, 2
    s_add_u32 s83, s83, s36
    s_mul_i32 s83, s83, 81920
    s_mul_i32 s84, s40, 2560
    s_add_u32 s83, s83, s84
    v_and_b32 v37, 0x1ff, v21
    buffer_load_dwordx4 v[240:243], v21, s[16:19], s83 offen sc1
    v_mul_f32 v103, v33, v207
    v_exp_f32 v96, v96
    v_mfma_f32_32x32x16_bf16 v[128:143], v[52:55], a[212:215], v[128:143]
    ds_read_b64_tr_b16 v[48:49], v17 offset:16384
    ds_read_b64_tr_b16 v[50:51], v17 offset:17408
    v_exp_f32 v97, v97
    v_exp_f32 v98, v98
    v_mfma_f32_32x32x16_bf16 v[112:127], v[56:59], a[200:203], v[112:127]
    ds_read_b64_tr_b16 v[52:53], v19 offset:16384
    ds_read_b64_tr_b16 v[54:55], v19 offset:17408
    v_exp_f32 v99, v99
    v_exp_f32 v100, v100
    v_mfma_f32_32x32x16_bf16 v[128:143], v[60:63], a[200:203], v[128:143]
    ds_read_b64_tr_b16 v[56:57], v13 offset:20480
    ds_read_b64_tr_b16 v[58:59], v13 offset:21504
    buffer_load_dwordx4 v[248:251], v37, s[16:19], s83 offen offset:1024 sc1
    v_exp_f32 v101, v101
    v_exp_f32 v102, v102
    v_mfma_f32_32x32x16_bf16 v[112:127], v[64:67], a[216:219], v[112:127]
    ds_read_b64_tr_b16 v[60:61], v15 offset:20480
    ds_read_b64_tr_b16 v[62:63], v15 offset:21504
    buffer_load_dwordx4 v[244:247], v21, s[16:19], s83 offen offset:1536 sc1
    v_exp_f32 v103, v103
    v_fma_f32 v96, v96, v32, v32
    s_waitcnt lgkmcnt(4)
    v_mfma_f32_32x32x16_bf16 v[128:143], v[68:71], a[216:219], v[128:143]
    ds_read_b64_tr_b16 v[64:65], v17 offset:20480
    ds_read_b64_tr_b16 v[66:67], v17 offset:21504
    v_fma_f32 v97, v97, v32, v32
    v_fma_f32 v98, v98, v32, v32
    v_fma_f32 v99, v99, v32, v32
    v_fma_f32 v100, v100, v32, v32
    v_mfma_f32_32x32x16_bf16 v[112:127], v[40:43], a[220:223], v[112:127]
    ds_read_b64_tr_b16 v[68:69], v19 offset:20480
    ds_read_b64_tr_b16 v[70:71], v19 offset:21504
    s_add_u32 s84, s82, 0
    s_mul_i32 s83, s84, s79
    s_add_u32 s83, s83, s81
    s_cmp_lt_i32 s84, 0
    s_cselect_b32 s83, 2146435072, s83
    s_add_u32 m0, s80, 0
    s_nop 0
    buffer_load_dwordx4 v1, s[16:19], s83 offen offset:0 sc1 lds
    v_fma_f32 v101, v101, v32, v32
    v_fma_f32 v102, v102, v32, v32
    v_fma_f32 v103, v103, v32, v32
    v_mfma_f32_16x16x32_bf16 v[26:29], v[40:43], a[252:255], v[26:29]
    v_rcp_f32 v96, v96
    v_mfma_f32_32x32x16_bf16 v[128:143], v[44:47], a[220:223], v[128:143]
    ds_read_b64_tr_b16 v[40:41], v14 offset:16384
    ds_read_b64_tr_b16 v[42:43], v14 offset:17408
    v_rcp_f32 v97, v97
    v_rcp_f32 v98, v98
    v_mfma_f32_32x32x16_bf16 v[112:127], v[48:51], a[236:239], v[112:127]
    ds_read_b64_tr_b16 v[44:45], v16 offset:16384
    ds_read_b64_tr_b16 v[46:47], v16 offset:17408
    v_rcp_f32 v99, v99
    v_rcp_f32 v100, v100
    v_mfma_f32_16x16x32_bf16 v[26:29], v[48:51], a[252:255], v[26:29]
    v_rcp_f32 v101, v101
    v_mfma_f32_32x32x16_bf16 v[128:143], v[52:55], a[236:239], v[128:143]
    ds_read_b64_tr_b16 v[48:49], v18 offset:16384
    ds_read_b64_tr_b16 v[50:51], v18 offset:17408
    buffer_load_dwordx4 v2, s[16:19], s83 offen offset:1024 sc1 lds
    v_rcp_f32 v102, v102
    v_rcp_f32 v103, v103
    s_waitcnt lgkmcnt(4)
    v_mfma_f32_32x32x16_bf16 v[112:127], v[56:59], a[224:227], v[112:127]
    ds_read_b64_tr_b16 v[52:53], v20 offset:16384
    ds_read_b64_tr_b16 v[54:55], v20 offset:17408
    buffer_load_dwordx4 v3, s[16:19], s83 offen offset:2048 sc1 lds
    v_mul_f32 v200, v200, v96
    v_mul_f32 v201, v201, v97
    v_mul_f32 v202, v202, v98
    v_mfma_f32_16x16x32_bf16 v[26:29], v[56:59], a[252:255], v[26:29]
    v_mul_f32 v203, v203, v99
    v_mul_f32 v204, v204, v100
    v_mfma_f32_32x32x16_bf16 v[128:143], v[60:63], a[224:227], v[128:143]
    ds_read_b64_tr_b16 v[56:57], v14 offset:20480
    ds_read_b64_tr_b16 v[58:59], v14 offset:21504
    v_mul_f32 v205, v205, v101
    v_mul_f32 v206, v206, v102
    v_mul_f32 v207, v207, v103
    v_cvt_pk_bf16_f32 v108, v200, v201
    v_mfma_f32_32x32x16_bf16 v[112:127], v[64:67], a[240:243], v[112:127]
    ds_read_b64_tr_b16 v[60:61], v16 offset:20480
    ds_read_b64_tr_b16 v[62:63], v16 offset:21504
    buffer_load_dwordx4 v4, s[16:19], s83 offen offset:3072 sc1 lds
    v_cvt_pk_bf16_f32 v109, v202, v203
    v_cvt_pk_bf16_f32 v110, v204, v205
    v_cvt_pk_bf16_f32 v111, v206, v207
    v_mfma_f32_16x16x32_bf16 v[26:29], v[64:67], a[252:255], v[26:29]
    v_mfma_f32_32x32x16_bf16 v[128:143], v[68:71], a[240:243], v[128:143]
    ds_read_b64_tr_b16 v[64:65], v18 offset:20480
    ds_read_b64_tr_b16 v[66:67], v18 offset:21504
    s_add_u32 m0, s80, 4096
    s_nop 0
    buffer_load_dwordx4 v87, s[16:19], s83 offen offset:0 sc1 lds
    buffer_store_dwordx4 v[108:111], v21, s[16:19], s54 offen offset:1024 sc1
    v_mfma_f32_32x32x16_bf16 v[112:127], v[40:43], a[228:231], v[112:127]
    ds_read_b64_tr_b16 v[68:69], v20 offset:20480
    ds_read_b64_tr_b16 v[70:71], v20 offset:21504
    s_waitcnt lgkmcnt(6)
    v_mfma_f32_32x32x16_bf16 v[128:143], v[44:47], a[228:231], v[128:143]
    ds_write_b128 v25, v[26:29] offset:768
    v_mfma_f32_32x32x16_bf16 v[112:127], v[48:51], a[244:247], v[112:127]
    s_add_u32 s84, s82, 1
    s_mul_i32 s83, s84, s79
    s_add_u32 s83, s83, s81
    s_cmp_lt_i32 s84, 0
    s_cselect_b32 s83, 2146435072, s83
    s_add_u32 m0, s80, 5120
    s_nop 0
    buffer_load_dwordx4 v1, s[16:19], s83 offen offset:0 sc1 lds
    v_mfma_f32_32x32x16_bf16 v[128:143], v[52:55], a[244:247], v[128:143]
    v_mfma_f32_32x32x16_bf16 v[112:127], v[56:59], a[232:235], v[112:127]
    s_waitcnt lgkmcnt(0)
    s_barrier
    ds_read_b32 v224, v23 offset:768
    ds_read_b32 v225, v23 offset:1792
    ds_read_b32 v228, v24 offset:896
    ds_read_b32 v229, v24 offset:1920
    buffer_load_dwordx4 v2, s[16:19], s83 offen offset:1024 sc1 lds
    v_mfma_f32_32x32x16_bf16 v[128:143], v[60:63], a[232:235], v[128:143]
    buffer_load_dwordx4 v3, s[16:19], s83 offen offset:2048 sc1 lds
    v_mfma_f32_32x32x16_bf16 v[112:127], v[64:67], a[248:251], v[112:127]
    v_mfma_f32_32x32x16_bf16 v[128:143], v[68:71], a[248:251], v[128:143]
    s_waitcnt lgkmcnt(2)
    v_add_f32 v224, v224, v225
    v_and_b32 v35, 0xffff0000, v224
    v_sub_f32 v225, v224, v35
    v_and_b32 v35, 0xffff0000, v225
    v_alignbit_b32 v224, v35, v224, 16
    v_sub_f32 v225, v225, v35
    v_or_b32 v224, v224, v35
    v_lshrrev_b32 v225, 16, v225
    s_nop 1
    v_mfma_f32_32x32x16_bf16 v[112:127], v[224:227], v[232:235], v[112:127]
    s_waitcnt lgkmcnt(0)
    v_add_f32 v228, v228, v229
    v_and_b32 v36, 0xffff0000, v228
    v_sub_f32 v229, v228, v36
    v_and_b32 v36, 0xffff0000, v229
    v_alignbit_b32 v228, v36, v228, 16
    v_sub_f32 v229, v229, v36
    v_or_b32 v228, v228, v36
    v_lshrrev_b32 v229, 16, v229
    s_nop 1
    v_mfma_f32_32x32x16_bf16 v[128:143], v[228:231], v[232:235], v[128:143]
    buffer_load_dwordx4 v4, s[16:19], s83 offen offset:3072 sc1 lds
    v_mul_f32 v88, v33, v112
    v_mul_f32 v89, v33, v113
    v_mul_f32 v90, v33, v114
    v_mul_f32 v91, v33, v115
    s_add_u32 m0, s80, 9216
    s_nop 0
    buffer_load_dwordx4 v87, s[16:19], s83 offen offset:0 sc1 lds
    v_mul_f32 v92, v33, v116
    v_mul_f32 v93, v33, v117
    v_mul_f32 v94, v33, v118
    v_mul_f32 v95, v33, v119
    v_exp_f32 v88, v88
    v_exp_f32 v89, v89
    v_exp_f32 v90, v90
    v_exp_f32 v91, v91
    v_exp_f32 v92, v92
    v_exp_f32 v93, v93
    v_exp_f32 v94, v94
    v_exp_f32 v95, v95
    s_add_u32 s84, s82, 2
    s_mul_i32 s83, s84, s79
    s_add_u32 s83, s83, s81
    s_cmp_lt_i32 s84, 0
    s_cselect_b32 s83, 2146435072, s83
    s_add_u32 m0, s80, 10240
    s_nop 0
    buffer_load_dwordx4 v1, s[16:19], s83 offen offset:0 sc1 lds
    v_fma_f32 v88, v88, v32, v32
    v_fma_f32 v89, v89, v32, v32
    v_fma_f32 v90, v90, v32, v32
    v_fma_f32 v91, v91, v32, v32
    v_fma_f32 v92, v92, v32, v32
    v_fma_f32 v93, v93, v32, v32
    v_fma_f32 v94, v94, v32, v32
    v_fma_f32 v95, v95, v32, v32
    v_rcp_f32 v88, v88
    v_rcp_f32 v89, v89
    v_rcp_f32 v90, v90
    v_rcp_f32 v91, v91
    buffer_load_dwordx4 v2, s[16:19], s83 offen offset:1024 sc1 lds
    buffer_load_dwordx4 v3, s[16:19], s83 offen offset:2048 sc1 lds
    v_rcp_f32 v92, v92
    v_rcp_f32 v93, v93
    v_rcp_f32 v94, v94
    v_rcp_f32 v95, v95
    buffer_load_dwordx4 v4, s[16:19], s83 offen offset:3072 sc1 lds
    v_mul_f32 v112, v112, v88
    v_mul_f32 v113, v113, v89
    v_mul_f32 v114, v114, v90
    v_mul_f32 v115, v115, v91
    s_add_u32 m0, s80, 14336
    s_nop 0
    buffer_load_dwordx4 v87, s[16:19], s83 offen offset:0 sc1 lds
    v_mul_f32 v116, v116, v92
    v_mul_f32 v117, v117, v93
    v_mul_f32 v118, v118, v94
    v_mul_f32 v119, v119, v95
    v_cvt_pk_bf16_f32 v104, v112, v113
    v_cvt_pk_bf16_f32 v105, v114, v115
    v_cvt_pk_bf16_f32 v106, v116, v117
    v_cvt_pk_bf16_f32 v107, v118, v119
    s_add_u32 s67, s65, 81920
    buffer_load_dwordx4 a[80:83], v21, s[16:19], s67 offen offset:0 sc1
    buffer_store_dwordx4 v[104:107], v21, s[16:19], s55 offen offset:0 sc1
    v_mul_f32 v96, v33, v120
    v_mul_f32 v97, v33, v121
    v_mul_f32 v98, v33, v122
    v_mul_f32 v99, v33, v123
    v_mul_f32 v100, v33, v124
    v_mul_f32 v101, v33, v125
    v_mul_f32 v102, v33, v126
    v_mul_f32 v103, v33, v127
    v_exp_f32 v96, v96
    v_exp_f32 v97, v97
    v_exp_f32 v98, v98
    buffer_load_dwordx4 a[84:87], v21, s[16:19], s67 offen offset:1024 sc1
    v_exp_f32 v99, v99
    v_exp_f32 v100, v100
    v_exp_f32 v101, v101
    v_exp_f32 v102, v102
    v_exp_f32 v103, v103
    v_fma_f32 v96, v96, v32, v32
    v_fma_f32 v97, v97, v32, v32
    v_fma_f32 v98, v98, v32, v32
    buffer_load_dwordx4 a[88:91], v21, s[16:19], s67 offen offset:2048 sc1
    v_fma_f32 v99, v99, v32, v32
    v_fma_f32 v100, v100, v32, v32
    v_fma_f32 v101, v101, v32, v32
    v_fma_f32 v102, v102, v32, v32
    buffer_load_dwordx4 a[92:95], v21, s[16:19], s67 offen offset:3072 sc1
    v_fma_f32 v103, v103, v32, v32
    v_rcp_f32 v96, v96
    v_rcp_f32 v97, v97
    v_rcp_f32 v98, v98
    v_rcp_f32 v99, v99
    v_rcp_f32 v100, v100
    v_rcp_f32 v101, v101
    v_rcp_f32 v102, v102
    v_rcp_f32 v103, v103
    v_mul_f32 v120, v120, v96
    v_mul_f32 v121, v121, v97
    v_mul_f32 v122, v122, v98
    s_add_u32 s67, s67, 4096
    buffer_load_dwordx4 a[96:99], v21, s[16:19], s67 offen offset:0 sc1
    v_mul_f32 v123, v123, v99
    v_mul_f32 v124, v124, v100
    v_mul_f32 v125, v125, v101
    v_mul_f32 v126, v126, v102
    v_mul_f32 v127, v127, v103
    v_cvt_pk_bf16_f32 v108, v120, v121
    v_cvt_pk_bf16_f32 v109, v122, v123
    v_cvt_pk_bf16_f32 v110, v124, v125
    v_cvt_pk_bf16_f32 v111, v126, v127
    buffer_store_dwordx4 v[108:111], v21, s[16:19], s55 offen offset:1024 sc1
    v_mul_f32 v88, v33, v128
    v_mul_f32 v89, v33, v129
    v_mul_f32 v90, v33, v130
    v_mul_f32 v91, v33, v131
    v_mul_f32 v92, v33, v132
    v_mul_f32 v93, v33, v133
    v_mul_f32 v94, v33, v134
    v_mul_f32 v95, v33, v135
    v_exp_f32 v88, v88
    v_exp_f32 v89, v89
    v_exp_f32 v90, v90
    v_exp_f32 v91, v91
    v_exp_f32 v92, v92
    v_exp_f32 v93, v93
    v_exp_f32 v94, v94
    v_exp_f32 v95, v95
    v_fma_f32 v88, v88, v32, v32
    v_fma_f32 v89, v89, v32, v32
    v_fma_f32 v90, v90, v32, v32
    v_fma_f32 v91, v91, v32, v32
    v_fma_f32 v92, v92, v32, v32
    v_fma_f32 v93, v93, v32, v32
    v_fma_f32 v94, v94, v32, v32
    v_fma_f32 v95, v95, v32, v32
    v_rcp_f32 v88, v88
    v_rcp_f32 v89, v89
    v_rcp_f32 v90, v90
    v_rcp_f32 v91, v91
    v_rcp_f32 v92, v92
    v_rcp_f32 v93, v93
    v_rcp_f32 v94, v94
    v_rcp_f32 v95, v95
    v_mul_f32 v128, v128, v88
    v_mul_f32 v129, v129, v89
    v_mul_f32 v130, v130, v90
    v_mul_f32 v131, v131, v91
    v_mul_f32 v132, v132, v92
    v_mul_f32 v133, v133, v93
    v_mul_f32 v134, v134, v94
    v_mul_f32 v135, v135, v95
    v_cvt_pk_bf16_f32 v104, v128, v129
    v_cvt_pk_bf16_f32 v105, v130, v131
    v_cvt_pk_bf16_f32 v106, v132, v133
    v_cvt_pk_bf16_f32 v107, v134, v135
    buffer_store_dwordx4 v[104:107], v21, s[16:19], s56 offen offset:0 sc1
    v_mul_f32 v96, v33, v136
    v_mul_f32 v97, v33, v137
    v_mul_f32 v98, v33, v138
    v_mul_f32 v99, v33, v139
    v_mul_f32 v100, v33, v140
    v_mul_f32 v101, v33, v141
    v_mul_f32 v102, v33, v142
    v_mul_f32 v103, v33, v143
    v_exp_f32 v96, v96
    v_exp_f32 v97, v97
    v_exp_f32 v98, v98
    v_exp_f32 v99, v99
    v_exp_f32 v100, v100
    v_exp_f32 v101, v101
    v_exp_f32 v102, v102
    v_exp_f32 v103, v103
    v_fma_f32 v96, v96, v32, v32
    v_fma_f32 v97, v97, v32, v32
    v_fma_f32 v98, v98, v32, v32
    v_fma_f32 v99, v99, v32, v32
    v_fma_f32 v100, v100, v32, v32
    v_fma_f32 v101, v101, v32, v32
    v_fma_f32 v102, v102, v32, v32
    v_fma_f32 v103, v103, v32, v32
    v_rcp_f32 v96, v96
    v_rcp_f32 v97, v97
    v_rcp_f32 v98, v98
    v_rcp_f32 v99, v99
    v_rcp_f32 v100, v100
    v_rcp_f32 v101, v101
    v_rcp_f32 v102, v102
    v_rcp_f32 v103, v103
    v_mul_f32 v136, v136, v96
    v_mul_f32 v137, v137, v97
    v_mul_f32 v138, v138, v98
    v_mul_f32 v139, v139, v99
    v_mul_f32 v140, v140, v100
    v_mul_f32 v141, v141, v101
    v_mul_f32 v142, v142, v102
    v_mul_f32 v143, v143, v103
    v_cvt_pk_bf16_f32 v108, v136, v137
    v_cvt_pk_bf16_f32 v109, v138, v139
    v_cvt_pk_bf16_f32 v110, v140, v141
    v_cvt_pk_bf16_f32 v111, v142, v143
    buffer_store_dwordx4 v[108:111], v21, s[16:19], s56 offen offset:1024 sc1
    s_waitcnt vmcnt(9)
    s_branch L_att
L_att:
    s_barrier
    v_and_b32 v6, 31, v0
    v_lshrrev_b32 v7, 5, v0
    s_mul_i32 s47, s36, 2560
    s_add_u32 s47, s47, 65536
    v_lshl_add_u32 v8, v6, 4, s47
    v_lshl_add_u32 v18, v7, 9, v8
    v_add_u32 v8, 0x400, v8
    s_add_u32 s48, s47, 61440
    v_mov_b32 v9, s48
    v_cmp_gt_u32 vcc, 32, v0
    s_nop 1
    v_cndmask_b32 v19, v9, v8, vcc
    ds_read_b128 v[22:25], v18 offset:0
    ds_read_b128 v[26:29], v19 offset:0
    ds_read_b128 v[30:33], v18 offset:20480
    ds_read_b128 v[34:37], v19 offset:20480
    v_mov_b32 v9, 0x3f80
    v_cndmask_b32 v10, v9, v248, vcc
    v_cndmask_b32_e64 v11, 0, v249, vcc
    v_mov_b32 v12, 0
    v_mov_b32 v13, 0
    v_cndmask_b32_e64 v14, v9, 0, vcc
    v_mov_b32 v15, 0
    v_cndmask_b32_e64 v16, 0, v250, vcc
    v_cndmask_b32_e64 v17, 0, v251, vcc
    s_mov_b32 s70, 0xffffffff
    s_mov_b32 s71, 0xfffffff0
    s_mov_b32 s72, 0xfffffffe
    s_mov_b32 s73, 0xffffffe0
    s_mov_b32 s74, 0xfffffffc
    s_mov_b32 s75, 0xffffffc0
    s_mov_b32 s76, 0xfffffff8
    s_mov_b32 s77, 0xffffff80
    s_mov_b32 s78, 0xffffff00
    s_mov_b32 s79, 0xfffff000
    s_mov_b32 s80, 0xfffffe00
    s_mov_b32 s81, 0xffffe000
    s_mov_b32 s82, 0xfffffc00
    s_mov_b32 s83, 0xffffc000
    s_mov_b32 s84, 0xfffff800
    s_mov_b32 s85, 0xffff8000
    s_waitcnt lgkmcnt(0)
    v_mfma_f32_32x32x16_bf16 v[96:111], v[22:25], v[240:243], 0
    ds_read_b128 v[22:25], v18 offset:2560
    s_mov_b32 s86, 0xffff0000
    s_mov_b32 s87, 0xfff00000
    s_mov_b32 s88, 0xfffe0000
    s_mov_b32 s89, 0xffe00000
    s_mov_b32 s90, 0xfffc0000
    s_mov_b32 s91, 0xffc00000
    s_mov_b32 s92, 0xfff80000
    s_mov_b32 s93, 0xff800000
    v_mfma_f32_32x32x16_bf16 v[96:111], v[26:29], v[10:13], v[96:111]
    ds_read_b128 v[26:29], v19 offset:2560
    s_mov_b32 s94, 0xff000000
    s_mov_b32 s95, 0xf0000000
    s_mov_b32 s96, 0xfe000000
    s_mov_b32 s97, 0xe0000000
    s_mov_b32 s98, 0xfc000000
    s_mov_b32 s99, 0xc0000000
    s_mov_b32 s100, 0xf8000000
    s_mov_b32 s101, 0x80000000
    v_mfma_f32_32x32x16_bf16 v[112:127], v[30:33], v[240:243], 0
    ds_read_b128 v[30:33], v18 offset:5120
    v_and_b32 v8, 3, v6
    v_bfe_u32 v9, v6, 2, 1
    v_lshl_add_u32 v8, v9, 3, v8
    v_bfe_u32 v9, v6, 3, 1
    v_lshl_add_u32 v8, v9, 2, v8
    v_add_u32 v9, 24, v8
    v_cmp_gt_u32 vcc, 16, v6
    s_nop 1
    v_cndmask_b32 v8, v6, v8, vcc
    v_mfma_f32_32x32x16_bf16 v[112:127], v[34:37], v[10:13], v[112:127]
    ds_read_b128 v[34:37], v19 offset:5120
    v_add_u32 v20, 4, v6
    v_cndmask_b32 v9, v20, v9, vcc
    s_add_u32 s47, s47, 30720
    v_mul_u32_u24 v20, 640, v7
    v_add_u32 v20, s47, v20
    v_lshl_add_u32 v8, v8, 4, v20
    v_lshl_add_u32 v9, v9, 4, v20
    s_add_u32 s48, s48, 16
    v_mov_b32 v20, s48
    v_cmp_gt_u32 vcc, 20, v6
    s_nop 1
    v_cndmask_b32 v62, v20, v8, vcc
    v_cndmask_b32 v63, v20, v9, vcc
    ds_read_b128 v[46:49], v62 offset:0
    ds_read_b128 v[50:53], v62 offset:1280
    ds_read_b128 v[38:41], v62 offset:20480
    ds_read_b128 v[42:45], v62 offset:21760
    v_cndmask_b32_e64 v112, v96, v112, s[70:71]
    v_cndmask_b32_e64 v113, v97, v113, s[72:73]
    v_cndmask_b32_e64 v114, v98, v114, s[74:75]
    v_cndmask_b32_e64 v115, v99, v115, s[76:77]
    v_cndmask_b32_e64 v116, v100, v116, s[78:79]
    v_cndmask_b32_e64 v117, v101, v117, s[80:81]
    v_cndmask_b32_e64 v118, v102, v118, s[82:83]
    v_cndmask_b32_e64 v119, v103, v119, s[84:85]
    v_cndmask_b32_e64 v120, v104, v120, s[86:87]
    v_cndmask_b32_e64 v121, v105, v121, s[88:89]
    v_cndmask_b32_e64 v122, v106, v122, s[90:91]
    v_cndmask_b32_e64 v123, v107, v123, s[92:93]
    v_cndmask_b32_e64 v124, v108, v124, s[94:95]
    v_cndmask_b32_e64 v125, v109, v125, s[96:97]
    v_cndmask_b32_e64 v126, v110, v126, s[98:99]
    v_cndmask_b32_e64 v127, v111, v127, s[100:101]
    v_mov_b32 v8, 0xffff
    v_cndmask_b32_e64 v54, 0, v8, s[70:71]
    v_cndmask_b32_e64 v54, v54, -1, s[72:73]
    v_cndmask_b32_e64 v55, 0, v8, s[74:75]
    v_cndmask_b32_e64 v55, v55, -1, s[76:77]
    v_cndmask_b32_e64 v56, 0, v8, s[78:79]
    v_cndmask_b32_e64 v56, v56, -1, s[80:81]
    v_cndmask_b32_e64 v57, 0, v8, s[82:83]
    v_cndmask_b32_e64 v57, v57, -1, s[84:85]
    v_cndmask_b32_e64 v58, 0, v8, s[86:87]
    v_cndmask_b32_e64 v58, v58, -1, s[88:89]
    v_cndmask_b32_e64 v59, 0, v8, s[90:91]
    v_cndmask_b32_e64 v59, v59, -1, s[92:93]
    v_cndmask_b32_e64 v60, 0, v8, s[94:95]
    v_cndmask_b32_e64 v60, v60, -1, s[96:97]
    v_cndmask_b32_e64 v61, 0, v8, s[98:99]
    v_cndmask_b32_e64 v61, v61, -1, s[100:101]
    v_exp_f32 v112, v112
    v_exp_f32 v113, v113
    v_exp_f32 v114, v114
    s_waitcnt lgkmcnt(0)
    v_mfma_f32_32x32x16_bf16 v[128:143], v[22:25], v[240:243], 0
    ds_read_b128 v[22:25], v18 offset:7680
    v_exp_f32 v115, v115
    v_exp_f32 v116, v116
    v_exp_f32 v117, v117
    v_exp_f32 v118, v118
    v_mfma_f32_32x32x16_bf16 v[128:143], v[26:29], v[10:13], v[128:143]
    ds_read_b128 v[26:29], v19 offset:7680
    v_exp_f32 v119, v119
    s_lshl_b32 s47, s39, 2
    s_add_u32 s47, s47, s36
    s_mul_i32 s53, s47, 151552
    s_mul_i32 s48, s40, 2560
    s_add_u32 s53, s53, s48
    s_add_u32 s53, s53, 7974912
    s_lshl_b32 s47, s47, 4
    s_add_u32 s47, s47, s40
    s_lshl_b32 s47, s47, 4
    s_add_u32 s54, s47, 20627456
    v_cvt_pk_bf16_f32 v112, v112, v113
    v_cvt_pk_bf16_f32 v113, v114, v115
    v_cvt_pk_bf16_f32 v114, v116, v117
    v_cvt_pk_bf16_f32 v115, v118, v119
    v_bfi_b32 v96, v54, 0, v112
    v_bfi_b32 v97, v55, 0, v113
    v_bfi_b32 v98, v56, 0, v114
    v_bfi_b32 v99, v57, 0, v115
    v_and_b32 v112, v54, v112
    v_and_b32 v113, v55, v113
    v_and_b32 v114, v56, v114
    v_and_b32 v115, v57, v115
    v_exp_f32 v120, v120
    v_exp_f32 v121, v121
    v_mfma_f32_32x32x16_bf16 v[64:79], v[46:49], v[96:99], 0
    v_exp_f32 v122, v122
    v_exp_f32 v123, v123
    v_exp_f32 v124, v124
    v_exp_f32 v125, v125
    v_mfma_f32_32x32x16_bf16 v[64:79], v[38:41], v[112:115], v[64:79]
    ds_read_b128 v[38:41], v62 offset:2560
    v_exp_f32 v126, v126
    v_exp_f32 v127, v127
    s_lshl_b32 s56, s37, 2
    s_add_u32 s56, s56, s36
    s_lshl_b32 s56, s56, 4
    s_add_u32 s56, s56, s38
    s_lshl_b32 s56, s56, 4
    s_add_u32 s56, s56, 20611072
    s_add_u32 s67, s65, 102400
    buffer_load_dwordx4 a[100:103], v21, s[16:19], s67 offen offset:0 sc1
    v_cvt_pk_bf16_f32 v116, v120, v121
    v_cvt_pk_bf16_f32 v117, v122, v123
    v_cvt_pk_bf16_f32 v118, v124, v125
    v_cvt_pk_bf16_f32 v119, v126, v127
    v_bfi_b32 v100, v58, 0, v116
    v_bfi_b32 v101, v59, 0, v117
    v_bfi_b32 v102, v60, 0, v118
    v_bfi_b32 v103, v61, 0, v119
    v_and_b32 v116, v58, v116
    v_and_b32 v117, v59, v117
    v_and_b32 v118, v60, v118
    v_and_b32 v119, v61, v119
    v_mfma_f32_32x32x16_bf16 v[64:79], v[50:53], v[100:103], v[64:79]
    buffer_load_dwordx4 a[104:107], v21, s[16:19], s67 offen offset:1024 sc1
    v_mfma_f32_32x32x16_bf16 v[64:79], v[42:45], v[116:119], v[64:79]
    ds_read_b128 v[42:45], v62 offset:3840
    v_exp_f32 v128, v128
    v_exp_f32 v129, v129
    v_exp_f32 v130, v130
    v_mfma_f32_32x32x16_bf16 v[144:159], v[30:33], v[240:243], 0
    ds_read_b128 v[30:33], v18 offset:10240
    v_exp_f32 v131, v131
    v_exp_f32 v132, v132
    v_exp_f32 v133, v133
    v_exp_f32 v134, v134
    v_mfma_f32_32x32x16_bf16 v[144:159], v[34:37], v[10:13], v[144:159]
    ds_read_b128 v[34:37], v19 offset:10240
    v_exp_f32 v135, v135
    s_getreg_b32 s49, hwreg(HW_REG_IB_STS, 30, 2)
    s_getreg_b32 s50, hwreg(HW_REG_IB_STS, 0, 4)
    s_mov_b32 s3, 0
    s_lshl4_add_u32 s49, s49, s50
    s_cmp_le_u32 s49, 1
    s_cbranch_scc0 L_tf11
    buffer_store_dword v253, v252, s[16:19], s56 offen sc1
    s_mov_b32 s3, 0x100
L_tf11:
    buffer_load_dwordx4 a[108:111], v21, s[16:19], s67 offen offset:2048 sc1
    buffer_load_dwordx4 a[112:115], v21, s[16:19], s67 offen offset:3072 sc1
    v_cvt_pk_bf16_f32 v128, v128, v129
    v_cvt_pk_bf16_f32 v129, v130, v131
    v_cvt_pk_bf16_f32 v130, v132, v133
    v_cvt_pk_bf16_f32 v131, v134, v135
    v_exp_f32 v136, v136
    v_exp_f32 v137, v137
    v_exp_f32 v138, v138
    s_waitcnt lgkmcnt(0)
    v_mfma_f32_32x32x16_bf16 v[64:79], v[38:41], v[128:131], v[64:79]
    ds_read_b128 v[38:41], v62 offset:5120
    v_exp_f32 v139, v139
    v_exp_f32 v140, v140
    v_exp_f32 v141, v141
    v_exp_f32 v142, v142
    v_exp_f32 v143, v143
    v_cvt_pk_bf16_f32 v132, v136, v137
    v_cvt_pk_bf16_f32 v133, v138, v139
    v_cvt_pk_bf16_f32 v134, v140, v141
    v_cvt_pk_bf16_f32 v135, v142, v143
    s_add_u32 s67, s67, 4096
    buffer_load_dwordx4 a[116:119], v21, s[16:19], s67 offen offset:0 sc1
    v_mfma_f32_32x32x16_bf16 v[64:79], v[42:45], v[132:135], v[64:79]
    ds_read_b128 v[42:45], v62 offset:6400
    v_exp_f32 v144, v144
    v_exp_f32 v145, v145
    v_exp_f32 v146, v146
    v_mfma_f32_32x32x16_bf16 v[96:111], v[22:25], v[240:243], 0
    ds_read_b128 v[22:25], v18 offset:12800
    v_exp_f32 v147, v147
    v_exp_f32 v148, v148
    v_exp_f32 v149, v149
    v_exp_f32 v150, v150
    v_mfma_f32_32x32x16_bf16 v[96:111], v[26:29], v[10:13], v[96:111]
    ds_read_b128 v[26:29], v19 offset:12800
    v_exp_f32 v151, v151
    s_getreg_b32 s49, hwreg(HW_REG_IB_STS, 30, 2)
    s_getreg_b32 s50, hwreg(HW_REG_IB_STS, 0, 4)
    s_lshl4_add_u32 s49, s49, s50
    s_or_b32 s49, s49, s3
    s_cmp_le_u32 s49, 4
    s_cbranch_scc0 L_tf12
    buffer_store_dword v253, v252, s[16:19], s56 offen sc1
    s_mov_b32 s3, 0x100
L_tf12:
    s_add_u32 s67, s65, 122880
    buffer_load_dwordx4 a[120:123], v21, s[16:19], s67 offen offset:0 sc1
    v_cvt_pk_bf16_f32 v144, v144, v145
    v_cvt_pk_bf16_f32 v145, v146, v147
    v_cvt_pk_bf16_f32 v146, v148, v149
    v_cvt_pk_bf16_f32 v147, v150, v151
    v_exp_f32 v152, v152
    v_exp_f32 v153, v153
    v_exp_f32 v154, v154
    s_waitcnt lgkmcnt(0)
    v_mfma_f32_32x32x16_bf16 v[64:79], v[38:41], v[144:147], v[64:79]
    ds_read_b128 v[38:41], v62 offset:7680
    v_exp_f32 v155, v155
    v_exp_f32 v156, v156
    v_exp_f32 v157, v157
    v_exp_f32 v158, v158
    v_exp_f32 v159, v159
    v_cvt_pk_bf16_f32 v148, v152, v153
    v_cvt_pk_bf16_f32 v149, v154, v155
    v_cvt_pk_bf16_f32 v150, v156, v157
    v_cvt_pk_bf16_f32 v151, v158, v159
    buffer_load_dwordx4 a[124:127], v21, s[16:19], s67 offen offset:1024 sc1
    s_nop 0
    v_mfma_f32_32x32x16_bf16 v[64:79], v[42:45], v[148:151], v[64:79]
    ds_read_b128 v[42:45], v62 offset:8960
    v_exp_f32 v96, v96
    v_exp_f32 v97, v97
    v_exp_f32 v98, v98
    v_mfma_f32_32x32x16_bf16 v[112:127], v[30:33], v[240:243], 0
    ds_read_b128 v[30:33], v18 offset:15360
    v_exp_f32 v99, v99
    v_exp_f32 v100, v100
    v_exp_f32 v101, v101
    v_exp_f32 v102, v102
    v_mfma_f32_32x32x16_bf16 v[112:127], v[34:37], v[10:13], v[112:127]
    ds_read_b128 v[34:37], v19 offset:15360
    v_exp_f32 v103, v103
    s_getreg_b32 s49, hwreg(HW_REG_IB_STS, 30, 2)
    s_getreg_b32 s50, hwreg(HW_REG_IB_STS, 0, 4)
    s_lshl4_add_u32 s49, s49, s50
    s_or_b32 s49, s49, s3
    s_cmp_le_u32 s49, 6
    s_cbranch_scc0 L_tf13
    buffer_store_dword v253, v252, s[16:19], s56 offen sc1
    s_mov_b32 s3, 0x100
L_tf13:
    buffer_load_dwordx4 a[128:131], v21, s[16:19], s67 offen offset:2048 sc1
    buffer_load_dwordx4 a[132:135], v21, s[16:19], s67 offen offset:3072 sc1
    v_add_u32 v6, 20661248, v21
    buffer_load_dword v7, v6, s[16:19], 0 offen sc1
    v_cvt_pk_bf16_f32 v96, v96, v97
    v_cvt_pk_bf16_f32 v97, v98, v99
    v_cvt_pk_bf16_f32 v98, v100, v101
    v_cvt_pk_bf16_f32 v99, v102, v103
    v_exp_f32 v104, v104
    v_exp_f32 v105, v105
    v_exp_f32 v106, v106
    s_waitcnt lgkmcnt(0)
    v_mfma_f32_32x32x16_bf16 v[64:79], v[38:41], v[96:99], v[64:79]
    ds_read_b128 v[38:41], v62 offset:10240
    v_exp_f32 v107, v107
    v_exp_f32 v108, v108
    v_exp_f32 v109, v109
    v_exp_f32 v110, v110
    v_exp_f32 v111, v111
    v_cvt_pk_bf16_f32 v100, v104, v105
    v_cvt_pk_bf16_f32 v101, v106, v107
    v_cvt_pk_bf16_f32 v102, v108, v109
    v_cvt_pk_bf16_f32 v103, v110, v111
    s_add_u32 s67, s67, 4096
    buffer_load_dwordx4 a[136:139], v21, s[16:19], s67 offen offset:0 sc1
    v_mfma_f32_32x32x16_bf16 v[64:79], v[42:45], v[100:103], v[64:79]
    ds_read_b128 v[42:45], v62 offset:11520
    v_exp_f32 v112, v112
    v_exp_f32 v113, v113
    v_exp_f32 v114, v114
    v_mfma_f32_32x32x16_bf16 v[128:143], v[22:25], v[240:243], 0
    ds_read_b128 v[22:25], v18 offset:17920
    v_exp_f32 v115, v115
    v_exp_f32 v116, v116
    v_exp_f32 v117, v117
    v_exp_f32 v118, v118
    v_mfma_f32_32x32x16_bf16 v[128:143], v[26:29], v[10:13], v[128:143]
    ds_read_b128 v[26:29], v19 offset:17920
    v_exp_f32 v119, v119
    s_cmp_lg_u32 s3, 0
    s_cbranch_scc1 L_tf14
    s_waitcnt vmcnt(11)
    buffer_store_dword v253, v252, s[16:19], s56 offen sc1
    s_mov_b32 s3, 0x100
L_tf14:
    s_add_u32 s67, s65, 143360
    buffer_load_dwordx4 a[140:143], v21, s[16:19], s67 offen offset:0 sc1
    v_cvt_pk_bf16_f32 v112, v112, v113
    v_cvt_pk_bf16_f32 v113, v114, v115
    v_cvt_pk_bf16_f32 v114, v116, v117
    v_cvt_pk_bf16_f32 v115, v118, v119
    v_exp_f32 v120, v120
    v_exp_f32 v121, v121
    v_exp_f32 v122, v122
    s_waitcnt lgkmcnt(1)
    v_mfma_f32_32x32x16_bf16 v[64:79], v[38:41], v[112:115], v[64:79]
    ds_read_b128 v[38:41], v62 offset:12800
    v_exp_f32 v123, v123
    v_exp_f32 v124, v124
    v_exp_f32 v125, v125
    v_exp_f32 v126, v126
    v_exp_f32 v127, v127
    v_cvt_pk_bf16_f32 v116, v120, v121
    v_cvt_pk_bf16_f32 v117, v122, v123
    v_cvt_pk_bf16_f32 v118, v124, v125
    v_cvt_pk_bf16_f32 v119, v126, v127
    buffer_load_dwordx4 a[144:147], v21, s[16:19], s67 offen offset:1024 sc1
    s_nop 0
    v_mfma_f32_32x32x16_bf16 v[64:79], v[42:45], v[116:119], v[64:79]
    ds_read_b128 v[42:45], v62 offset:14080
    v_exp_f32 v128, v128
    v_exp_f32 v129, v129
    v_exp_f32 v130, v130
    v_mfma_f32_32x32x16_bf16 v[144:159], v[30:33], v[240:243], 0
    ds_read_b128 v[30:33], v18 offset:1536
    v_exp_f32 v131, v131
    v_exp_f32 v132, v132
    v_exp_f32 v133, v133
    v_exp_f32 v134, v134
    v_mfma_f32_32x32x16_bf16 v[144:159], v[34:37], v[10:13], v[144:159]
    ds_read_b128 v[34:37], v19 offset:0
    v_exp_f32 v135, v135
    buffer_load_dwordx4 a[148:151], v21, s[16:19], s67 offen offset:2048 sc1
    buffer_load_dwordx4 a[152:155], v21, s[16:19], s67 offen offset:3072 sc1
    v_cvt_pk_bf16_f32 v128, v128, v129
    v_cvt_pk_bf16_f32 v129, v130, v131
    v_cvt_pk_bf16_f32 v130, v132, v133
    v_cvt_pk_bf16_f32 v131, v134, v135
    v_exp_f32 v136, v136
    v_exp_f32 v137, v137
    v_exp_f32 v138, v138
    s_waitcnt lgkmcnt(1)
    v_mfma_f32_32x32x16_bf16 v[64:79], v[38:41], v[128:131], v[64:79]
    ds_read_b128 v[38:41], v62 offset:15360
    v_exp_f32 v139, v139
    v_exp_f32 v140, v140
    v_exp_f32 v141, v141
    v_exp_f32 v142, v142
    v_exp_f32 v143, v143
    v_cvt_pk_bf16_f32 v132, v136, v137
    v_cvt_pk_bf16_f32 v133, v138, v139
    v_cvt_pk_bf16_f32 v134, v140, v141
    v_cvt_pk_bf16_f32 v135, v142, v143
    s_add_u32 s67, s67, 4096
    buffer_load_dwordx4 a[156:159], v21, s[16:19], s67 offen offset:0 sc1
    v_mfma_f32_32x32x16_bf16 v[64:79], v[42:45], v[132:135], v[64:79]
    ds_read_b128 v[42:45], v62 offset:16640
    v_exp_f32 v144, v144
    v_exp_f32 v145, v145
    v_exp_f32 v146, v146
    v_mfma_f32_32x32x16_bf16 v[96:111], v[22:25], v[240:243], 0
    ds_read_b128 v[22:25], v18 offset:22016
    v_exp_f32 v147, v147
    v_exp_f32 v148, v148
    v_exp_f32 v149, v149
    v_exp_f32 v150, v150
    v_mfma_f32_32x32x16_bf16 v[96:111], v[26:29], v[10:13], v[96:111]
    ds_read_b128 v[26:29], v19 offset:20480
    v_exp_f32 v151, v151
    s_waitcnt vmcnt(6)
    v_cmp_ne_u32 vcc, 0, v7
    s_nop 0
    s_cmp_eq_u64 vcc, -1
    s_cbranch_scc0 L_spin14
L_back14:
    v_cvt_pk_bf16_f32 v144, v144, v145
    v_cvt_pk_bf16_f32 v145, v146, v147
    v_cvt_pk_bf16_f32 v146, v148, v149
    v_cvt_pk_bf16_f32 v147, v150, v151
    v_exp_f32 v152, v152
    v_exp_f32 v153, v153
    v_exp_f32 v154, v154
    s_waitcnt lgkmcnt(1)
    v_mfma_f32_32x32x16_bf16 v[64:79], v[38:41], v[144:147], v[64:79]
    ds_read_b128 v[38:41], v62 offset:17920
    v_exp_f32 v155, v155
    v_exp_f32 v156, v156
    s_lshl_b32 s67, s51, 2
    s_add_u32 m0, s67, 0
    s_add_u32 s67, s65, 163840
    buffer_load_dwordx4 v21, s[16:19], s67 offen offset:0 sc1 lds
    v_exp_f32 v157, v157
    v_exp_f32 v158, v158
    v_exp_f32 v159, v159
    v_cvt_pk_bf16_f32 v148, v152, v153
    v_cvt_pk_bf16_f32 v149, v154, v155
    v_cvt_pk_bf16_f32 v150, v156, v157
    v_cvt_pk_bf16_f32 v151, v158, v159
    buffer_load_dwordx4 v21, s[16:19], s67 offen offset:1024 sc1 lds
    s_nop 0
    v_mfma_f32_32x32x16_bf16 v[64:79], v[42:45], v[148:151], v[64:79]
    ds_read_b128 v[42:45], v62 offset:19200
    v_exp_f32 v96, v96
    v_exp_f32 v97, v97
    v_exp_f32 v98, v98
    v_mfma_f32_32x32x16_bf16 v[112:127], v[30:33], v[244:247], 0
    ds_read_b128 v[30:33], v18 offset:4096
    v_exp_f32 v99, v99
    v_exp_f32 v100, v100
    v_exp_f32 v101, v101
    v_exp_f32 v102, v102
    v_mfma_f32_32x32x16_bf16 v[112:127], v[34:37], v[14:17], v[112:127]
    ds_read_b128 v[34:37], v19 offset:2560
    v_exp_f32 v103, v103
    v_cvt_pk_bf16_f32 v96, v96, v97
    v_cvt_pk_bf16_f32 v97, v98, v99
    v_cvt_pk_bf16_f32 v98, v100, v101
    v_cvt_pk_bf16_f32 v99, v102, v103
    v_exp_f32 v104, v104
    v_mfma_f32_32x32x16_bf16 v[128:143], v[22:25], v[244:247], 0
    ds_read_b128 v[22:25], v18 offset:6656
    v_exp_f32 v105, v105
    v_exp_f32 v106, v106
    v_exp_f32 v107, v107
    v_exp_f32 v108, v108
    s_waitcnt lgkmcnt(2)
    v_mfma_f32_32x32x16_bf16 v[128:143], v[26:29], v[14:17], v[128:143]
    ds_read_b128 v[26:29], v19 offset:5120
    v_exp_f32 v109, v109
    v_exp_f32 v110, v110
    v_exp_f32 v111, v111
    buffer_load_dwordx4 v21, s[16:19], s67 offen offset:2048 sc1 lds
    buffer_load_dwordx4 v21, s[16:19], s67 offen offset:3072 sc1 lds
    v_lshrrev_b32 v5, 4, v0
    v_and_b32 v4, 15, v0
    v_lshlrev_b32 v4, 4, v4
    v_lshl_add_u32 v5, v5, 9, v4
    v_mfma_f32_32x32x16_bf16 v[64:79], v[38:41], v[96:99], v[64:79]
    ds_read_b128 v[38:41], v63 offset:20480
    v_cvt_pk_bf16_f32 v100, v104, v105
    v_cvt_pk_bf16_f32 v101, v106, v107
    v_cvt_pk_bf16_f32 v102, v108, v109
    v_cvt_pk_bf16_f32 v103, v110, v111
    s_add_u32 m0, m0, 4096
    s_add_u32 s67, s67, 4096
    buffer_load_dwordx4 v21, s[16:19], s67 offen offset:0 sc1 lds
    s_lshl_b32 s47, s43, 8
    s_mul_i32 s48, s44, 151552
    s_add_u32 s45, s47, s48
    v_add_u32 v1, s45, v5
    s_xor_b32 s47, s47, 0x100
    s_add_u32 s45, s47, s48
    v_add_u32 v2, s45, v5
    s_sub_u32 s48, 151552, s48
    s_add_u32 s45, s47, s48
    v_add_u32 v4, s45, v5
    s_xor_b32 s47, s47, 0x100
    s_add_u32 s45, s47, s48
    v_add_u32 v3, s45, v5
    ds_read_b128 v[46:49], v63 offset:0
    ds_read_b128 v[50:53], v63 offset:1280
    v_mfma_f32_32x32x16_bf16 v[64:79], v[42:45], v[100:103], v[64:79]
    ds_read_b128 v[42:45], v63 offset:21760
    s_lshl_b32 s67, s51, 2
    s_add_u32 m0, s67, 5120
    s_add_u32 s67, s65, 184320
    buffer_load_dwordx4 v21, s[16:19], s67 offen offset:0 sc1 lds
    s_mul_i32 s66, s41, 303104
    s_lshl_b32 s47, s36, 11
    s_add_u32 s66, s66, s47
    s_add_u32 s66, s66, 7864320
    v_cndmask_b32_e64 v128, v112, v128, s[70:71]
    v_cndmask_b32_e64 v129, v113, v129, s[72:73]
    v_cndmask_b32_e64 v130, v114, v130, s[74:75]
    v_cndmask_b32_e64 v131, v115, v131, s[76:77]
    v_cndmask_b32_e64 v132, v116, v132, s[78:79]
    v_cndmask_b32_e64 v133, v117, v133, s[80:81]
    v_cndmask_b32_e64 v134, v118, v134, s[82:83]
    v_cndmask_b32_e64 v135, v119, v135, s[84:85]
    v_cndmask_b32_e64 v136, v120, v136, s[86:87]
    v_cndmask_b32_e64 v137, v121, v137, s[88:89]
    v_cndmask_b32_e64 v138, v122, v138, s[90:91]
    v_cndmask_b32_e64 v139, v123, v139, s[92:93]
    v_cndmask_b32_e64 v140, v124, v140, s[94:95]
    v_cndmask_b32_e64 v141, v125, v141, s[96:97]
    v_cndmask_b32_e64 v142, v126, v142, s[98:99]
    v_cndmask_b32_e64 v143, v127, v143, s[100:101]
    v_exp_f32 v128, v128
    v_exp_f32 v129, v129
    v_exp_f32 v130, v130
    v_mfma_f32_32x32x16_bf16 v[144:159], v[30:33], v[244:247], 0
    ds_read_b128 v[30:33], v18 offset:9216
    v_exp_f32 v131, v131
    v_exp_f32 v132, v132
    v_exp_f32 v133, v133
    v_exp_f32 v134, v134
    s_waitcnt lgkmcnt(1)
    v_mfma_f32_32x32x16_bf16 v[144:159], v[34:37], v[14:17], v[144:159]
    ds_read_b128 v[34:37], v19 offset:7680
    v_exp_f32 v135, v135
    buffer_load_dwordx4 v21, s[16:19], s67 offen offset:1024 sc1 lds
    s_lshl_b32 s47, s41, 9
    s_add_u32 s47, s47, 20611072
    v_and_b32 v8, 0x1ff, v21
    v_add_u32 v8, s47, v8
    s_mov_b32 s62, 0x80008000
    s_mov_b32 s63, 0x80008000
    buffer_load_dword v7, v8, s[16:19], 0 offen sc1
    v_cvt_pk_bf16_f32 v128, v128, v129
    v_cvt_pk_bf16_f32 v129, v130, v131
    v_cvt_pk_bf16_f32 v130, v132, v133
    v_cvt_pk_bf16_f32 v131, v134, v135
    v_bfi_b32 v112, v54, 0, v128
    v_bfi_b32 v113, v55, 0, v129
    v_bfi_b32 v114, v56, 0, v130
    v_bfi_b32 v115, v57, 0, v131
    v_and_b32 v128, v54, v128
    v_and_b32 v129, v55, v129
    v_and_b32 v130, v56, v130
    v_and_b32 v131, v57, v131
    v_exp_f32 v136, v136
    v_exp_f32 v137, v137
    v_mfma_f32_32x32x16_bf16 v[80:95], v[46:49], v[112:115], 0
    v_exp_f32 v138, v138
    v_exp_f32 v139, v139
    v_exp_f32 v140, v140
    v_exp_f32 v141, v141
    v_mfma_f32_32x32x16_bf16 v[80:95], v[38:41], v[128:131], v[80:95]
    ds_read_b128 v[38:41], v63 offset:2560
    v_exp_f32 v142, v142
    v_exp_f32 v143, v143
    buffer_load_dwordx4 v21, s[16:19], s67 offen offset:2048 sc1 lds
    buffer_load_dwordx4 v21, s[16:19], s67 offen offset:3072 sc1 lds
    v_cvt_pk_bf16_f32 v132, v136, v137
    v_cvt_pk_bf16_f32 v133, v138, v139
    v_cvt_pk_bf16_f32 v134, v140, v141
    v_cvt_pk_bf16_f32 v135, v142, v143
    v_bfi_b32 v116, v58, 0, v132
    v_bfi_b32 v117, v59, 0, v133
    v_bfi_b32 v118, v60, 0, v134
    v_bfi_b32 v119, v61, 0, v135
    v_and_b32 v132, v58, v132
    v_and_b32 v133, v59, v133
    s_add_u32 m0, m0, 4096
    s_add_u32 s67, s67, 4096
    buffer_load_dwordx4 v21, s[16:19], s67 offen offset:0 sc1 lds
    v_and_b32 v134, v60, v134
    v_and_b32 v135, v61, v135
    v_mfma_f32_32x32x16_bf16 v[80:95], v[50:53], v[116:119], v[80:95]
    s_lshl_b32 s67, s51, 2
    s_add_u32 m0, s67, 10240
    s_add_u32 s67, s65, 204800
    buffer_load_dwordx4 v21, s[16:19], s67 offen offset:0 sc1 lds
    v_mfma_f32_32x32x16_bf16 v[80:95], v[42:45], v[132:135], v[80:95]
    ds_read_b128 v[42:45], v63 offset:3840
    v_exp_f32 v144, v144
    v_exp_f32 v145, v145
    v_exp_f32 v146, v146
    v_mfma_f32_32x32x16_bf16 v[96:111], v[22:25], v[244:247], 0
    ds_read_b128 v[22:25], v18 offset:11776
    v_exp_f32 v147, v147
    v_exp_f32 v148, v148
    v_exp_f32 v149, v149
    v_exp_f32 v150, v150
    v_mfma_f32_32x32x16_bf16 v[96:111], v[26:29], v[14:17], v[96:111]
    ds_read_b128 v[26:29], v19 offset:10240
    v_exp_f32 v151, v151
    buffer_load_dwordx4 v21, s[16:19], s67 offen offset:1024 sc1 lds
    v_cvt_pk_bf16_f32 v144, v144, v145
    v_cvt_pk_bf16_f32 v145, v146, v147
    v_cvt_pk_bf16_f32 v146, v148, v149
    v_cvt_pk_bf16_f32 v147, v150, v151
    v_exp_f32 v152, v152
    v_exp_f32 v153, v153
    v_exp_f32 v154, v154
    s_waitcnt lgkmcnt(1)
    v_mfma_f32_32x32x16_bf16 v[80:95], v[38:41], v[144:147], v[80:95]
    ds_read_b128 v[38:41], v63 offset:5120
    v_exp_f32 v155, v155
    v_exp_f32 v156, v156
    buffer_load_dwordx4 v21, s[16:19], s67 offen offset:2048 sc1 lds
    buffer_load_dwordx4 v21, s[16:19], s67 offen offset:3072 sc1 lds
    v_exp_f32 v157, v157
    v_exp_f32 v158, v158
    v_exp_f32 v159, v159
    v_cvt_pk_bf16_f32 v148, v152, v153
    v_cvt_pk_bf16_f32 v149, v154, v155
    v_cvt_pk_bf16_f32 v150, v156, v157
    v_cvt_pk_bf16_f32 v151, v158, v159
    s_add_u32 m0, m0, 4096
    s_add_u32 s67, s67, 4096
    buffer_load_dwordx4 v21, s[16:19], s67 offen offset:0 sc1 lds
    v_mfma_f32_32x32x16_bf16 v[80:95], v[42:45], v[148:151], v[80:95]
    ds_read_b128 v[42:45], v63 offset:6400
    v_exp_f32 v96, v96
    v_exp_f32 v97, v97
    v_exp_f32 v98, v98
    v_mfma_f32_32x32x16_bf16 v[112:127], v[30:33], v[244:247], 0
    ds_read_b128 v[30:33], v18 offset:14336
    v_exp_f32 v99, v99
    v_exp_f32 v100, v100
    v_exp_f32 v101, v101
    v_exp_f32 v102, v102
    v_mfma_f32_32x32x16_bf16 v[112:127], v[34:37], v[14:17], v[112:127]
    ds_read_b128 v[34:37], v19 offset:12800
    v_exp_f32 v103, v103
    s_waitcnt vmcnt(8)
    v_cmp_ne_u32 vcc, 0, v7
    s_nop 0
    s_or_b64 vcc, vcc, s[62:63]
    s_cmp_eq_u64 vcc, -1
    s_cbranch_scc0 L_spin15
L_back15:
    v_cvt_pk_bf16_f32 v96, v96, v97
    v_cvt_pk_bf16_f32 v97, v98, v99
    v_cvt_pk_bf16_f32 v98, v100, v101
    v_cvt_pk_bf16_f32 v99, v102, v103
    v_exp_f32 v104, v104
    v_exp_f32 v105, v105
    v_exp_f32 v106, v106
    s_waitcnt lgkmcnt(1)
    v_mfma_f32_32x32x16_bf16 v[80:95], v[38:41], v[96:99], v[80:95]
    ds_read_b128 v[38:41], v63 offset:7680
    v_exp_f32 v107, v107
    v_exp_f32 v108, v108
    v_add_f32_e64 v9, abs(v64), abs(v65)
    v_add_f32_e64 v20, abs(v66), abs(v67)
    v_add_f32_e64 v9, v9, abs(v68)
    s_add_u32 s61, s66, 0
    buffer_load_dwordx4 a[164:167], v2, s[16:19], s61 offen sc1
    v_exp_f32 v109, v109
    v_exp_f32 v110, v110
    v_exp_f32 v111, v111
    v_cvt_pk_bf16_f32 v100, v104, v105
    v_cvt_pk_bf16_f32 v101, v106, v107
    v_cvt_pk_bf16_f32 v102, v108, v109
    v_cvt_pk_bf16_f32 v103, v110, v111
    v_add_f32_e64 v20, v20, abs(v69)
    v_cmp_lt_f32 vcc, 0x30800000, v76
    s_nop 0
    s_and_b64 s[58:59], exec, vcc
    buffer_load_dwordx4 a[168:171], v3, s[16:19], s61 offen sc1
    buffer_load_dwordx4 a[172:175], v4, s[16:19], s61 offen sc1
    v_mfma_f32_32x32x16_bf16 v[80:95], v[42:45], v[100:103], v[80:95]
    ds_read_b128 v[42:45], v63 offset:8960
    v_exp_f32 v112, v112
    v_exp_f32 v113, v113
    v_exp_f32 v114, v114
    v_mfma_f32_32x32x16_bf16 v[128:143], v[22:25], v[244:247], 0
    ds_read_b128 v[22:25], v18 offset:16896
    v_exp_f32 v115, v115
    v_exp_f32 v116, v116
    v_exp_f32 v117, v117
    v_exp_f32 v118, v118
    v_mfma_f32_32x32x16_bf16 v[128:143], v[26:29], v[14:17], v[128:143]
    ds_read_b128 v[26:29], v19 offset:15360
    v_exp_f32 v119, v119
    v_add_f32_e64 v9, v9, abs(v70)
    v_add_f32_e64 v20, v20, abs(v71)
    buffer_load_dwordx4 a[160:163], v1, s[16:19], s61 offen sc1
    v_cvt_pk_bf16_f32 v112, v112, v113
    v_cvt_pk_bf16_f32 v113, v114, v115
    v_cvt_pk_bf16_f32 v114, v116, v117
    v_cvt_pk_bf16_f32 v115, v118, v119
    v_exp_f32 v120, v120
    v_exp_f32 v121, v121
    v_exp_f32 v122, v122
    s_waitcnt lgkmcnt(1)
    v_mfma_f32_32x32x16_bf16 v[80:95], v[38:41], v[112:115], v[80:95]
    ds_read_b128 v[38:41], v63 offset:10240
    v_exp_f32 v123, v123
    v_exp_f32 v124, v124
    v_add_f32_e64 v9, v9, abs(v72)
    v_add_f32_e64 v20, v20, abs(v73)
    v_add_f32_e64 v9, v9, abs(v74)
    s_add_u32 s61, s66, 8192
    buffer_load_dwordx4 a[180:183], v2, s[16:19], s61 offen sc1
    v_exp_f32 v125, v125
    v_exp_f32 v126, v126
    v_exp_f32 v127, v127
    v_cvt_pk_bf16_f32 v116, v120, v121
    v_cvt_pk_bf16_f32 v117, v122, v123
    v_cvt_pk_bf16_f32 v118, v124, v125
    v_cvt_pk_bf16_f32 v119, v126, v127
    v_add_f32_e64 v20, v20, abs(v75)
    v_fmamk_f32 v9, v76, 0x61000000, v9
    buffer_load_dwordx4 a[184:187], v3, s[16:19], s61 offen sc1
    buffer_load_dwordx4 a[188:191], v4, s[16:19], s61 offen sc1
    v_mfma_f32_32x32x16_bf16 v[80:95], v[42:45], v[116:119], v[80:95]
    ds_read_b128 v[42:45], v63 offset:11520
    v_exp_f32 v128, v128
    v_exp_f32 v129, v129
    v_exp_f32 v130, v130
    v_mfma_f32_32x32x16_bf16 v[144:159], v[30:33], v[244:247], 0
    ds_read_b128 v[30:33], v18 offset:19456
    v_exp_f32 v131, v131
    v_exp_f32 v132, v132
    v_exp_f32 v133, v133
    v_exp_f32 v134, v134
    v_mfma_f32_32x32x16_bf16 v[144:159], v[34:37], v[14:17], v[144:159]
    ds_read_b128 v[34:37], v19 offset:17920
    v_exp_f32 v135, v135
    v_add_f32 v9, v9, v20
    v_cmp_gt_f32 vcc, 0x7f800000, v9
    s_nop 0
    s_and_b64 s[58:59], s[58:59], vcc
    buffer_load_dwordx4 a[176:179], v1, s[16:19], s61 offen sc1
    v_cvt_pk_bf16_f32 v128, v128, v129
    v_cvt_pk_bf16_f32 v129, v130, v131
    v_cvt_pk_bf16_f32 v130, v132, v133
    v_cvt_pk_bf16_f32 v131, v134, v135
    v_exp_f32 v136, v136
    v_exp_f32 v137, v137
    v_exp_f32 v138, v138
    s_waitcnt lgkmcnt(1)
    v_mfma_f32_32x32x16_bf16 v[80:95], v[38:41], v[128:131], v[80:95]
    ds_read_b128 v[38:41], v63 offset:12800
    v_exp_f32 v139, v139
    v_exp_f32 v140, v140
    s_add_u32 s61, s66, 16384
    buffer_load_dwordx4 a[196:199], v2, s[16:19], s61 offen sc1
    v_exp_f32 v141, v141
    v_exp_f32 v142, v142
    v_exp_f32 v143, v143
    v_cvt_pk_bf16_f32 v132, v136, v137
    v_cvt_pk_bf16_f32 v133, v138, v139
    v_cvt_pk_bf16_f32 v134, v140, v141
    v_cvt_pk_bf16_f32 v135, v142, v143
    buffer_load_dwordx4 a[200:203], v3, s[16:19], s61 offen sc1
    buffer_load_dwordx4 a[204:207], v4, s[16:19], s61 offen sc1
    v_mfma_f32_32x32x16_bf16 v[80:95], v[42:45], v[132:135], v[80:95]
    ds_read_b128 v[42:45], v63 offset:14080
    v_exp_f32 v144, v144
    v_exp_f32 v145, v145
    v_exp_f32 v146, v146
    v_mfma_f32_32x32x16_bf16 v[96:111], v[22:25], v[244:247], 0
    v_exp_f32 v147, v147
    v_exp_f32 v148, v148
    v_exp_f32 v149, v149
    v_exp_f32 v150, v150
    v_mfma_f32_32x32x16_bf16 v[96:111], v[26:29], v[14:17], v[96:111]
    v_exp_f32 v151, v151
    buffer_load_dwordx4 a[192:195], v1, s[16:19], s61 offen sc1
    v_cvt_pk_bf16_f32 v144, v144, v145
    v_cvt_pk_bf16_f32 v145, v146, v147
    v_cvt_pk_bf16_f32 v146, v148, v149
    v_cvt_pk_bf16_f32 v147, v150, v151
    v_exp_f32 v152, v152
    v_exp_f32 v153, v153
    v_exp_f32 v154, v154
    s_waitcnt lgkmcnt(0)
    v_mfma_f32_32x32x16_bf16 v[80:95], v[38:41], v[144:147], v[80:95]
    ds_read_b128 v[38:41], v63 offset:15360
    v_exp_f32 v155, v155
    v_exp_f32 v156, v156
    s_add_u32 s61, s66, 24576
    buffer_load_dwordx4 a[212:215], v2, s[16:19], s61 offen sc1
    buffer_load_dwordx4 a[216:219], v3, s[16:19], s61 offen sc1
    v_exp_f32 v157, v157
    v_exp_f32 v158, v158
    v_exp_f32 v159, v159
    v_cvt_pk_bf16_f32 v148, v152, v153
    v_cvt_pk_bf16_f32 v149, v154, v155
    v_cvt_pk_bf16_f32 v150, v156, v157
    v_cvt_pk_bf16_f32 v151, v158, v159
    buffer_load_dwordx4 a[220:223], v4, s[16:19], s61 offen sc1
    s_nop 0
    v_mfma_f32_32x32x16_bf16 v[80:95], v[42:45], v[148:151], v[80:95]
    ds_read_b128 v[42:45], v63 offset:16640
    v_exp_f32 v96, v96
    v_exp_f32 v97, v97
    v_exp_f32 v98, v98
    v_mfma_f32_32x32x16_bf16 v[112:127], v[30:33], v[244:247], 0
    v_exp_f32 v99, v99
    v_exp_f32 v100, v100
    v_exp_f32 v101, v101
    v_exp_f32 v102, v102
    v_mfma_f32_32x32x16_bf16 v[112:127], v[34:37], v[14:17], v[112:127]
    v_exp_f32 v103, v103
    buffer_load_dwordx4 a[208:211], v1, s[16:19], s61 offen sc1
    s_add_u32 s61, s66, 32768
    buffer_load_dwordx4 a[228:231], v2, s[16:19], s61 offen sc1
    v_cvt_pk_bf16_f32 v96, v96, v97
    v_cvt_pk_bf16_f32 v97, v98, v99
    v_cvt_pk_bf16_f32 v98, v100, v101
    v_cvt_pk_bf16_f32 v99, v102, v103
    v_exp_f32 v104, v104
    v_exp_f32 v105, v105
    v_exp_f32 v106, v106
    s_waitcnt lgkmcnt(0)
    v_mfma_f32_32x32x16_bf16 v[80:95], v[38:41], v[96:99], v[80:95]
    ds_read_b128 v[38:41], v63 offset:17920
    v_exp_f32 v107, v107
    v_exp_f32 v108, v108
    buffer_load_dwordx4 a[232:235], v3, s[16:19], s61 offen sc1
    v_exp_f32 v109, v109
    v_exp_f32 v110, v110
    v_exp_f32 v111, v111
    v_cvt_pk_bf16_f32 v100, v104, v105
    v_cvt_pk_bf16_f32 v101, v106, v107
    v_cvt_pk_bf16_f32 v102, v108, v109
    v_cvt_pk_bf16_f32 v103, v110, v111
    buffer_load_dwordx4 a[236:239], v4, s[16:19], s61 offen sc1
    buffer_load_dwordx4 a[224:227], v1, s[16:19], s61 offen sc1
    v_mfma_f32_32x32x16_bf16 v[80:95], v[42:45], v[100:103], v[80:95]
    ds_read_b128 v[42:45], v63 offset:19200
    v_exp_f32 v112, v112
    v_exp_f32 v113, v113
    v_exp_f32 v114, v114
    v_exp_f32 v115, v115
    v_exp_f32 v116, v116
    v_exp_f32 v117, v117
    v_exp_f32 v118, v118
    v_exp_f32 v119, v119
    s_add_u32 s61, s66, 40960
    buffer_load_dwordx4 a[244:247], v2, s[16:19], s61 offen sc1
    v_cvt_pk_bf16_f32 v112, v112, v113
    v_cvt_pk_bf16_f32 v113, v114, v115
    v_cvt_pk_bf16_f32 v114, v116, v117
    v_cvt_pk_bf16_f32 v115, v118, v119
    v_exp_f32 v120, v120
    v_exp_f32 v121, v121
    v_exp_f32 v122, v122
    s_waitcnt lgkmcnt(0)
    v_mfma_f32_32x32x16_bf16 v[80:95], v[38:41], v[112:115], v[80:95]
    v_exp_f32 v123, v123
    v_exp_f32 v124, v124
    buffer_load_dwordx4 a[248:251], v3, s[16:19], s61 offen sc1
    v_exp_f32 v125, v125
    v_exp_f32 v126, v126
    v_exp_f32 v127, v127
    v_cvt_pk_bf16_f32 v116, v120, v121
    v_cvt_pk_bf16_f32 v117, v122, v123
    v_cvt_pk_bf16_f32 v118, v124, v125
    v_cvt_pk_bf16_f32 v119, v126, v127
    buffer_load_dwordx4 a[252:255], v4, s[16:19], s61 offen sc1
    buffer_load_dwordx4 a[240:243], v1, s[16:19], s61 offen sc1
    v_mfma_f32_32x32x16_bf16 v[80:95], v[42:45], v[116:119], v[80:95]
    v_cmp_gt_u32 vcc, 32, v0
    v_mov_b32 v5, 0x7ff00000
    s_nop 0
    v_cndmask_b32 v5, v5, v21, vcc
    s_nop 7
    v_add_f32_e64 v9, abs(v80), abs(v81)
    v_add_f32_e64 v20, abs(v82), abs(v83)
    v_add_f32_e64 v9, v9, abs(v84)
    v_add_f32_e64 v20, v20, abs(v85)
    v_cmp_lt_f32 vcc, 0x30800000, v92
    s_nop 0
    s_and_b64 s[58:59], s[58:59], vcc
    v_add_f32_e64 v9, v9, abs(v86)
    v_add_f32_e64 v20, v20, abs(v87)
    v_add_f32_e64 v9, v9, abs(v88)
    v_add_f32_e64 v20, v20, abs(v89)
    v_add_f32_e64 v9, v9, abs(v90)
    v_add_f32_e64 v20, v20, abs(v91)
    v_fmamk_f32 v9, v92, 0x61000000, v9
    v_add_f32 v9, v9, v20
    v_cmp_gt_f32 vcc, 0x7f800000, v9
    s_nop 0
    s_and_b64 s[58:59], s[58:59], vcc
    s_cmp_eq_u64 s[58:59], -1
    s_cbranch_scc0 L_exact
L_exact_done:
    s_waitcnt vmcnt(23)
    v_mfma_f32_16x16x32_bf16 v[116:119], a[0:3], a[164:167], 0
    v_rcp_f32 v76, v76
    v_mfma_f32_16x16x32_bf16 v[120:123], a[4:7], a[164:167], 0
    s_add_u32 s61, s66, 49152
    buffer_load_dwordx4 v[26:29], v2, s[16:19], s61 offen sc1
    v_mul_f32 v64, v76, v64
    v_mul_f32 v65, v76, v65
    v_mfma_f32_16x16x32_bf16 v[124:127], a[8:11], a[164:167], 0
    v_mul_f32 v66, v76, v66
    v_mul_f32 v67, v76, v67
    v_mfma_f32_16x16x32_bf16 v[128:131], a[12:15], a[164:167], 0
    v_mul_f32 v68, v76, v68
    v_mul_f32 v69, v76, v69
    v_mfma_f32_16x16x32_bf16 v[132:135], a[16:19], a[164:167], 0
    v_mul_f32 v70, v76, v70
    v_mul_f32 v71, v76, v71
    s_waitcnt vmcnt(23)
    v_mfma_f32_16x16x32_bf16 v[136:139], a[0:3], a[168:171], 0
    buffer_load_dwordx4 v[30:33], v3, s[16:19], s61 offen sc1
    v_mul_f32 v72, v76, v72
    v_mul_f32 v73, v76, v73
    v_mul_f32 v74, v76, v74
    v_mfma_f32_16x16x32_bf16 v[140:143], a[4:7], a[168:171], 0
    v_mul_f32 v75, v76, v75
    v_cvt_pk_bf16_f32 v64, v64, v65
    v_mfma_f32_16x16x32_bf16 v[144:147], a[8:11], a[168:171], 0
    v_cvt_pk_bf16_f32 v65, v66, v67
    v_cvt_pk_bf16_f32 v66, v68, v69
    v_cvt_pk_bf16_f32 v67, v70, v71
    v_mfma_f32_16x16x32_bf16 v[148:151], a[12:15], a[168:171], 0
    buffer_load_dwordx4 v[34:37], v4, s[16:19], s61 offen sc1
    buffer_store_dwordx4 v[64:67], v21, s[16:19], s53 offen offset:0 sc1
    v_mfma_f32_16x16x32_bf16 v[152:155], a[16:19], a[168:171], 0
    v_cvt_pk_bf16_f32 v76, v72, v73
    v_cvt_pk_bf16_f32 v77, v74, v75
    v_rcp_f32 v92, v92
    s_waitcnt vmcnt(25)
    v_mfma_f32_16x16x32_bf16 v[156:159], a[0:3], a[172:175], 0
    v_mul_f32 v80, v92, v80
    v_mul_f32 v81, v92, v81
    v_mfma_f32_16x16x32_bf16 v[160:163], a[4:7], a[172:175], 0
    buffer_load_dwordx4 v[22:25], v1, s[16:19], s61 offen sc1
    v_mul_f32 v82, v92, v82
    v_mul_f32 v83, v92, v83
    v_mul_f32 v84, v92, v84
    v_mfma_f32_16x16x32_bf16 v[164:167], a[8:11], a[172:175], 0
    v_mul_f32 v85, v92, v85
    v_mul_f32 v86, v92, v86
    v_mul_f32 v87, v92, v87
    v_mfma_f32_16x16x32_bf16 v[168:171], a[12:15], a[172:175], 0
    v_mul_f32 v88, v92, v88
    v_mul_f32 v89, v92, v89
    v_mul_f32 v90, v92, v90
    v_mfma_f32_16x16x32_bf16 v[172:175], a[16:19], a[172:175], 0
    v_mul_f32 v91, v92, v91
    v_cvt_pk_bf16_f32 v80, v80, v81
    v_cvt_pk_bf16_f32 v81, v82, v83
    s_waitcnt vmcnt(25)
    v_mfma_f32_16x16x32_bf16 v[96:99], a[0:3], a[160:163], 0
    s_add_u32 s61, s66, 57344
    buffer_load_dwordx4 v[42:45], v2, s[16:19], s61 offen sc1
    v_cvt_pk_bf16_f32 v82, v84, v85
    v_cvt_pk_bf16_f32 v83, v86, v87
    buffer_store_dwordx4 v[80:83], v21, s[16:19], s53 offen offset:1536 sc1
    v_mfma_f32_16x16x32_bf16 v[100:103], a[4:7], a[160:163], 0
    v_cvt_pk_bf16_f32 v78, v88, v89
    v_cvt_pk_bf16_f32 v79, v90, v91
    v_mfma_f32_16x16x32_bf16 v[104:107], a[8:11], a[160:163], 0
    buffer_store_dwordx4 v[76:79], v5, s[16:19], s53 offen offset:1024 sc1
    v_mfma_f32_16x16x32_bf16 v[108:111], a[12:15], a[160:163], 0
    buffer_load_dwordx4 v[46:49], v3, s[16:19], s61 offen sc1
    s_lshl_b32 s47, s51, 2
    v_add_u32 v14, s47, v21
    v_mfma_f32_16x16x32_bf16 v[112:115], a[16:19], a[160:163], 0
    ds_read_b128 a[0:3], v14 offset:0
    s_waitcnt vmcnt(28)
    v_mfma_f32_16x16x32_bf16 v[116:119], a[20:23], a[180:183], v[116:119]
    ds_read_b128 a[4:7], v14 offset:1024
    ds_read_b128 a[8:11], v14 offset:2048
    v_mfma_f32_16x16x32_bf16 v[120:123], a[24:27], a[180:183], v[120:123]
    ds_read_b128 a[12:15], v14 offset:3072
    ds_read_b128 a[16:19], v14 offset:4096
    v_mfma_f32_16x16x32_bf16 v[124:127], a[28:31], a[180:183], v[124:127]
    buffer_load_dwordx4 v[50:53], v4, s[16:19], s61 offen sc1
    v_mfma_f32_16x16x32_bf16 v[128:131], a[32:35], a[180:183], v[128:131]
    v_and_b32 v9, 15, v0
    v_mul_u32_u24 v9, 1280, v9
    v_mfma_f32_16x16x32_bf16 v[132:135], a[36:39], a[180:183], v[132:135]
    v_lshrrev_b32 v10, 4, v0
    v_mul_u32_u24 v10, 40, v10
    s_waitcnt vmcnt(28)
    v_mfma_f32_16x16x32_bf16 v[136:139], a[20:23], a[184:187], v[136:139]
    buffer_load_dwordx4 v[38:41], v1, s[16:19], s61 offen sc1
    v_mfma_f32_16x16x32_bf16 v[140:143], a[24:27], a[184:187], v[140:143]
    v_add_u32 v9, v9, v10
    s_lshl_b32 s47, s41, 2
    v_mfma_f32_16x16x32_bf16 v[144:147], a[28:31], a[184:187], v[144:147]
    s_add_u32 s47, s47, s36
    s_mul_i32 s55, s47, 20480
    v_mfma_f32_16x16x32_bf16 v[148:151], a[32:35], a[184:187], v[148:151]
    s_add_u32 s61, s66, 65536
    buffer_load_dwordx4 a[164:167], v2, s[16:19], s61 offen sc1
    v_mfma_f32_16x16x32_bf16 v[152:155], a[36:39], a[184:187], v[152:155]
    s_mul_i32 s47, s42, 160
    s_add_u32 s55, s55, s47
    s_waitcnt vmcnt(29)
    v_mfma_f32_16x16x32_bf16 v[156:159], a[20:23], a[188:191], v[156:159]
    v_mfma_f32_16x16x32_bf16 v[160:163], a[24:27], a[188:191], v[160:163]
    v_mfma_f32_16x16x32_bf16 v[164:167], a[28:31], a[188:191], v[164:167]
    buffer_load_dwordx4 a[168:171], v3, s[16:19], s61 offen sc1
    v_mfma_f32_16x16x32_bf16 v[168:171], a[32:35], a[188:191], v[168:171]
    v_mfma_f32_16x16x32_bf16 v[172:175], a[36:39], a[188:191], v[172:175]
    s_waitcnt vmcnt(29)
    v_mfma_f32_16x16x32_bf16 v[96:99], a[20:23], a[176:179], v[96:99]
    buffer_load_dwordx4 a[172:175], v4, s[16:19], s61 offen sc1
    v_mfma_f32_16x16x32_bf16 v[100:103], a[24:27], a[176:179], v[100:103]
    v_mfma_f32_16x16x32_bf16 v[104:107], a[28:31], a[176:179], v[104:107]
    v_mfma_f32_16x16x32_bf16 v[108:111], a[32:35], a[176:179], v[108:111]
    buffer_load_dwordx4 a[160:163], v1, s[16:19], s61 offen sc1
    v_mfma_f32_16x16x32_bf16 v[112:115], a[36:39], a[176:179], v[112:115]
    ds_read_b128 a[20:23], v14 offset:5120
    s_waitcnt vmcnt(30)
    v_mfma_f32_16x16x32_bf16 v[116:119], a[40:43], a[196:199], v[116:119]
    ds_read_b128 a[24:27], v14 offset:6144
    ds_read_b128 a[28:31], v14 offset:7168
    v_mfma_f32_16x16x32_bf16 v[120:123], a[44:47], a[196:199], v[120:123]
    ds_read_b128 a[32:35], v14 offset:8192
    ds_read_b128 a[36:39], v14 offset:9216
    v_mfma_f32_16x16x32_bf16 v[124:127], a[48:51], a[196:199], v[124:127]
    s_add_u32 s61, s66, 73728
    buffer_load_dwordx4 a[180:183], v2, s[16:19], s61 offen sc1
    v_mfma_f32_16x16x32_bf16 v[128:131], a[52:55], a[196:199], v[128:131]
    v_mfma_f32_16x16x32_bf16 v[132:135], a[56:59], a[196:199], v[132:135]
    s_waitcnt vmcnt(30)
    v_mfma_f32_16x16x32_bf16 v[136:139], a[40:43], a[200:203], v[136:139]
    buffer_load_dwordx4 a[184:187], v3, s[16:19], s61 offen sc1
    v_mfma_f32_16x16x32_bf16 v[140:143], a[44:47], a[200:203], v[140:143]
    v_mfma_f32_16x16x32_bf16 v[144:147], a[48:51], a[200:203], v[144:147]
    v_mfma_f32_16x16x32_bf16 v[148:151], a[52:55], a[200:203], v[148:151]
    v_mfma_f32_16x16x32_bf16 v[152:155], a[56:59], a[200:203], v[152:155]
    buffer_load_dwordx4 a[188:191], v4, s[16:19], s61 offen sc1
    s_waitcnt vmcnt(31)
    v_mfma_f32_16x16x32_bf16 v[156:159], a[40:43], a[204:207], v[156:159]
    v_mfma_f32_16x16x32_bf16 v[160:163], a[44:47], a[204:207], v[160:163]
    v_mfma_f32_16x16x32_bf16 v[164:167], a[48:51], a[204:207], v[164:167]
    buffer_load_dwordx4 a[176:179], v1, s[16:19], s61 offen sc1
    v_mfma_f32_16x16x32_bf16 v[168:171], a[52:55], a[204:207], v[168:171]
    v_mfma_f32_16x16x32_bf16 v[172:175], a[56:59], a[204:207], v[172:175]
    s_waitcnt vmcnt(31)
    v_mfma_f32_16x16x32_bf16 v[96:99], a[40:43], a[192:195], v[96:99]
    v_mfma_f32_16x16x32_bf16 v[100:103], a[44:47], a[192:195], v[100:103]
    v_mfma_f32_16x16x32_bf16 v[104:107], a[48:51], a[192:195], v[104:107]
    v_mfma_f32_16x16x32_bf16 v[108:111], a[52:55], a[192:195], v[108:111]
    v_mfma_f32_16x16x32_bf16 v[112:115], a[56:59], a[192:195], v[112:115]
    ds_read_b128 a[40:43], v14 offset:10240
    s_waitcnt vmcnt(30)
    v_mfma_f32_16x16x32_bf16 v[116:119], a[60:63], a[212:215], v[116:119]
    s_add_u32 s61, s66, 81920
    buffer_load_dwordx4 a[196:199], v2, s[16:19], s61 offen sc1
    v_mfma_f32_16x16x32_bf16 v[120:123], a[64:67], a[212:215], v[120:123]
    ds_read_b128 a[44:47], v14 offset:11264
    ds_read_b128 a[48:51], v14 offset:12288
    v_mfma_f32_16x16x32_bf16 v[124:127], a[68:71], a[212:215], v[124:127]
    s_getreg_b32 s49, hwreg(HW_REG_IB_STS, 30, 2)
    s_getreg_b32 s50, hwreg(HW_REG_IB_STS, 0, 4)
    s_mov_b32 s3, 0
    s_lshl4_add_u32 s49, s49, s50
    s_cmp_le_u32 s49, 11
    s_cbranch_scc0 L_tf15
    buffer_store_dword v253, v252, s[16:19], s54 offen sc1
    s_mov_b32 s3, 0x100
L_tf15:
    v_mfma_f32_16x16x32_bf16 v[128:131], a[72:75], a[212:215], v[128:131]
    ds_read_b128 a[52:55], v14 offset:13312
    ds_read_b128 a[56:59], v14 offset:14336
    v_mfma_f32_16x16x32_bf16 v[132:135], a[76:79], a[212:215], v[132:135]
    buffer_load_dwordx4 a[200:203], v3, s[16:19], s61 offen sc1
    s_waitcnt vmcnt(31)
    v_mfma_f32_16x16x32_bf16 v[136:139], a[60:63], a[216:219], v[136:139]
    v_mfma_f32_16x16x32_bf16 v[140:143], a[64:67], a[216:219], v[140:143]
    v_mfma_f32_16x16x32_bf16 v[144:147], a[68:71], a[216:219], v[144:147]
    buffer_load_dwordx4 a[204:207], v4, s[16:19], s61 offen sc1
    v_mfma_f32_16x16x32_bf16 v[148:151], a[72:75], a[216:219], v[148:151]
    v_mfma_f32_16x16x32_bf16 v[152:155], a[76:79], a[216:219], v[152:155]
    s_waitcnt vmcnt(31)
    v_mfma_f32_16x16x32_bf16 v[156:159], a[60:63], a[220:223], v[156:159]
    buffer_load_dwordx4 a[192:195], v1, s[16:19], s61 offen sc1
    v_mfma_f32_16x16x32_bf16 v[160:163], a[64:67], a[220:223], v[160:163]
    v_mfma_f32_16x16x32_bf16 v[164:167], a[68:71], a[220:223], v[164:167]
    v_mfma_f32_16x16x32_bf16 v[168:171], a[72:75], a[220:223], v[168:171]
    s_add_u32 s67, s65, 225280
    buffer_load_dwordx4 v[176:179], v21, s[16:19], s67 offen offset:0 sc1
    v_mfma_f32_16x16x32_bf16 v[172:175], a[76:79], a[220:223], v[172:175]
    s_waitcnt vmcnt(32)
    v_mfma_f32_16x16x32_bf16 v[96:99], a[60:63], a[208:211], v[96:99]
    v_mfma_f32_16x16x32_bf16 v[100:103], a[64:67], a[208:211], v[100:103]
    buffer_load_dwordx4 v[236:239], v9, s[4:7], s55 offen
    v_mfma_f32_16x16x32_bf16 v[104:107], a[68:71], a[208:211], v[104:107]
    buffer_load_dwordx4 v[180:183], v21, s[16:19], s67 offen offset:1024 sc1
    v_mfma_f32_16x16x32_bf16 v[108:111], a[72:75], a[208:211], v[108:111]
    v_mfma_f32_16x16x32_bf16 v[112:115], a[76:79], a[208:211], v[112:115]
    s_waitcnt vmcnt(33)
    v_mfma_f32_16x16x32_bf16 v[116:119], a[80:83], a[228:231], v[116:119]
    buffer_load_dwordx4 v[184:187], v21, s[16:19], s67 offen offset:2048 sc1
    buffer_load_dwordx4 v[240:243], v9, s[4:7], s55 offen offset:16
    v_mfma_f32_16x16x32_bf16 v[120:123], a[84:87], a[228:231], v[120:123]
    v_mfma_f32_16x16x32_bf16 v[124:127], a[88:91], a[228:231], v[124:127]
    s_getreg_b32 s49, hwreg(HW_REG_IB_STS, 30, 2)
    s_getreg_b32 s50, hwreg(HW_REG_IB_STS, 0, 4)
    s_lshl4_add_u32 s49, s49, s50
    s_or_b32 s49, s49, s3
    s_cmp_le_u32 s49, 19
    s_cbranch_scc0 L_tf16
    buffer_store_dword v253, v252, s[16:19], s54 offen sc1
    s_mov_b32 s3, 0x100
L_tf16:
    v_mfma_f32_16x16x32_bf16 v[128:131], a[92:95], a[228:231], v[128:131]
    buffer_load_dwordx4 v[188:191], v21, s[16:19], s67 offen offset:3072 sc1
    v_mfma_f32_16x16x32_bf16 v[132:135], a[96:99], a[228:231], v[132:135]
    s_waitcnt vmcnt(35)
    v_mfma_f32_16x16x32_bf16 v[136:139], a[80:83], a[232:235], v[136:139]
    buffer_load_dwordx2 v[244:245], v9, s[4:7], s55 offen offset:32
    v_mfma_f32_16x16x32_bf16 v[140:143], a[84:87], a[232:235], v[140:143]
    s_xor_b32 s47, s36, 1
    s_mul_i32 s47, s47, 15360
    v_mfma_f32_16x16x32_bf16 v[144:147], a[88:91], a[232:235], v[144:147]
    s_add_u32 s67, s67, 4096
    buffer_load_dwordx4 v[192:195], v21, s[16:19], s67 offen offset:0 sc1
    v_mfma_f32_16x16x32_bf16 v[148:151], a[92:95], a[232:235], v[148:151]
    s_add_u32 s47, s47, 0
    v_add_u32 v11, s47, v21
    v_mfma_f32_16x16x32_bf16 v[152:155], a[96:99], a[232:235], v[152:155]
    s_xor_b32 s47, s36, 2
    s_mul_i32 s47, s47, 15360
    s_waitcnt vmcnt(36)
    v_mfma_f32_16x16x32_bf16 v[156:159], a[80:83], a[236:239], v[156:159]
    s_add_u32 s47, s47, 5120
    v_add_u32 v12, s47, v21
    v_mfma_f32_16x16x32_bf16 v[160:163], a[84:87], a[236:239], v[160:163]
    s_add_u32 s61, s66, 90112
    buffer_load_dwordx4 a[212:215], v2, s[16:19], s61 offen sc1
    v_mfma_f32_16x16x32_bf16 v[164:167], a[88:91], a[236:239], v[164:167]
    s_xor_b32 s47, s36, 3
    s_mul_i32 s47, s47, 15360
    v_mfma_f32_16x16x32_bf16 v[168:171], a[92:95], a[236:239], v[168:171]
    s_add_u32 s47, s47, 10240
    v_add_u32 v13, s47, v21
    v_mfma_f32_16x16x32_bf16 v[172:175], a[96:99], a[236:239], v[172:175]
    buffer_load_dwordx4 a[216:219], v3, s[16:19], s61 offen sc1
    s_waitcnt vmcnt(37)
    v_mfma_f32_16x16x32_bf16 v[96:99], a[80:83], a[224:227], v[96:99]
    s_mul_i32 s47, s36, 15360
    v_add_u32 v10, s47, v21
    v_mfma_f32_16x16x32_bf16 v[100:103], a[84:87], a[224:227], v[100:103]
    v_mfma_f32_16x16x32_bf16 v[104:107], a[88:91], a[224:227], v[104:107]
    v_mfma_f32_16x16x32_bf16 v[108:111], a[92:95], a[224:227], v[108:111]
    buffer_load_dwordx4 a[220:223], v4, s[16:19], s61 offen sc1
    v_mfma_f32_16x16x32_bf16 v[112:115], a[96:99], a[224:227], v[112:115]
    s_waitcnt vmcnt(37)
    v_mfma_f32_16x16x32_bf16 v[116:119], a[100:103], a[244:247], v[116:119]
    v_mfma_f32_16x16x32_bf16 v[120:123], a[104:107], a[244:247], v[120:123]
    buffer_load_dwordx4 a[208:211], v1, s[16:19], s61 offen sc1
    v_mfma_f32_16x16x32_bf16 v[124:127], a[108:111], a[244:247], v[124:127]
    s_getreg_b32 s49, hwreg(HW_REG_IB_STS, 30, 2)
    s_getreg_b32 s50, hwreg(HW_REG_IB_STS, 0, 4)
    s_lshl4_add_u32 s49, s49, s50
    s_or_b32 s49, s49, s3
    s_cmp_le_u32 s49, 26
    s_cbranch_scc0 L_tf17
    buffer_store_dword v253, v252, s[16:19], s54 offen sc1
    s_mov_b32 s3, 0x100
L_tf17:
    v_mfma_f32_16x16x32_bf16 v[128:131], a[112:115], a[244:247], v[128:131]
    v_mfma_f32_16x16x32_bf16 v[132:135], a[116:119], a[244:247], v[132:135]
    s_add_u32 s67, s65, 245760
    buffer_load_dwordx4 v[196:199], v21, s[16:19], s67 offen offset:0 sc1
    s_waitcnt vmcnt(38)
    v_mfma_f32_16x16x32_bf16 v[136:139], a[100:103], a[248:251], v[136:139]
    v_mfma_f32_16x16x32_bf16 v[140:143], a[104:107], a[248:251], v[140:143]
    v_mfma_f32_16x16x32_bf16 v[144:147], a[108:111], a[248:251], v[144:147]
    v_mfma_f32_16x16x32_bf16 v[148:151], a[112:115], a[248:251], v[148:151]
    buffer_load_dwordx4 v[200:203], v21, s[16:19], s67 offen offset:1024 sc1
    v_mfma_f32_16x16x32_bf16 v[152:155], a[116:119], a[248:251], v[152:155]
    s_waitcnt vmcnt(38)
    v_mfma_f32_16x16x32_bf16 v[156:159], a[100:103], a[252:255], v[156:159]
    v_mfma_f32_16x16x32_bf16 v[160:163], a[104:107], a[252:255], v[160:163]
    buffer_load_dwordx4 v[204:207], v21, s[16:19], s67 offen offset:2048 sc1
    v_mfma_f32_16x16x32_bf16 v[164:167], a[108:111], a[252:255], v[164:167]
    v_mfma_f32_16x16x32_bf16 v[168:171], a[112:115], a[252:255], v[168:171]
    v_mfma_f32_16x16x32_bf16 v[172:175], a[116:119], a[252:255], v[172:175]
    buffer_load_dwordx4 v[208:211], v21, s[16:19], s67 offen offset:3072 sc1
    s_waitcnt vmcnt(39)
    v_mfma_f32_16x16x32_bf16 v[96:99], a[100:103], a[240:243], v[96:99]
    v_mfma_f32_16x16x32_bf16 v[100:103], a[104:107], a[240:243], v[100:103]
    v_mfma_f32_16x16x32_bf16 v[104:107], a[108:111], a[240:243], v[104:107]
    v_mfma_f32_16x16x32_bf16 v[108:111], a[112:115], a[240:243], v[108:111]
    s_add_u32 s67, s67, 4096
    buffer_load_dwordx4 v[212:215], v21, s[16:19], s67 offen offset:0 sc1
    v_mfma_f32_16x16x32_bf16 v[112:115], a[116:119], a[240:243], v[112:115]
    s_waitcnt vmcnt(39)
    v_mfma_f32_16x16x32_bf16 v[116:119], a[120:123], v[26:29], v[116:119]
    v_mfma_f32_16x16x32_bf16 v[120:123], a[124:127], v[26:29], v[120:123]
    s_add_u32 s61, s66, 98304
    buffer_load_dwordx4 a[228:231], v2, s[16:19], s61 offen sc1
    v_mfma_f32_16x16x32_bf16 v[124:127], a[128:131], v[26:29], v[124:127]
    s_getreg_b32 s49, hwreg(HW_REG_IB_STS, 30, 2)
    s_getreg_b32 s50, hwreg(HW_REG_IB_STS, 0, 4)
    s_lshl4_add_u32 s49, s49, s50
    s_or_b32 s49, s49, s3
    s_cmp_le_u32 s49, 32
    s_cbranch_scc0 L_tf18
    buffer_store_dword v253, v252, s[16:19], s54 offen sc1
    s_mov_b32 s3, 0x100
L_tf18:
    v_mfma_f32_16x16x32_bf16 v[128:131], a[132:135], v[26:29], v[128:131]
    v_mfma_f32_16x16x32_bf16 v[132:135], a[136:139], v[26:29], v[132:135]
    s_waitcnt vmcnt(39)
    v_mfma_f32_16x16x32_bf16 v[136:139], a[120:123], v[30:33], v[136:139]
    buffer_load_dwordx4 a[232:235], v3, s[16:19], s61 offen sc1
    v_mfma_f32_16x16x32_bf16 v[140:143], a[124:127], v[30:33], v[140:143]
    v_mfma_f32_16x16x32_bf16 v[144:147], a[128:131], v[30:33], v[144:147]
    v_mfma_f32_16x16x32_bf16 v[148:151], a[132:135], v[30:33], v[148:151]
    buffer_load_dwordx4 a[236:239], v4, s[16:19], s61 offen sc1
    v_mfma_f32_16x16x32_bf16 v[152:155], a[136:139], v[30:33], v[152:155]
    s_waitcnt vmcnt(40)
    v_mfma_f32_16x16x32_bf16 v[156:159], a[120:123], v[34:37], v[156:159]
    v_mfma_f32_16x16x32_bf16 v[160:163], a[124:127], v[34:37], v[160:163]
    buffer_load_dwordx4 a[224:227], v1, s[16:19], s61 offen sc1
    v_mfma_f32_16x16x32_bf16 v[164:167], a[128:131], v[34:37], v[164:167]
    v_mfma_f32_16x16x32_bf16 v[168:171], a[132:135], v[34:37], v[168:171]
    v_mfma_f32_16x16x32_bf16 v[172:175], a[136:139], v[34:37], v[172:175]
    s_waitcnt vmcnt(39)
    v_mfma_f32_16x16x32_bf16 v[96:99], a[120:123], v[22:25], v[96:99]
    s_add_u32 s67, s65, 266240
    s_cmp_lt_u32 s36, 2
    s_cselect_b32 s67, s67, 2146435072
    buffer_load_dwordx4 v[216:219], v21, s[16:19], s67 offen offset:0 sc1
    v_mfma_f32_16x16x32_bf16 v[100:103], a[124:127], v[22:25], v[100:103]
    v_mfma_f32_16x16x32_bf16 v[104:107], a[128:131], v[22:25], v[104:107]
    v_mfma_f32_16x16x32_bf16 v[108:111], a[132:135], v[22:25], v[108:111]
    v_mfma_f32_16x16x32_bf16 v[112:115], a[136:139], v[22:25], v[112:115]
    buffer_load_dwordx4 v[220:223], v21, s[16:19], s67 offen offset:1024 sc1
    s_waitcnt vmcnt(40)
    v_mfma_f32_16x16x32_bf16 v[116:119], a[140:143], v[42:45], v[116:119]
    v_mfma_f32_16x16x32_bf16 v[120:123], a[144:147], v[42:45], v[120:123]
    v_mfma_f32_16x16x32_bf16 v[124:127], a[148:151], v[42:45], v[124:127]
    buffer_load_dwordx4 v[224:227], v21, s[16:19], s67 offen offset:2048 sc1
    s_cmp_lg_u32 s3, 0
    s_cbranch_scc1 L_tf19
    s_waitcnt vmcnt(39)
    buffer_store_dword v253, v252, s[16:19], s54 offen sc1
    s_mov_b32 s3, 0x100
L_tf19:
    v_mfma_f32_16x16x32_bf16 v[128:131], a[152:155], v[42:45], v[128:131]
    v_mfma_f32_16x16x32_bf16 v[132:135], a[156:159], v[42:45], v[132:135]
    s_waitcnt vmcnt(38)
    v_mfma_f32_16x16x32_bf16 v[136:139], a[140:143], v[46:49], v[136:139]
    buffer_load_dwordx4 v[228:231], v21, s[16:19], s67 offen offset:3072 sc1
    v_mfma_f32_16x16x32_bf16 v[140:143], a[144:147], v[46:49], v[140:143]
    v_mfma_f32_16x16x32_bf16 v[144:147], a[148:151], v[46:49], v[144:147]
    v_mfma_f32_16x16x32_bf16 v[148:151], a[152:155], v[46:49], v[148:151]
    s_add_u32 s67, s67, 4096
    buffer_load_dwordx4 v[232:235], v21, s[16:19], s67 offen offset:0 sc1
    v_mfma_f32_16x16x32_bf16 v[152:155], a[156:159], v[46:49], v[152:155]
    s_waitcnt vmcnt(39)
    v_mfma_f32_16x16x32_bf16 v[156:159], a[140:143], v[50:53], v[156:159]
    v_mfma_f32_16x16x32_bf16 v[160:163], a[144:147], v[50:53], v[160:163]
    v_mfma_f32_16x16x32_bf16 v[164:167], a[148:151], v[50:53], v[164:167]
    s_add_u32 s61, s66, 106496
    s_cmp_lt_u32 s36, 2
    s_cselect_b32 s61, s61, 2146435072
    buffer_load_dwordx4 a[244:247], v2, s[16:19], s61 offen sc1
    v_mfma_f32_16x16x32_bf16 v[168:171], a[152:155], v[50:53], v[168:171]
    v_mfma_f32_16x16x32_bf16 v[172:175], a[156:159], v[50:53], v[172:175]
    s_waitcnt vmcnt(39)
    v_mfma_f32_16x16x32_bf16 v[96:99], a[140:143], v[38:41], v[96:99]
    v_mfma_f32_16x16x32_bf16 v[100:103], a[144:147], v[38:41], v[100:103]
    buffer_load_dwordx4 a[248:251], v3, s[16:19], s61 offen sc1
    v_mfma_f32_16x16x32_bf16 v[104:107], a[148:151], v[38:41], v[104:107]
    v_mfma_f32_16x16x32_bf16 v[108:111], a[152:155], v[38:41], v[108:111]
    v_mfma_f32_16x16x32_bf16 v[112:115], a[156:159], v[38:41], v[112:115]
    buffer_load_dwordx4 a[252:255], v4, s[16:19], s61 offen sc1
    s_waitcnt vmcnt(40) lgkmcnt(0)
    v_mfma_f32_16x16x32_bf16 v[116:119], a[0:3], a[164:167], v[116:119]
    v_mfma_f32_16x16x32_bf16 v[120:123], a[4:7], a[164:167], v[120:123]
    v_mfma_f32_16x16x32_bf16 v[124:127], a[8:11], a[164:167], v[124:127]
    buffer_load_dwordx4 a[240:243], v1, s[16:19], s61 offen sc1
    v_mfma_f32_16x16x32_bf16 v[128:131], a[12:15], a[164:167], v[128:131]
    v_mfma_f32_16x16x32_bf16 v[132:135], a[16:19], a[164:167], v[132:135]
    s_waitcnt vmcnt(40)
    v_mfma_f32_16x16x32_bf16 v[136:139], a[0:3], a[168:171], v[136:139]
    s_add_u32 s67, s65, 276480
    buffer_load_dwordx4 v[76:79], v21, s[16:19], s67 offen offset:0 sc1
    v_mfma_f32_16x16x32_bf16 v[140:143], a[4:7], a[168:171], v[140:143]
    v_mfma_f32_16x16x32_bf16 v[144:147], a[8:11], a[168:171], v[144:147]
    v_mfma_f32_16x16x32_bf16 v[148:151], a[12:15], a[168:171], v[148:151]
    v_mfma_f32_16x16x32_bf16 v[152:155], a[16:19], a[168:171], v[152:155]
    buffer_load_dwordx4 v[80:83], v21, s[16:19], s67 offen offset:1024 sc1
    s_waitcnt vmcnt(41)
    v_mfma_f32_16x16x32_bf16 v[156:159], a[0:3], a[172:175], v[156:159]
    v_mfma_f32_16x16x32_bf16 v[160:163], a[4:7], a[172:175], v[160:163]
    v_mfma_f32_16x16x32_bf16 v[164:167], a[8:11], a[172:175], v[164:167]
    buffer_load_dwordx4 v[84:87], v21, s[16:19], s67 offen offset:2048 sc1
    v_mfma_f32_16x16x32_bf16 v[168:171], a[12:15], a[172:175], v[168:171]
    v_mfma_f32_16x16x32_bf16 v[172:175], a[16:19], a[172:175], v[172:175]
    s_waitcnt vmcnt(41)
    v_mfma_f32_16x16x32_bf16 v[96:99], a[0:3], a[160:163], v[96:99]
    buffer_load_dwordx4 v[88:91], v21, s[16:19], s67 offen offset:3072 sc1
    v_mfma_f32_16x16x32_bf16 v[100:103], a[4:7], a[160:163], v[100:103]
    v_mfma_f32_16x16x32_bf16 v[104:107], a[8:11], a[160:163], v[104:107]
    v_mfma_f32_16x16x32_bf16 v[108:111], a[12:15], a[160:163], v[108:111]
    v_mfma_f32_16x16x32_bf16 v[112:115], a[16:19], a[160:163], v[112:115]
    s_add_u32 s67, s67, 4096
    buffer_load_dwordx4 v[92:95], v21, s[16:19], s67 offen offset:0 sc1
    s_waitcnt vmcnt(42)
    v_mfma_f32_16x16x32_bf16 v[116:119], a[20:23], a[180:183], v[116:119]
    s_lshl_b32 s47, s41, 9
    s_add_u32 s47, s47, 20627456
    v_and_b32 v8, 0x1ff, v21
    v_add_u32 v8, s47, v8
    buffer_load_dword v7, v8, s[16:19], 0 offen sc1
    v_mfma_f32_16x16x32_bf16 v[120:123], a[24:27], a[180:183], v[120:123]
    v_mfma_f32_16x16x32_bf16 v[124:127], a[28:31], a[180:183], v[124:127]
    s_add_u32 s67, s65, 296960
    buffer_load_dwordx4 a[60:63], v21, s[16:19], s67 offen offset:0 sc1
    v_mfma_f32_16x16x32_bf16 v[128:131], a[32:35], a[180:183], v[128:131]
    v_mfma_f32_16x16x32_bf16 v[132:135], a[36:39], a[180:183], v[132:135]
    s_waitcnt vmcnt(43)
    v_mfma_f32_16x16x32_bf16 v[136:139], a[20:23], a[184:187], v[136:139]
    v_mfma_f32_16x16x32_bf16 v[140:143], a[24:27], a[184:187], v[140:143]
    buffer_load_dwordx4 a[64:67], v21, s[16:19], s67 offen offset:1024 sc1
    v_mfma_f32_16x16x32_bf16 v[144:147], a[28:31], a[184:187], v[144:147]
    v_mfma_f32_16x16x32_bf16 v[148:151], a[32:35], a[184:187], v[148:151]
    v_mfma_f32_16x16x32_bf16 v[152:155], a[36:39], a[184:187], v[152:155]
    buffer_load_dwordx4 a[68:71], v21, s[16:19], s67 offen offset:2048 sc1
    s_waitcnt vmcnt(44)
    v_mfma_f32_16x16x32_bf16 v[156:159], a[20:23], a[188:191], v[156:159]
    v_mfma_f32_16x16x32_bf16 v[160:163], a[24:27], a[188:191], v[160:163]
    v_mfma_f32_16x16x32_bf16 v[164:167], a[28:31], a[188:191], v[164:167]
    buffer_load_dwordx4 a[72:75], v21, s[16:19], s67 offen offset:3072 sc1
    v_mfma_f32_16x16x32_bf16 v[168:171], a[32:35], a[188:191], v[168:171]
    v_mfma_f32_16x16x32_bf16 v[172:175], a[36:39], a[188:191], v[172:175]
    s_waitcnt vmcnt(44)
    v_mfma_f32_16x16x32_bf16 v[96:99], a[20:23], a[176:179], v[96:99]
    v_mfma_f32_16x16x32_bf16 v[100:103], a[24:27], a[176:179], v[100:103]
    s_add_u32 s67, s67, 4096
    buffer_load_dwordx4 a[76:79], v21, s[16:19], s67 offen offset:0 sc1
    v_mfma_f32_16x16x32_bf16 v[104:107], a[28:31], a[176:179], v[104:107]
    v_mfma_f32_16x16x32_bf16 v[108:111], a[32:35], a[176:179], v[108:111]
    v_mfma_f32_16x16x32_bf16 v[112:115], a[36:39], a[176:179], v[112:115]
    s_add_u32 s67, s65, 317440
    buffer_load_dwordx4 a[80:83], v21, s[16:19], s67 offen offset:0 sc1
    s_waitcnt vmcnt(45)
    v_mfma_f32_16x16x32_bf16 v[116:119], a[40:43], a[196:199], v[116:119]
    v_mfma_f32_16x16x32_bf16 v[120:123], a[44:47], a[196:199], v[120:123]
    v_mfma_f32_16x16x32_bf16 v[124:127], a[48:51], a[196:199], v[124:127]
    v_mfma_f32_16x16x32_bf16 v[128:131], a[52:55], a[196:199], v[128:131]
    buffer_load_dwordx4 a[84:87], v21, s[16:19], s67 offen offset:1024 sc1
    v_mfma_f32_16x16x32_bf16 v[132:135], a[56:59], a[196:199], v[132:135]
    s_waitcnt vmcnt(45)
    v_mfma_f32_16x16x32_bf16 v[136:139], a[40:43], a[200:203], v[136:139]
    v_mfma_f32_16x16x32_bf16 v[140:143], a[44:47], a[200:203], v[140:143]
    buffer_load_dwordx4 a[88:91], v21, s[16:19], s67 offen offset:2048 sc1
    v_mfma_f32_16x16x32_bf16 v[144:147], a[48:51], a[200:203], v[144:147]
    v_mfma_f32_16x16x32_bf16 v[148:151], a[52:55], a[200:203], v[148:151]
    v_mfma_f32_16x16x32_bf16 v[152:155], a[56:59], a[200:203], v[152:155]
    buffer_load_dwordx4 a[92:95], v21, s[16:19], s67 offen offset:3072 sc1
    s_waitcnt vmcnt(46)
    v_mfma_f32_16x16x32_bf16 v[156:159], a[40:43], a[204:207], v[156:159]
    v_mfma_f32_16x16x32_bf16 v[160:163], a[44:47], a[204:207], v[160:163]
    v_mfma_f32_16x16x32_bf16 v[164:167], a[48:51], a[204:207], v[164:167]
    v_mfma_f32_16x16x32_bf16 v[168:171], a[52:55], a[204:207], v[168:171]
    s_add_u32 s67, s67, 4096
    buffer_load_dwordx4 a[96:99], v21, s[16:19], s67 offen offset:0 sc1
    v_mfma_f32_16x16x32_bf16 v[172:175], a[56:59], a[204:207], v[172:175]
    s_waitcnt vmcnt(46)
    v_mfma_f32_16x16x32_bf16 v[96:99], a[40:43], a[192:195], v[96:99]
    v_mfma_f32_16x16x32_bf16 v[100:103], a[44:47], a[192:195], v[100:103]
    v_mfma_f32_16x16x32_bf16 v[104:107], a[48:51], a[192:195], v[104:107]
    v_mfma_f32_16x16x32_bf16 v[108:111], a[52:55], a[192:195], v[108:111]
    s_waitcnt vmcnt(10)
    v_cmp_ne_u32 vcc, 0, v7
    s_nop 0
    s_cmp_eq_u64 vcc, -1
    s_cbranch_scc0 L_spin16
L_back16:
    v_mfma_f32_16x16x32_bf16 v[112:115], a[56:59], a[192:195], v[112:115]
    v_mfma_f32_16x16x32_bf16 v[116:119], v[176:179], a[212:215], v[116:119]
    s_add_u32 s61, s66, 110592
    buffer_load_dwordx4 v[26:29], v2, s[16:19], s61 offen sc1
    v_mfma_f32_16x16x32_bf16 v[120:123], v[180:183], a[212:215], v[120:123]
    v_mfma_f32_16x16x32_bf16 v[124:127], v[184:187], a[212:215], v[124:127]
    v_mfma_f32_16x16x32_bf16 v[128:131], v[188:191], a[212:215], v[128:131]
    v_mfma_f32_16x16x32_bf16 v[132:135], v[192:195], a[212:215], v[132:135]
    buffer_load_dwordx4 v[30:33], v3, s[16:19], s61 offen sc1
    v_mfma_f32_16x16x32_bf16 v[136:139], v[176:179], a[216:219], v[136:139]
    v_mfma_f32_16x16x32_bf16 v[140:143], v[180:183], a[216:219], v[140:143]
    v_mfma_f32_16x16x32_bf16 v[144:147], v[184:187], a[216:219], v[144:147]
    buffer_load_dwordx4 v[34:37], v4, s[16:19], s61 offen sc1
    v_mfma_f32_16x16x32_bf16 v[148:151], v[188:191], a[216:219], v[148:151]
    v_mfma_f32_16x16x32_bf16 v[152:155], v[192:195], a[216:219], v[152:155]
    v_mfma_f32_16x16x32_bf16 v[156:159], v[176:179], a[220:223], v[156:159]
    buffer_load_dwordx4 v[22:25], v1, s[16:19], s61 offen sc1
    v_mfma_f32_16x16x32_bf16 v[160:163], v[180:183], a[220:223], v[160:163]
    v_mfma_f32_16x16x32_bf16 v[164:167], v[184:187], a[220:223], v[164:167]
    v_mfma_f32_16x16x32_bf16 v[168:171], v[188:191], a[220:223], v[168:171]
    v_mfma_f32_16x16x32_bf16 v[172:175], v[192:195], a[220:223], v[172:175]
    s_add_u32 s61, s66, 118784
    buffer_load_dwordx4 v[42:45], v2, s[16:19], s61 offen sc1
    v_mfma_f32_16x16x32_bf16 v[96:99], v[176:179], a[208:211], v[96:99]
    v_mfma_f32_16x16x32_bf16 v[100:103], v[180:183], a[208:211], v[100:103]
    v_mfma_f32_16x16x32_bf16 v[104:107], v[184:187], a[208:211], v[104:107]
    buffer_load_dwordx4 v[46:49], v3, s[16:19], s61 offen sc1
    v_mfma_f32_16x16x32_bf16 v[108:111], v[188:191], a[208:211], v[108:111]
    v_mfma_f32_16x16x32_bf16 v[112:115], v[192:195], a[208:211], v[112:115]
    v_mfma_f32_16x16x32_bf16 v[116:119], v[196:199], a[228:231], v[116:119]
    s_barrier
    v_mfma_f32_16x16x32_bf16 v[120:123], v[200:203], a[228:231], v[120:123]
    buffer_load_dwordx4 v[50:53], v4, s[16:19], s61 offen sc1
    v_mfma_f32_16x16x32_bf16 v[124:127], v[204:207], a[228:231], v[124:127]
    v_lshlrev_b32 v54, 16, v236
    v_and_b32 v55, 0xffff0000, v236
    v_mfma_f32_16x16x32_bf16 v[128:131], v[208:211], a[228:231], v[128:131]
    v_lshlrev_b32 v56, 16, v237
    v_and_b32 v57, 0xffff0000, v237
    v_mfma_f32_16x16x32_bf16 v[132:135], v[212:215], a[228:231], v[132:135]
    buffer_load_dwordx4 v[38:41], v1, s[16:19], s61 offen sc1
    v_mfma_f32_16x16x32_bf16 v[136:139], v[196:199], a[232:235], v[136:139]
    v_lshlrev_b32 v58, 16, v238
    v_and_b32 v59, 0xffff0000, v238
    v_mfma_f32_16x16x32_bf16 v[140:143], v[200:203], a[232:235], v[140:143]
    v_lshlrev_b32 v60, 16, v239
    v_and_b32 v61, 0xffff0000, v239
    v_mfma_f32_16x16x32_bf16 v[144:147], v[204:207], a[232:235], v[144:147]
    s_add_u32 s67, s65, 337920
    buffer_load_dwordx4 a[100:103], v21, s[16:19], s67 offen offset:0 sc1
    v_mfma_f32_16x16x32_bf16 v[148:151], v[208:211], a[232:235], v[148:151]
    v_lshlrev_b32 v62, 16, v240
    v_and_b32 v63, 0xffff0000, v240
    v_mfma_f32_16x16x32_bf16 v[152:155], v[212:215], a[232:235], v[152:155]
    v_lshlrev_b32 v64, 16, v241
    v_and_b32 v65, 0xffff0000, v241
    v_mfma_f32_16x16x32_bf16 v[156:159], v[196:199], a[236:239], v[156:159]
    v_lshlrev_b32 v66, 16, v242
    v_and_b32 v67, 0xffff0000, v242
    v_mfma_f32_16x16x32_bf16 v[160:163], v[200:203], a[236:239], v[160:163]
    buffer_load_dwordx4 a[104:107], v21, s[16:19], s67 offen offset:1024 sc1
    v_mfma_f32_16x16x32_bf16 v[164:167], v[204:207], a[236:239], v[164:167]
    v_lshlrev_b32 v68, 16, v243
    v_and_b32 v69, 0xffff0000, v243
    v_mfma_f32_16x16x32_bf16 v[168:171], v[208:211], a[236:239], v[168:171]
    v_lshlrev_b32 v70, 16, v244
    v_and_b32 v71, 0xffff0000, v244
    v_mfma_f32_16x16x32_bf16 v[172:175], v[212:215], a[236:239], v[172:175]
    buffer_load_dwordx4 a[108:111], v21, s[16:19], s67 offen offset:2048 sc1
    v_mfma_f32_16x16x32_bf16 v[96:99], v[196:199], a[224:227], v[96:99]
    v_lshlrev_b32 v72, 16, v245
    v_and_b32 v73, 0xffff0000, v245
    v_mfma_f32_16x16x32_bf16 v[100:103], v[200:203], a[224:227], v[100:103]
    v_mfma_f32_16x16x32_bf16 v[104:107], v[204:207], a[224:227], v[104:107]
    buffer_load_dwordx4 a[112:115], v21, s[16:19], s67 offen offset:3072 sc1
    v_mfma_f32_16x16x32_bf16 v[108:111], v[208:211], a[224:227], v[108:111]
    v_mfma_f32_16x16x32_bf16 v[112:115], v[212:215], a[224:227], v[112:115]
    v_mfma_f32_16x16x32_bf16 v[116:119], v[216:219], a[244:247], v[116:119]
    v_mfma_f32_16x16x32_bf16 v[120:123], v[220:223], a[244:247], v[120:123]
    s_add_u32 s67, s67, 4096
    buffer_load_dwordx4 a[116:119], v21, s[16:19], s67 offen offset:0 sc1
    v_mfma_f32_16x16x32_bf16 v[124:127], v[224:227], a[244:247], v[124:127]
    v_mfma_f32_16x16x32_bf16 v[128:131], v[228:231], a[244:247], v[128:131]
    v_mfma_f32_16x16x32_bf16 v[132:135], v[232:235], a[244:247], v[132:135]
    s_add_u32 s61, s66, 126976
    buffer_load_dwordx4 a[164:167], v2, s[16:19], s61 offen sc1
    v_mfma_f32_16x16x32_bf16 v[136:139], v[216:219], a[248:251], v[136:139]
    v_mfma_f32_16x16x32_bf16 v[140:143], v[220:223], a[248:251], v[140:143]
    v_mfma_f32_16x16x32_bf16 v[144:147], v[224:227], a[248:251], v[144:147]
    v_mfma_f32_16x16x32_bf16 v[148:151], v[228:231], a[248:251], v[148:151]
    buffer_load_dwordx4 a[168:171], v3, s[16:19], s61 offen sc1
    v_mfma_f32_16x16x32_bf16 v[152:155], v[232:235], a[248:251], v[152:155]
    v_mfma_f32_16x16x32_bf16 v[156:159], v[216:219], a[252:255], v[156:159]
    v_mfma_f32_16x16x32_bf16 v[160:163], v[220:223], a[252:255], v[160:163]
    buffer_load_dwordx4 a[172:175], v4, s[16:19], s61 offen sc1
    v_mfma_f32_16x16x32_bf16 v[164:167], v[224:227], a[252:255], v[164:167]
    v_mfma_f32_16x16x32_bf16 v[168:171], v[228:231], a[252:255], v[168:171]
    v_mfma_f32_16x16x32_bf16 v[172:175], v[232:235], a[252:255], v[172:175]
    buffer_load_dwordx4 a[160:163], v1, s[16:19], s61 offen sc1
    v_mfma_f32_16x16x32_bf16 v[96:99], v[216:219], a[240:243], v[96:99]
    v_mfma_f32_16x16x32_bf16 v[100:103], v[220:223], a[240:243], v[100:103]
    v_mfma_f32_16x16x32_bf16 v[104:107], v[224:227], a[240:243], v[104:107]
    s_add_u32 s67, s65, 358400
    buffer_load_dwordx4 a[120:123], v21, s[16:19], s67 offen offset:0 sc1
    v_mfma_f32_16x16x32_bf16 v[108:111], v[228:231], a[240:243], v[108:111]
    v_mfma_f32_16x16x32_bf16 v[112:115], v[232:235], a[240:243], v[112:115]
    s_waitcnt vmcnt(17)
    v_mfma_f32_16x16x32_bf16 v[116:119], v[76:79], v[26:29], v[116:119]
    v_mfma_f32_16x16x32_bf16 v[120:123], v[80:83], v[26:29], v[120:123]
    buffer_load_dwordx4 a[124:127], v21, s[16:19], s67 offen offset:1024 sc1
    v_mfma_f32_16x16x32_bf16 v[124:127], v[84:87], v[26:29], v[124:127]
    v_mfma_f32_16x16x32_bf16 v[128:131], v[88:91], v[26:29], v[128:131]
    v_mfma_f32_16x16x32_bf16 v[132:135], v[92:95], v[26:29], v[132:135]
    buffer_load_dwordx4 a[128:131], v21, s[16:19], s67 offen offset:2048 sc1
    s_waitcnt vmcnt(18)
    v_mfma_f32_16x16x32_bf16 v[136:139], v[76:79], v[30:33], v[136:139]
    v_mfma_f32_16x16x32_bf16 v[140:143], v[80:83], v[30:33], v[140:143]
    v_mfma_f32_16x16x32_bf16 v[144:147], v[84:87], v[30:33], v[144:147]
    buffer_load_dwordx4 a[132:135], v21, s[16:19], s67 offen offset:3072 sc1
    v_mfma_f32_16x16x32_bf16 v[148:151], v[88:91], v[30:33], v[148:151]
    v_mfma_f32_16x16x32_bf16 v[152:155], v[92:95], v[30:33], v[152:155]
    s_waitcnt vmcnt(18)
    v_mfma_f32_16x16x32_bf16 v[156:159], v[76:79], v[34:37], v[156:159]
    v_mfma_f32_16x16x32_bf16 v[160:163], v[80:83], v[34:37], v[160:163]
    s_add_u32 s67, s67, 4096
    buffer_load_dwordx4 a[136:139], v21, s[16:19], s67 offen offset:0 sc1
    v_mfma_f32_16x16x32_bf16 v[164:167], v[84:87], v[34:37], v[164:167]
    v_mfma_f32_16x16x32_bf16 v[168:171], v[88:91], v[34:37], v[168:171]
    v_mfma_f32_16x16x32_bf16 v[172:175], v[92:95], v[34:37], v[172:175]
    s_waitcnt vmcnt(18)
    v_mfma_f32_16x16x32_bf16 v[96:99], v[76:79], v[22:25], v[96:99]
    s_add_u32 s61, s66, 135168
    buffer_load_dwordx4 a[180:183], v2, s[16:19], s61 offen sc1
    v_mfma_f32_16x16x32_bf16 v[100:103], v[80:83], v[22:25], v[100:103]
    v_mfma_f32_16x16x32_bf16 v[104:107], v[84:87], v[22:25], v[104:107]
    v_mfma_f32_16x16x32_bf16 v[108:111], v[88:91], v[22:25], v[108:111]
    buffer_load_dwordx4 a[184:187], v3, s[16:19], s61 offen sc1
    v_mfma_f32_16x16x32_bf16 v[112:115], v[92:95], v[22:25], v[112:115]
    s_waitcnt vmcnt(19)
    v_mfma_f32_16x16x32_bf16 v[116:119], a[60:63], v[42:45], v[116:119]
    v_mfma_f32_16x16x32_bf16 v[120:123], a[64:67], v[42:45], v[120:123]
    v_mfma_f32_16x16x32_bf16 v[124:127], a[68:71], v[42:45], v[124:127]
    buffer_load_dwordx4 a[188:191], v4, s[16:19], s61 offen sc1
    v_mfma_f32_16x16x32_bf16 v[128:131], a[72:75], v[42:45], v[128:131]
    v_mfma_f32_16x16x32_bf16 v[132:135], a[76:79], v[42:45], v[132:135]
    s_waitcnt vmcnt(19)
    v_mfma_f32_16x16x32_bf16 v[136:139], a[60:63], v[46:49], v[136:139]
    buffer_load_dwordx4 a[176:179], v1, s[16:19], s61 offen sc1
    v_mfma_f32_16x16x32_bf16 v[140:143], a[64:67], v[46:49], v[140:143]
    v_mfma_f32_16x16x32_bf16 v[144:147], a[68:71], v[46:49], v[144:147]
    v_mfma_f32_16x16x32_bf16 v[148:151], a[72:75], v[46:49], v[148:151]
    s_add_u32 s61, s66, 143360
    buffer_load_dwordx4 a[196:199], v2, s[16:19], s61 offen sc1
    v_mfma_f32_16x16x32_bf16 v[152:155], a[76:79], v[46:49], v[152:155]
    s_waitcnt vmcnt(20)
    v_mfma_f32_16x16x32_bf16 v[156:159], a[60:63], v[50:53], v[156:159]
    v_mfma_f32_16x16x32_bf16 v[160:163], a[64:67], v[50:53], v[160:163]
    v_mfma_f32_16x16x32_bf16 v[164:167], a[68:71], v[50:53], v[164:167]
    buffer_load_dwordx4 a[200:203], v3, s[16:19], s61 offen sc1
    v_mfma_f32_16x16x32_bf16 v[168:171], a[72:75], v[50:53], v[168:171]
    v_mfma_f32_16x16x32_bf16 v[172:175], a[76:79], v[50:53], v[172:175]
    s_waitcnt vmcnt(20)
    v_mfma_f32_16x16x32_bf16 v[96:99], a[60:63], v[38:41], v[96:99]
    buffer_load_dwordx4 a[204:207], v4, s[16:19], s61 offen sc1
    v_mfma_f32_16x16x32_bf16 v[100:103], a[64:67], v[38:41], v[100:103]
    v_mfma_f32_16x16x32_bf16 v[104:107], a[68:71], v[38:41], v[104:107]
    v_mfma_f32_16x16x32_bf16 v[108:111], a[72:75], v[38:41], v[108:111]
    buffer_load_dwordx4 a[192:195], v1, s[16:19], s61 offen sc1
    v_mfma_f32_16x16x32_bf16 v[112:115], a[76:79], v[38:41], v[112:115]
    s_waitcnt vmcnt(16)
    v_mfma_f32_16x16x32_bf16 v[116:119], a[80:83], a[164:167], v[116:119]
    v_mfma_f32_16x16x32_bf16 v[120:123], a[84:87], a[164:167], v[120:123]
    v_mfma_f32_16x16x32_bf16 v[124:127], a[88:91], a[164:167], v[124:127]
    v_mfma_f32_16x16x32_bf16 v[128:131], a[92:95], a[164:167], v[128:131]
    v_mfma_f32_16x16x32_bf16 v[132:135], a[96:99], a[164:167], v[132:135]
    s_waitcnt vmcnt(15)
    v_mfma_f32_16x16x32_bf16 v[136:139], a[80:83], a[168:171], v[136:139]
    v_mfma_f32_16x16x32_bf16 v[140:143], a[84:87], a[168:171], v[140:143]
    v_mfma_f32_16x16x32_bf16 v[144:147], a[88:91], a[168:171], v[144:147]
    v_mfma_f32_16x16x32_bf16 v[148:151], a[92:95], a[168:171], v[148:151]
    v_mfma_f32_16x16x32_bf16 v[152:155], a[96:99], a[168:171], v[152:155]
    s_waitcnt vmcnt(14)
    v_mfma_f32_16x16x32_bf16 v[156:159], a[80:83], a[172:175], v[156:159]
    v_mfma_f32_16x16x32_bf16 v[160:163], a[84:87], a[172:175], v[160:163]
    v_mfma_f32_16x16x32_bf16 v[164:167], a[88:91], a[172:175], v[164:167]
    v_mfma_f32_16x16x32_bf16 v[168:171], a[92:95], a[172:175], v[168:171]
    v_mfma_f32_16x16x32_bf16 v[172:175], a[96:99], a[172:175], v[172:175]
    s_waitcnt vmcnt(13)
    v_mfma_f32_16x16x32_bf16 v[96:99], a[80:83], a[160:163], v[96:99]
    v_mfma_f32_16x16x32_bf16 v[100:103], a[84:87], a[160:163], v[100:103]
    v_mfma_f32_16x16x32_bf16 v[104:107], a[88:91], a[160:163], v[104:107]
    v_mfma_f32_16x16x32_bf16 v[108:111], a[92:95], a[160:163], v[108:111]
    v_mfma_f32_16x16x32_bf16 v[112:115], a[96:99], a[160:163], v[112:115]
    s_waitcnt vmcnt(7)
    v_mfma_f32_16x16x32_bf16 v[116:119], a[100:103], a[180:183], v[116:119]
    v_mfma_f32_16x16x32_bf16 v[120:123], a[104:107], a[180:183], v[120:123]
    v_mfma_f32_16x16x32_bf16 v[124:127], a[108:111], a[180:183], v[124:127]
    v_mfma_f32_16x16x32_bf16 v[128:131], a[112:115], a[180:183], v[128:131]
    v_mfma_f32_16x16x32_bf16 v[132:135], a[116:119], a[180:183], v[132:135]
    s_waitcnt vmcnt(6)
    v_mfma_f32_16x16x32_bf16 v[136:139], a[100:103], a[184:187], v[136:139]
    v_mfma_f32_16x16x32_bf16 v[140:143], a[104:107], a[184:187], v[140:143]
    v_mfma_f32_16x16x32_bf16 v[144:147], a[108:111], a[184:187], v[144:147]
    v_mfma_f32_16x16x32_bf16 v[148:151], a[112:115], a[184:187], v[148:151]
    v_mfma_f32_16x16x32_bf16 v[152:155], a[116:119], a[184:187], v[152:155]
    s_waitcnt vmcnt(5)
    v_mfma_f32_16x16x32_bf16 v[156:159], a[100:103], a[188:191], v[156:159]
    v_mfma_f32_16x16x32_bf16 v[160:163], a[104:107], a[188:191], v[160:163]
    v_mfma_f32_16x16x32_bf16 v[164:167], a[108:111], a[188:191], v[164:167]
    v_mfma_f32_16x16x32_bf16 v[168:171], a[112:115], a[188:191], v[168:171]
    v_mfma_f32_16x16x32_bf16 v[172:175], a[116:119], a[188:191], v[172:175]
    s_waitcnt vmcnt(4)
    v_mfma_f32_16x16x32_bf16 v[96:99], a[100:103], a[176:179], v[96:99]
    v_mfma_f32_16x16x32_bf16 v[100:103], a[104:107], a[176:179], v[100:103]
    v_mfma_f32_16x16x32_bf16 v[104:107], a[108:111], a[176:179], v[104:107]
    v_mfma_f32_16x16x32_bf16 v[108:111], a[112:115], a[176:179], v[108:111]
    v_mfma_f32_16x16x32_bf16 v[112:115], a[116:119], a[176:179], v[112:115]
    s_waitcnt vmcnt(3)
    v_mfma_f32_16x16x32_bf16 v[116:119], a[120:123], a[196:199], v[116:119]
    v_mfma_f32_16x16x32_bf16 v[120:123], a[124:127], a[196:199], v[120:123]
    v_mfma_f32_16x16x32_bf16 v[124:127], a[128:131], a[196:199], v[124:127]
    v_mfma_f32_16x16x32_bf16 v[128:131], a[132:135], a[196:199], v[128:131]
    v_mfma_f32_16x16x32_bf16 v[132:135], a[136:139], a[196:199], v[132:135]
    s_waitcnt vmcnt(2)
    v_mfma_f32_16x16x32_bf16 v[136:139], a[120:123], a[200:203], v[136:139]
    v_mfma_f32_16x16x32_bf16 v[140:143], a[124:127], a[200:203], v[140:143]
    v_mfma_f32_16x16x32_bf16 v[144:147], a[128:131], a[200:203], v[144:147]
    v_mfma_f32_16x16x32_bf16 v[148:151], a[132:135], a[200:203], v[148:151]
    v_mfma_f32_16x16x32_bf16 v[152:155], a[136:139], a[200:203], v[152:155]
    ds_write_b128 v11, v[116:119] offset:0
    s_waitcnt vmcnt(1)
    v_mfma_f32_16x16x32_bf16 v[156:159], a[120:123], a[204:207], v[156:159]
    ds_write_b128 v11, v[120:123] offset:1024
    v_mfma_f32_16x16x32_bf16 v[160:163], a[124:127], a[204:207], v[160:163]
    ds_write_b128 v11, v[124:127] offset:2048
    v_mfma_f32_16x16x32_bf16 v[164:167], a[128:131], a[204:207], v[164:167]
    ds_write_b128 v11, v[128:131] offset:3072
    v_mfma_f32_16x16x32_bf16 v[168:171], a[132:135], a[204:207], v[168:171]
    ds_write_b128 v11, v[132:135] offset:4096
    v_mfma_f32_16x16x32_bf16 v[172:175], a[136:139], a[204:207], v[172:175]
    ds_write_b128 v12, v[136:139] offset:0
    s_waitcnt vmcnt(0)
    v_mfma_f32_16x16x32_bf16 v[96:99], a[120:123], a[192:195], v[96:99]
    ds_write_b128 v12, v[140:143] offset:1024
    v_mfma_f32_16x16x32_bf16 v[100:103], a[124:127], a[192:195], v[100:103]
    ds_write_b128 v12, v[144:147] offset:2048
    v_mfma_f32_16x16x32_bf16 v[104:107], a[128:131], a[192:195], v[104:107]
    ds_write_b128 v12, v[148:151] offset:3072
    v_mfma_f32_16x16x32_bf16 v[108:111], a[132:135], a[192:195], v[108:111]
    ds_write_b128 v12, v[152:155] offset:4096
    v_mfma_f32_16x16x32_bf16 v[112:115], a[136:139], a[192:195], v[112:115]
    ds_write_b128 v13, v[156:159] offset:0
    ds_write_b128 v13, v[160:163] offset:1024
    ds_write_b128 v13, v[164:167] offset:2048
    ds_write_b128 v13, v[168:171] offset:3072
    ds_write_b128 v13, v[172:175] offset:4096
    v_add_f32 v96, v96, v54
    v_add_f32 v97, v97, v55
    v_add_f32 v98, v98, v56
    v_add_f32 v99, v99, v57
    v_add_f32 v100, v100, v58
    v_add_f32 v101, v101, v59
    v_add_f32 v102, v102, v60
    v_add_f32 v103, v103, v61
    v_add_f32 v104, v104, v62
    v_add_f32 v105, v105, v63
    v_add_f32 v106, v106, v64
    v_add_f32 v107, v107, v65
    v_add_f32 v108, v108, v66
    v_add_f32 v109, v109, v67
    v_add_f32 v110, v110, v68
    v_add_f32 v111, v111, v69
    v_add_f32 v112, v112, v70
    v_add_f32 v113, v113, v71
    v_add_f32 v114, v114, v72
    v_add_f32 v115, v115, v73
    s_waitcnt lgkmcnt(0)
    s_barrier
    ds_read_b128 v[176:179], v10 offset:0
    ds_read_b128 v[180:183], v10 offset:1024
    ds_read_b128 v[184:187], v10 offset:2048
    ds_read_b128 v[188:191], v10 offset:3072
    ds_read_b128 v[192:195], v10 offset:4096
    ds_read_b128 v[196:199], v10 offset:5120
    ds_read_b128 v[200:203], v10 offset:6144
    ds_read_b128 v[204:207], v10 offset:7168
    ds_read_b128 v[208:211], v10 offset:8192
    ds_read_b128 v[212:215], v10 offset:9216
    ds_read_b128 v[216:219], v10 offset:10240
    ds_read_b128 v[220:223], v10 offset:11264
    ds_read_b128 v[224:227], v10 offset:12288
    ds_read_b128 v[228:231], v10 offset:13312
    ds_read_b128 v[232:235], v10 offset:14336
    s_waitcnt lgkmcnt(14)
    v_add_f32 v96, v96, v176
    v_add_f32 v97, v97, v177
    v_add_f32 v98, v98, v178
    v_add_f32 v99, v99, v179
    s_waitcnt lgkmcnt(13)
    v_add_f32 v100, v100, v180
    v_add_f32 v101, v101, v181
    v_add_f32 v102, v102, v182
    v_add_f32 v103, v103, v183
    s_waitcnt lgkmcnt(10)
    v_add_f32 v104, v104, v184
    v_add_f32 v105, v105, v185
    v_add_f32 v106, v106, v186
    v_add_f32 v107, v107, v187
    v_add_f32 v108, v108, v188
    v_add_f32 v109, v109, v189
    v_add_f32 v110, v110, v190
    v_add_f32 v111, v111, v191
    v_add_f32 v112, v112, v192
    v_add_f32 v113, v113, v193
    v_add_f32 v114, v114, v194
    v_add_f32 v115, v115, v195
    s_waitcnt lgkmcnt(0)
    v_add_f32 v96, v96, v196
    v_add_f32 v97, v97, v197
    v_add_f32 v98, v98, v198
    v_add_f32 v99, v99, v199
    v_add_f32 v100, v100, v200
    v_add_f32 v101, v101, v201
    v_add_f32 v102, v102, v202
    v_add_f32 v103, v103, v203
    v_add_f32 v104, v104, v204
    v_add_f32 v105, v105, v205
    v_add_f32 v106, v106, v206
    v_add_f32 v107, v107, v207
    v_add_f32 v108, v108, v208
    v_add_f32 v109, v109, v209
    v_add_f32 v110, v110, v210
    v_add_f32 v111, v111, v211
    v_add_f32 v112, v112, v212
    v_add_f32 v113, v113, v213
    v_add_f32 v114, v114, v214
    v_add_f32 v115, v115, v215
    v_add_f32 v96, v96, v216
    v_add_f32 v97, v97, v217
    v_add_f32 v98, v98, v218
    v_add_f32 v99, v99, v219
    v_add_f32 v100, v100, v220
    v_add_f32 v101, v101, v221
    v_add_f32 v102, v102, v222
    v_add_f32 v103, v103, v223
    v_add_f32 v104, v104, v224
    v_add_f32 v105, v105, v225
    v_add_f32 v106, v106, v226
    v_add_f32 v107, v107, v227
    v_add_f32 v108, v108, v228
    v_add_f32 v109, v109, v229
    v_add_f32 v110, v110, v230
    v_add_f32 v111, v111, v231
    v_add_f32 v112, v112, v232
    v_add_f32 v113, v113, v233
    v_add_f32 v114, v114, v234
    v_add_f32 v115, v115, v235
    v_cvt_pk_bf16_f32 v236, v96, v97
    v_cvt_pk_bf16_f32 v237, v98, v99
    v_cvt_pk_bf16_f32 v238, v100, v101
    v_cvt_pk_bf16_f32 v239, v102, v103
    v_cvt_pk_bf16_f32 v240, v104, v105
    v_cvt_pk_bf16_f32 v241, v106, v107
    v_cvt_pk_bf16_f32 v242, v108, v109
    v_cvt_pk_bf16_f32 v243, v110, v111
    v_cvt_pk_bf16_f32 v244, v112, v113
    v_cvt_pk_bf16_f32 v245, v114, v115
    buffer_store_dwordx4 v[236:239], v9, s[20:23], s55 offen
    buffer_store_dwordx4 v[240:243], v9, s[20:23], s55 offen offset:16
    buffer_store_dwordx2 v[244:245], v9, s[20:23], s55 offen offset:32
    s_endpgm
L_p1v:
    v_and_b32 v34, 15, v0
    v_lshrrev_b32 v35, 2, v34
    v_bfe_u32 v37, v0, 1, 1
    v_and_b32 v36, 1, v0
    v_lshl_add_u32 v36, v36, 1, v37
    v_lshrrev_b32 v37, 5, v0
    v_lshl_add_u32 v37, v37, 3, v35
    v_lshlrev_b32 v37, 8, v37
    v_lshl_add_u32 v37, v36, 3, v37
    v_bfe_u32 v38, v0, 4, 1
    v_lshl_add_u32 v37, v38, 5, v37
    v_xor_b32 v35, s43, v35
    s_lshl_b32 s47, s44, 13
    v_add_u32 v37, s47, v37
    v_lshl_add_u32 v13, v35, 6, v37
    v_xor_b32 v14, 0x2000, v13
    v_xor_b32 v15, 64, v13
    v_xor_b32 v16, 64, v14
    v_xor_b32 v17, 0x80, v13
    v_xor_b32 v18, 0x80, v14
    v_xor_b32 v19, 0xc0, v13
    v_xor_b32 v20, 0xc0, v14
    v_and_b32 v37, 31, v0
    v_lshlrev_b32 v38, 2, v37
    s_lshl_b32 s47, s43, 7
    s_add_u32 s48, s47, 157696
    s_sub_u32 s47, 157696, s47
    v_add_u32 v23, s48, v38
    v_add_u32 v24, s47, v38
    v_mov_b32 v226, 0
    v_mov_b32 v227, 0
    v_mov_b32 v230, 0
    v_mov_b32 v231, 0
    v_mov_b32 v234, 0
    v_mov_b32 v235, 0
    v_bfe_u32 v38, v0, 2, 1
    v_bfe_u32 v39, v0, 3, 1
    v_and_b32 v37, 0x13, v0
    v_lshl_add_u32 v37, v38, 3, v37
    v_lshl_add_u32 v37, v39, 2, v37
    v_lshrrev_b32 v38, 5, v0
    v_mul_u32_u24 v38, 10240, v38
    v_lshl_add_u32 v22, v37, 4, v38
    v_add_u32 v34, 20480, v22
    s_lshl_b32 s47, s37, 2
    s_add_u32 s47, s47, s36
    s_mul_i32 s45, s47, 40960
    s_lshl_b32 s48, s38, 11
    s_add_u32 s45, s45, s48
    s_add_u32 s45, s45, 5222400
    s_lshl_b32 s48, s43, 9
    s_mov_b32 s57, 1.0
    s_add_u32 s53, s45, s48
    s_sub_u32 s54, s45, s48
    s_add_u32 s54, s54, 512
    s_add_u32 s55, s53, 1024
    s_add_u32 s56, s54, 1024
    s_lshl_b32 s45, s94, 7
    s_add_u32 m0, s52, 16384
    s_add_u32 s45, s45, s49
    buffer_load_dwordx4 v1, s[4:7], s45 offen offset:0 lds
    buffer_load_dwordx4 v2, s[4:7], s45 offen offset:1024 lds
    buffer_load_dwordx4 v3, s[4:7], s45 offen offset:2048 lds
    buffer_load_dwordx4 v4, s[4:7], s45 offen offset:3072 lds
    s_mul_i32 s46, s94, 245760
    s_add_u32 m0, s51, 16384
    s_add_u32 s46, s46, s50
    buffer_load_dwordx4 v5, s[8:11], s46 offen offset:0 lds
    buffer_load_dwordx4 v6, s[8:11], s46 offen offset:1024 lds
    buffer_load_dwordx4 v7, s[8:11], s46 offen offset:2048 lds
    buffer_load_dwordx4 v8, s[8:11], s46 offen offset:3072 lds
    v_mov_b32 v90, 0
    v_mov_b32 v91, 0
    v_cmp_ne_u32 vcc, 0, v88
    v_lshlrev_b32 v89, 3, v89
    s_lshl_b32 s86, s86, 4
    s_add_u32 s86, s86, 20643840
    v_mov_b32 v88, 0x7ff00000
    v_cndmask_b32 v86, v89, v88, vcc
    s_waitcnt vmcnt(19)
    v_dot2c_f32_bf16 v90, s58, v92
    v_dot2c_f32_bf16 v91, v92, v92
    v_dot2c_f32_bf16 v90, s58, v93
    v_dot2c_f32_bf16 v91, v93, v93
    v_dot2c_f32_bf16 v90, s58, v94
    v_dot2c_f32_bf16 v91, v94, v94
    v_dot2c_f32_bf16 v90, s58, v95
    v_dot2c_f32_bf16 v91, v95, v95
    s_waitcnt vmcnt(18)
    v_dot2c_f32_bf16 v90, s58, v96
    v_dot2c_f32_bf16 v91, v96, v96
    v_dot2c_f32_bf16 v90, s58, v97
    v_dot2c_f32_bf16 v91, v97, v97
    v_dot2c_f32_bf16 v90, s58, v98
    v_dot2c_f32_bf16 v91, v98, v98
    v_dot2c_f32_bf16 v90, s58, v99
    v_dot2c_f32_bf16 v91, v99, v99
    s_waitcnt vmcnt(17)
    v_dot2c_f32_bf16 v90, s58, v100
    v_dot2c_f32_bf16 v91, v100, v100
    v_dot2c_f32_bf16 v90, s58, v101
    v_dot2c_f32_bf16 v91, v101, v101
    v_dot2c_f32_bf16 v90, s58, v102
    v_dot2c_f32_bf16 v91, v102, v102
    v_dot2c_f32_bf16 v90, s58, v103
    v_dot2c_f32_bf16 v91, v103, v103
    s_waitcnt vmcnt(9)
    s_barrier
    ds_read_b128 a[92:95], v9 offset:0
    ds_read_b64_tr_b16 v[40:41], v13 offset:0
    ds_read_b64_tr_b16 v[42:43], v13 offset:1024
    ds_read_b64_tr_b16 v[44:45], v15 offset:0
    ds_read_b64_tr_b16 v[46:47], v15 offset:1024
    ds_read_b64_tr_b16 v[48:49], v17 offset:0
    ds_read_b64_tr_b16 v[50:51], v17 offset:1024
    ds_read_b64_tr_b16 v[52:53], v19 offset:0
    ds_read_b64_tr_b16 v[54:55], v19 offset:1024
    ds_read_b128 a[96:99], v10 offset:0
    ds_read_b64_tr_b16 v[56:57], v13 offset:4096
    ds_read_b64_tr_b16 v[58:59], v13 offset:5120
    ds_read_b64_tr_b16 v[60:61], v15 offset:4096
    ds_read_b64_tr_b16 v[62:63], v15 offset:5120
    ds_read_b64_tr_b16 v[64:65], v17 offset:4096
    s_waitcnt lgkmcnt(14)
    ds_read_b64_tr_b16 v[66:67], v17 offset:5120
    s_waitcnt lgkmcnt(14)
    ds_read_b64_tr_b16 v[68:69], v19 offset:4096
    s_waitcnt lgkmcnt(14)
    ds_read_b64_tr_b16 v[70:71], v19 offset:5120
    v_mfma_f32_32x32x16_bf16 v[112:127], a[92:95], v[40:43], 0
    s_lshl_b32 s45, s95, 7
    s_add_u32 m0, s52, 32768
    s_add_u32 s45, s45, s49
    buffer_load_dwordx4 v1, s[4:7], s45 offen offset:0 lds
    v_mfma_f32_16x16x32_bf16 v[26:29], v[40:43], a[252:255], 0
    s_waitcnt lgkmcnt(9)
    v_mfma_f32_32x32x16_bf16 v[128:143], a[92:95], v[44:47], 0
    ds_read_b64_tr_b16 v[40:41], v14 offset:0
    ds_read_b64_tr_b16 v[42:43], v14 offset:1024
    ds_read_b128 a[100:103], v11 offset:0
    buffer_load_dwordx4 v2, s[4:7], s45 offen offset:1024 lds
    v_mfma_f32_32x32x16_bf16 v[144:159], a[92:95], v[48:51], 0
    ds_read_b64_tr_b16 v[44:45], v16 offset:0
    ds_read_b64_tr_b16 v[46:47], v16 offset:1024
    buffer_load_dwordx4 v3, s[4:7], s45 offen offset:2048 lds
    v_mfma_f32_16x16x32_bf16 v[80:83], v[48:51], a[252:255], 0
    v_mfma_f32_32x32x16_bf16 v[160:175], a[92:95], v[52:55], 0
    ds_read_b64_tr_b16 v[48:49], v18 offset:0
    s_waitcnt lgkmcnt(6)
    ds_read_b64_tr_b16 v[50:51], v18 offset:1024
    buffer_load_dwordx4 v4, s[4:7], s45 offen offset:3072 lds
    v_mfma_f32_32x32x16_bf16 v[112:127], a[96:99], v[56:59], v[112:127]
    ds_read_b64_tr_b16 v[52:53], v20 offset:0
    ds_read_b64_tr_b16 v[54:55], v20 offset:1024
    s_mul_i32 s46, s95, 245760
    s_add_u32 m0, s51, 32768
    s_add_u32 s46, s46, s50
    buffer_load_dwordx4 v5, s[8:11], s46 offen offset:0 lds
    v_mfma_f32_16x16x32_bf16 v[26:29], v[56:59], a[252:255], v[26:29]
    v_add_f32_dpp v90, v90, v90 quad_perm:[1,0,3,2] row_mask:0xf bank_mask:0xf
    v_add_f32_dpp v91, v91, v91 quad_perm:[1,0,3,2] row_mask:0xf bank_mask:0xf
    v_mfma_f32_32x32x16_bf16 v[128:143], a[96:99], v[60:63], v[128:143]
    ds_read_b64_tr_b16 v[56:57], v14 offset:4096
    ds_read_b64_tr_b16 v[58:59], v14 offset:5120
    ds_read_b128 a[104:107], v12 offset:0
    buffer_load_dwordx4 v6, s[8:11], s46 offen offset:1024 lds
    v_mfma_f32_32x32x16_bf16 v[144:159], a[96:99], v[64:67], v[144:159]
    ds_read_b64_tr_b16 v[60:61], v16 offset:4096
    ds_read_b64_tr_b16 v[62:63], v16 offset:5120
    buffer_load_dwordx4 v7, s[8:11], s46 offen offset:2048 lds
    v_mfma_f32_16x16x32_bf16 v[80:83], v[64:67], a[252:255], v[80:83]
    v_add_f32_dpp v90, v90, v90 quad_perm:[2,3,0,1] row_mask:0xf bank_mask:0xf
    v_add_f32_dpp v91, v91, v91 quad_perm:[2,3,0,1] row_mask:0xf bank_mask:0xf
    v_mfma_f32_32x32x16_bf16 v[160:175], a[96:99], v[68:71], v[160:175]
    ds_read_b64_tr_b16 v[64:65], v18 offset:4096
    s_waitcnt lgkmcnt(6)
    ds_read_b64_tr_b16 v[66:67], v18 offset:5120
    buffer_load_dwordx4 v8, s[8:11], s46 offen offset:3072 lds
    v_mfma_f32_32x32x16_bf16 v[112:127], a[100:103], v[40:43], v[112:127]
    ds_read_b64_tr_b16 v[68:69], v20 offset:4096
    ds_read_b64_tr_b16 v[70:71], v20 offset:5120
    s_waitcnt vmcnt(8)
    s_barrier
    v_add_f32_dpp v90, v90, v90 row_half_mirror row_mask:0xf bank_mask:0xf
    v_mfma_f32_32x32x16_bf16 v[128:143], a[100:103], v[44:47], v[128:143]
    ds_read_b64_tr_b16 v[40:41], v13 offset:16384
    ds_read_b64_tr_b16 v[42:43], v13 offset:17408
    ds_read_b128 a[124:127], v9 offset:16384
    s_lshl_b32 s45, s93, 7
    s_add_u32 m0, s52, 49152
    s_add_u32 s45, s45, s98
    buffer_load_dwordx4 v1, s[4:7], s45 offen offset:0 lds
    v_mfma_f32_32x32x16_bf16 v[144:159], a[100:103], v[48:51], v[144:159]
    ds_read_b64_tr_b16 v[44:45], v15 offset:16384
    ds_read_b64_tr_b16 v[46:47], v15 offset:17408
    v_add_f32_dpp v91, v91, v91 row_half_mirror row_mask:0xf bank_mask:0xf
    v_add_f32_dpp v90, v90, v90 row_mirror row_mask:0xf bank_mask:0xf
    s_nop 0
    v_add_f32_dpp v91, v91, v91 row_mirror row_mask:0xf bank_mask:0xf
    v_mov_b32 v92, v90
    v_mfma_f32_32x32x16_bf16 v[160:175], a[100:103], v[52:55], v[160:175]
    ds_read_b64_tr_b16 v[48:49], v17 offset:16384
    s_waitcnt lgkmcnt(6)
    ds_read_b64_tr_b16 v[50:51], v17 offset:17408
    buffer_load_dwordx4 v2, s[4:7], s45 offen offset:1024 lds
    v_mfma_f32_32x32x16_bf16 v[112:127], a[104:107], v[56:59], v[112:127]
    ds_read_b64_tr_b16 v[52:53], v19 offset:16384
    ds_read_b64_tr_b16 v[54:55], v19 offset:17408
    v_mov_b32 v93, v91
    v_permlane16_swap_b32 v90, v92
    s_nop 0
    v_permlane16_swap_b32 v91, v93
    v_mfma_f32_32x32x16_bf16 v[128:143], a[104:107], v[60:63], v[128:143]
    ds_read_b64_tr_b16 v[56:57], v13 offset:20480
    ds_read_b64_tr_b16 v[58:59], v13 offset:21504
    ds_read_b128 a[128:131], v10 offset:16384
    buffer_load_dwordx4 v3, s[4:7], s45 offen offset:2048 lds
    v_mfma_f32_32x32x16_bf16 v[144:159], a[104:107], v[64:67], v[144:159]
    ds_read_b64_tr_b16 v[60:61], v15 offset:20480
    ds_read_b64_tr_b16 v[62:63], v15 offset:21504
    buffer_load_dwordx4 v4, s[4:7], s45 offen offset:3072 lds
    v_mfma_f32_32x32x16_bf16 v[160:175], a[104:107], v[68:71], v[160:175]
    ds_read_b64_tr_b16 v[64:65], v17 offset:20480
    s_waitcnt lgkmcnt(8)
    ds_read_b64_tr_b16 v[66:67], v17 offset:21504
    v_add_f32 v90, v90, v92
    v_add_f32 v91, v91, v93
    v_mul_f32 v90, 0x3acccccd, v90
    v_mul_f32 v91, 0x3acccccd, v91
    v_mfma_f32_32x32x16_bf16 v[112:127], a[124:127], v[40:43], v[112:127]
    ds_read_b64_tr_b16 v[68:69], v19 offset:20480
    ds_read_b64_tr_b16 v[70:71], v19 offset:21504
    s_mul_i32 s46, s93, 245760
    s_add_u32 m0, s51, 49152
    s_add_u32 s46, s46, s99
    buffer_load_dwordx4 v5, s[8:11], s46 offen offset:0 lds
    v_mfma_f32_16x16x32_bf16 v[26:29], v[40:43], a[252:255], v[26:29]
    v_fma_f32 v91, -v90, v90, v91
    v_max_f32 v91, 0, v91
    v_mfma_f32_32x32x16_bf16 v[128:143], a[124:127], v[44:47], v[128:143]
    ds_read_b64_tr_b16 v[40:41], v14 offset:16384
    ds_read_b64_tr_b16 v[42:43], v14 offset:17408
    ds_read_b128 a[132:135], v11 offset:16384
    v_cvt_pk_bf16_f32 v84, v90, v91
    v_and_b32 v85, 0xffff0000, v84
    v_mfma_f32_32x32x16_bf16 v[144:159], a[124:127], v[48:51], v[144:159]
    ds_read_b64_tr_b16 v[44:45], v16 offset:16384
    s_waitcnt lgkmcnt(6)
    ds_read_b64_tr_b16 v[46:47], v16 offset:17408
    v_and_b32 v84, 0xffff, v84
    v_add_f32 v85, 0x3727c5ac, v85
    v_xor_b32 v84, 0x8000, v84
    v_cvt_pk_bf16_f32 v85, v85, v85
    v_mfma_f32_16x16x32_bf16 v[80:83], v[48:51], a[252:255], v[80:83]
    v_lshlrev_b32 v85, 16, v85
    v_lshrrev_b32 v104, 4, v0
    v_mfma_f32_32x32x16_bf16 v[160:175], a[124:127], v[52:55], v[160:175]
    ds_read_b64_tr_b16 v[48:49], v18 offset:16384
    ds_read_b64_tr_b16 v[50:51], v18 offset:17408
    buffer_load_dwordx4 v6, s[8:11], s46 offen offset:1024 lds
    v_mfma_f32_32x32x16_bf16 v[112:127], a[128:131], v[56:59], v[112:127]
    ds_read_b64_tr_b16 v[52:53], v20 offset:16384
    ds_read_b64_tr_b16 v[54:55], v20 offset:17408
    buffer_load_dwordx4 v7, s[8:11], s46 offen offset:2048 lds
    v_mfma_f32_16x16x32_bf16 v[26:29], v[56:59], a[252:255], v[26:29]
    v_sqrt_f32 v85, v85
    v_mfma_f32_32x32x16_bf16 v[128:143], a[128:131], v[60:63], v[128:143]
    ds_read_b64_tr_b16 v[56:57], v14 offset:20480
    ds_read_b64_tr_b16 v[58:59], v14 offset:21504
    ds_read_b128 a[136:139], v12 offset:16384
    v_cvt_pk_bf16_f32 v85, v85, v85
    v_lshlrev_b32 v85, 16, v85
    v_mfma_f32_32x32x16_bf16 v[144:159], a[128:131], v[64:67], v[144:159]
    ds_read_b64_tr_b16 v[60:61], v16 offset:20480
    s_waitcnt lgkmcnt(6)
    ds_read_b64_tr_b16 v[62:63], v16 offset:21504
    buffer_load_dwordx4 v8, s[8:11], s46 offen offset:3072 lds
    v_mfma_f32_16x16x32_bf16 v[80:83], v[64:67], a[252:255], v[80:83]
    v_and_b32 v105, 15, v0
    v_lshlrev_b32 v107, 2, v104
    v_mfma_f32_32x32x16_bf16 v[160:175], a[128:131], v[68:71], v[160:175]
    ds_read_b64_tr_b16 v[64:65], v18 offset:20480
    ds_read_b64_tr_b16 v[66:67], v18 offset:21504
    v_xor_b32 v108, v105, v107
    v_lshrrev_b32 v105, 3, v108
    v_mul_u32_u24 v105, 320, v105
    v_add_u32 v104, v105, v104
    v_mfma_f32_32x32x16_bf16 v[112:127], a[132:135], v[40:43], v[112:127]
    ds_read_b64_tr_b16 v[68:69], v20 offset:20480
    ds_read_b64_tr_b16 v[70:71], v20 offset:21504
    s_waitcnt vmcnt(8)
    s_barrier
    v_and_b32 v250, 3, v0
    v_mfma_f32_32x32x16_bf16 v[128:143], a[132:135], v[44:47], v[128:143]
    ds_read_b64_tr_b16 v[40:41], v13 offset:32768
    ds_read_b64_tr_b16 v[42:43], v13 offset:33792
    ds_read_b128 a[156:159], v9 offset:32768
    s_lshl_b32 s45, s96, 7
    s_add_u32 m0, s52, 0
    s_add_u32 s45, s45, s49
    buffer_load_dwordx4 v1, s[4:7], s45 offen offset:0 lds
    v_lshlrev_b32 v250, 2, v250
    v_mfma_f32_32x32x16_bf16 v[144:159], a[132:135], v[48:51], v[144:159]
    ds_read_b64_tr_b16 v[44:45], v15 offset:32768
    s_waitcnt lgkmcnt(6)
    ds_read_b64_tr_b16 v[46:47], v15 offset:33792
    v_mul_u32_u24 v106, 3456, v104
    v_and_b32 v108, 7, v108
    v_lshl_add_u32 v236, v108, 4, v106
    v_add_u32 v237, 12800, v236
    v_mfma_f32_32x32x16_bf16 v[160:175], a[132:135], v[52:55], v[160:175]
    ds_read_b64_tr_b16 v[48:49], v17 offset:32768
    ds_read_b64_tr_b16 v[50:51], v17 offset:33792
    buffer_load_dwordx4 v2, s[4:7], s45 offen offset:1024 lds
    buffer_load_dword v251, v250, s[24:27], 0 offen sc1
    v_mfma_f32_32x32x16_bf16 v[112:127], a[136:139], v[56:59], v[112:127]
    ds_read_b64_tr_b16 v[52:53], v19 offset:32768
    ds_read_b64_tr_b16 v[54:55], v19 offset:33792
    v_add_u32 v238, 25600, v236
    v_add_u32 v239, 38400, v236
    v_mfma_f32_32x32x16_bf16 v[128:143], a[136:139], v[60:63], v[128:143]
    ds_read_b64_tr_b16 v[56:57], v13 offset:36864
    ds_read_b64_tr_b16 v[58:59], v13 offset:37888
    ds_read_b128 a[160:163], v10 offset:32768
    buffer_load_dwordx4 v3, s[4:7], s45 offen offset:2048 lds
    v_mfma_f32_32x32x16_bf16 v[144:159], a[136:139], v[64:67], v[144:159]
    ds_read_b64_tr_b16 v[60:61], v15 offset:36864
    s_waitcnt lgkmcnt(8)
    ds_read_b64_tr_b16 v[62:63], v15 offset:37888
    buffer_load_dwordx4 v4, s[4:7], s45 offen offset:3072 lds
    v_mfma_f32_32x32x16_bf16 v[160:175], a[136:139], v[68:71], v[160:175]
    ds_read_b64_tr_b16 v[64:65], v17 offset:36864
    ds_read_b64_tr_b16 v[66:67], v17 offset:37888
    v_mfma_f32_32x32x16_bf16 v[112:127], a[156:159], v[40:43], v[112:127]
    ds_read_b64_tr_b16 v[68:69], v19 offset:36864
    ds_read_b64_tr_b16 v[70:71], v19 offset:37888
    s_mul_i32 s46, s96, 245760
    s_add_u32 m0, s51, 0
    s_add_u32 s46, s46, s50
    buffer_load_dwordx4 v5, s[8:11], s46 offen offset:0 lds
    v_mfma_f32_16x16x32_bf16 v[26:29], v[40:43], a[252:255], v[26:29]
    s_lshl_b32 s92, s37, 2
    s_add_u32 s92, s92, s36
    v_mfma_f32_32x32x16_bf16 v[128:143], a[156:159], v[44:47], v[128:143]
    ds_read_b64_tr_b16 v[40:41], v14 offset:32768
    ds_read_b64_tr_b16 v[42:43], v14 offset:33792
    s_waitcnt lgkmcnt(6)
    ds_read_b128 a[164:167], v11 offset:32768
    s_lshl_b32 s92, s92, 4
    s_add_u32 s92, s92, s38
    v_mfma_f32_32x32x16_bf16 v[144:159], a[156:159], v[48:51], v[144:159]
    ds_read_b64_tr_b16 v[44:45], v16 offset:32768
    ds_read_b64_tr_b16 v[46:47], v16 offset:33792
    s_lshl_b32 s92, s92, 4
    s_add_u32 s92, s92, 20594688
    v_mfma_f32_16x16x32_bf16 v[80:83], v[48:51], a[252:255], v[80:83]
    v_mfma_f32_32x32x16_bf16 v[160:175], a[156:159], v[52:55], v[160:175]
    ds_read_b64_tr_b16 v[48:49], v18 offset:32768
    ds_read_b64_tr_b16 v[50:51], v18 offset:33792
    buffer_load_dwordx4 v6, s[8:11], s46 offen offset:1024 lds
    v_mfma_f32_32x32x16_bf16 v[112:127], a[160:163], v[56:59], v[112:127]
    ds_read_b64_tr_b16 v[52:53], v20 offset:32768
    ds_read_b64_tr_b16 v[54:55], v20 offset:33792
    buffer_load_dwordx4 v7, s[8:11], s46 offen offset:2048 lds
    v_mfma_f32_16x16x32_bf16 v[26:29], v[56:59], a[252:255], v[26:29]
    v_mfma_f32_32x32x16_bf16 v[128:143], a[160:163], v[60:63], v[128:143]
    ds_read_b64_tr_b16 v[56:57], v14 offset:36864
    ds_read_b64_tr_b16 v[58:59], v14 offset:37888
    s_waitcnt lgkmcnt(6)
    ds_read_b128 a[168:171], v12 offset:32768
    v_mfma_f32_32x32x16_bf16 v[144:159], a[160:163], v[64:67], v[144:159]
    ds_read_b64_tr_b16 v[60:61], v16 offset:36864
    ds_read_b64_tr_b16 v[62:63], v16 offset:37888
    buffer_load_dwordx4 v8, s[8:11], s46 offen offset:3072 lds
    v_mfma_f32_16x16x32_bf16 v[80:83], v[64:67], a[252:255], v[80:83]
    v_mfma_f32_32x32x16_bf16 v[160:175], a[160:163], v[68:71], v[160:175]
    ds_read_b64_tr_b16 v[64:65], v18 offset:36864
    ds_read_b64_tr_b16 v[66:67], v18 offset:37888
    v_mfma_f32_32x32x16_bf16 v[112:127], a[164:167], v[40:43], v[112:127]
    ds_read_b64_tr_b16 v[68:69], v20 offset:36864
    ds_read_b64_tr_b16 v[70:71], v20 offset:37888
    s_waitcnt vmcnt(9)
    s_barrier
    v_mfma_f32_32x32x16_bf16 v[128:143], a[164:167], v[44:47], v[128:143]
    ds_read_b64_tr_b16 v[40:41], v13 offset:49152
    ds_read_b64_tr_b16 v[42:43], v13 offset:50176
    s_waitcnt lgkmcnt(8)
    ds_read_b128 a[108:111], v9 offset:49152
    s_lshl_b32 s45, s97, 7
    s_add_u32 m0, s52, 16384
    s_add_u32 s45, s45, s49
    buffer_load_dwordx4 v1, s[4:7], s45 offen offset:0 lds
    v_mfma_f32_32x32x16_bf16 v[144:159], a[164:167], v[48:51], v[144:159]
    ds_read_b64_tr_b16 v[44:45], v15 offset:49152
    ds_read_b64_tr_b16 v[46:47], v15 offset:50176
    v_mfma_f32_32x32x16_bf16 v[160:175], a[164:167], v[52:55], v[160:175]
    ds_read_b64_tr_b16 v[48:49], v17 offset:49152
    ds_read_b64_tr_b16 v[50:51], v17 offset:50176
    buffer_load_dwordx4 v2, s[4:7], s45 offen offset:1024 lds
    v_mfma_f32_32x32x16_bf16 v[112:127], a[168:171], v[56:59], v[112:127]
    ds_read_b64_tr_b16 v[52:53], v19 offset:49152
    ds_read_b64_tr_b16 v[54:55], v19 offset:50176
    s_waitcnt lgkmcnt(8)
    v_mfma_f32_32x32x16_bf16 v[128:143], a[168:171], v[60:63], v[128:143]
    ds_read_b64_tr_b16 v[56:57], v13 offset:53248
    ds_read_b64_tr_b16 v[58:59], v13 offset:54272
    ds_read_b128 a[112:115], v10 offset:49152
    buffer_load_dwordx4 v3, s[4:7], s45 offen offset:2048 lds
    v_mfma_f32_32x32x16_bf16 v[144:159], a[168:171], v[64:67], v[144:159]
    ds_read_b64_tr_b16 v[60:61], v15 offset:53248
    ds_read_b64_tr_b16 v[62:63], v15 offset:54272
    buffer_load_dwordx4 v4, s[4:7], s45 offen offset:3072 lds
    v_mfma_f32_32x32x16_bf16 v[160:175], a[168:171], v[68:71], v[160:175]
    ds_read_b64_tr_b16 v[64:65], v17 offset:53248
    ds_read_b64_tr_b16 v[66:67], v17 offset:54272
    s_waitcnt lgkmcnt(9)
    v_mfma_f32_32x32x16_bf16 v[112:127], a[108:111], v[40:43], v[112:127]
    ds_read_b64_tr_b16 v[68:69], v19 offset:53248
    ds_read_b64_tr_b16 v[70:71], v19 offset:54272
    s_mul_i32 s46, s97, 245760
    s_add_u32 m0, s51, 16384
    s_add_u32 s46, s46, s50
    buffer_load_dwordx4 v5, s[8:11], s46 offen offset:0 lds
    v_mfma_f32_16x16x32_bf16 v[26:29], v[40:43], a[252:255], v[26:29]
    v_mfma_f32_32x32x16_bf16 v[128:143], a[108:111], v[44:47], v[128:143]
    ds_read_b64_tr_b16 v[40:41], v14 offset:49152
    ds_read_b64_tr_b16 v[42:43], v14 offset:50176
    ds_read_b128 a[116:119], v11 offset:49152
    v_mfma_f32_32x32x16_bf16 v[144:159], a[108:111], v[48:51], v[144:159]
    ds_read_b64_tr_b16 v[44:45], v16 offset:49152
    s_waitcnt lgkmcnt(7)
    ds_read_b64_tr_b16 v[46:47], v16 offset:50176
    v_mfma_f32_16x16x32_bf16 v[80:83], v[48:51], a[252:255], v[80:83]
    v_mfma_f32_32x32x16_bf16 v[160:175], a[108:111], v[52:55], v[160:175]
    ds_read_b64_tr_b16 v[48:49], v18 offset:49152
    ds_read_b64_tr_b16 v[50:51], v18 offset:50176
    buffer_load_dwordx4 v6, s[8:11], s46 offen offset:1024 lds
    v_mfma_f32_32x32x16_bf16 v[112:127], a[112:115], v[56:59], v[112:127]
    ds_read_b64_tr_b16 v[52:53], v20 offset:49152
    ds_read_b64_tr_b16 v[54:55], v20 offset:50176
    buffer_load_dwordx4 v7, s[8:11], s46 offen offset:2048 lds
    s_waitcnt vmcnt(13)
    v_cmp_ne_u32 vcc, 0, v251
    s_nop 0
    s_cmp_eq_u64 vcc, -1
    s_cbranch_scc0 L_spin6
L_back6:
    buffer_store_dwordx2 v[84:85], v86, s[16:19], s86 offen sc1
    v_mfma_f32_16x16x32_bf16 v[26:29], v[56:59], a[252:255], v[26:29]
    v_mfma_f32_32x32x16_bf16 v[128:143], a[112:115], v[60:63], v[128:143]
    ds_read_b64_tr_b16 v[56:57], v14 offset:53248
    ds_read_b64_tr_b16 v[58:59], v14 offset:54272
    ds_read_b128 a[120:123], v12 offset:49152
    s_waitcnt lgkmcnt(6)
    v_mfma_f32_32x32x16_bf16 v[144:159], a[112:115], v[64:67], v[144:159]
    ds_read_b64_tr_b16 v[60:61], v16 offset:53248
    ds_read_b64_tr_b16 v[62:63], v16 offset:54272
    buffer_load_dwordx4 v8, s[8:11], s46 offen offset:3072 lds
    v_mfma_f32_16x16x32_bf16 v[80:83], v[64:67], a[252:255], v[80:83]
    v_mfma_f32_32x32x16_bf16 v[160:175], a[112:115], v[68:71], v[160:175]
    ds_read_b64_tr_b16 v[64:65], v18 offset:53248
    ds_read_b64_tr_b16 v[66:67], v18 offset:54272
    v_mfma_f32_32x32x16_bf16 v[112:127], a[116:119], v[40:43], v[112:127]
    ds_read_b64_tr_b16 v[68:69], v20 offset:53248
    ds_read_b64_tr_b16 v[70:71], v20 offset:54272
    s_waitcnt vmcnt(9)
    s_barrier
    v_mfma_f32_32x32x16_bf16 v[128:143], a[116:119], v[44:47], v[128:143]
    ds_read_b64_tr_b16 v[40:41], v13 offset:0
    ds_read_b64_tr_b16 v[42:43], v13 offset:1024
    ds_read_b128 a[188:191], v9 offset:0
    s_lshl_b32 s45, s94, 7
    s_add_u32 m0, s52, 32768
    s_add_u32 s45, s45, s98
    buffer_load_dwordx4 v1, s[4:7], s45 offen offset:0 lds
    s_waitcnt lgkmcnt(7)
    v_mfma_f32_32x32x16_bf16 v[144:159], a[116:119], v[48:51], v[144:159]
    ds_read_b64_tr_b16 v[44:45], v15 offset:0
    ds_read_b64_tr_b16 v[46:47], v15 offset:1024
    v_mfma_f32_32x32x16_bf16 v[160:175], a[116:119], v[52:55], v[160:175]
    ds_read_b64_tr_b16 v[48:49], v17 offset:0
    ds_read_b64_tr_b16 v[50:51], v17 offset:1024
    buffer_load_dwordx4 v2, s[4:7], s45 offen offset:1024 lds
    v_mfma_f32_32x32x16_bf16 v[112:127], a[120:123], v[56:59], v[112:127]
    ds_read_b64_tr_b16 v[52:53], v19 offset:0
    ds_read_b64_tr_b16 v[54:55], v19 offset:1024
    v_mfma_f32_32x32x16_bf16 v[128:143], a[120:123], v[60:63], v[128:143]
    ds_read_b64_tr_b16 v[56:57], v13 offset:4096
    ds_read_b64_tr_b16 v[58:59], v13 offset:5120
    s_waitcnt lgkmcnt(8)
    ds_read_b128 a[192:195], v10 offset:0
    buffer_load_dwordx4 v3, s[4:7], s45 offen offset:2048 lds
    s_mov_b32 s74, s59
    s_mov_b32 s75, s60
    s_mul_i32 s89, s36, 55296
    s_lshl_b32 s59, s59, 7
    s_lshl_b32 s60, s60, 7
    s_add_u32 s59, s59, s89
    s_add_u32 s60, s60, s89
    s_cmp_lt_u32 s38, 12
    s_cselect_b32 s60, s60, 2146435072
    v_mfma_f32_32x32x16_bf16 v[144:159], a[120:123], v[64:67], v[144:159]
    ds_read_b64_tr_b16 v[60:61], v15 offset:4096
    ds_read_b64_tr_b16 v[62:63], v15 offset:5120
    buffer_load_dwordx4 v4, s[4:7], s45 offen offset:3072 lds
    v_mfma_f32_32x32x16_bf16 v[160:175], a[120:123], v[68:71], v[160:175]
    ds_read_b64_tr_b16 v[64:65], v17 offset:4096
    ds_read_b64_tr_b16 v[66:67], v17 offset:5120
    v_mfma_f32_32x32x16_bf16 v[112:127], a[188:191], v[40:43], v[112:127]
    ds_read_b64_tr_b16 v[68:69], v19 offset:4096
    ds_read_b64_tr_b16 v[70:71], v19 offset:5120
    s_mul_i32 s46, s94, 245760
    s_add_u32 m0, s51, 32768
    s_add_u32 s46, s46, s99
    buffer_load_dwordx4 v5, s[8:11], s46 offen offset:0 lds
    v_mfma_f32_16x16x32_bf16 v[26:29], v[40:43], a[252:255], v[26:29]
    s_waitcnt lgkmcnt(6)
    v_mfma_f32_32x32x16_bf16 v[128:143], a[188:191], v[44:47], v[128:143]
    ds_read_b64_tr_b16 v[40:41], v14 offset:0
    ds_read_b64_tr_b16 v[42:43], v14 offset:1024
    ds_read_b128 a[196:199], v11 offset:0
    v_mfma_f32_32x32x16_bf16 v[144:159], a[188:191], v[48:51], v[144:159]
    ds_read_b64_tr_b16 v[44:45], v16 offset:0
    ds_read_b64_tr_b16 v[46:47], v16 offset:1024
    v_mfma_f32_16x16x32_bf16 v[80:83], v[48:51], a[252:255], v[80:83]
    v_mfma_f32_32x32x16_bf16 v[160:175], a[188:191], v[52:55], v[160:175]
    ds_read_b64_tr_b16 v[48:49], v18 offset:0
    ds_read_b64_tr_b16 v[50:51], v18 offset:1024
    buffer_load_dwordx4 v6, s[8:11], s46 offen offset:1024 lds
    s_lshl_b32 s47, s37, 2
    s_add_u32 s47, s47, s36
    s_lshl_b32 s47, s47, 8
    s_add_u32 s47, s47, 20643840
    v_and_b32 v30, 31, v0
    v_lshl_add_u32 v30, v30, 3, s47
    v_mfma_f32_32x32x16_bf16 v[112:127], a[192:195], v[56:59], v[112:127]
    ds_read_b64_tr_b16 v[52:53], v20 offset:0
    ds_read_b64_tr_b16 v[54:55], v20 offset:1024
    buffer_load_dwordx4 v7, s[8:11], s46 offen offset:2048 lds
    v_mfma_f32_16x16x32_bf16 v[26:29], v[56:59], a[252:255], v[26:29]
    v_lshrrev_b32 v37, 3, v0
    v_and_b32 v38, 7, v0
    s_waitcnt lgkmcnt(4)
    v_mfma_f32_32x32x16_bf16 v[128:143], a[192:195], v[60:63], v[128:143]
    ds_read_b64_tr_b16 v[56:57], v14 offset:4096
    ds_read_b64_tr_b16 v[58:59], v14 offset:5120
    ds_read_b128 a[200:203], v12 offset:0
    s_mul_i32 s47, s43, 6
    s_lshl_b32 s48, s39, 2
    v_mfma_f32_32x32x16_bf16 v[144:159], a[192:195], v[64:67], v[144:159]
    ds_read_b64_tr_b16 v[60:61], v16 offset:4096
    ds_read_b64_tr_b16 v[62:63], v16 offset:5120
    buffer_load_dwordx4 v8, s[8:11], s46 offen offset:3072 lds
    v_mfma_f32_16x16x32_bf16 v[80:83], v[64:67], a[252:255], v[80:83]
    s_add_u32 s47, s47, s48
    s_sub_u32 s47, s47, 8
    v_mfma_f32_32x32x16_bf16 v[160:175], a[192:195], v[68:71], v[160:175]
    ds_read_b64_tr_b16 v[64:65], v18 offset:4096
    ds_read_b64_tr_b16 v[66:67], v18 offset:5120
    s_add_u32 s48, s48, s36
    v_add_u32 v39, s47, v37
    v_mov_b32 v250, s48
    v_cmp_gt_u32 vcc, 6, v37
    v_mfma_f32_32x32x16_bf16 v[112:127], a[196:199], v[40:43], v[112:127]
    ds_read_b64_tr_b16 v[68:69], v20 offset:4096
    ds_read_b64_tr_b16 v[70:71], v20 offset:5120
    s_waitcnt vmcnt(8)
    s_barrier
    s_lshl_b32 s45, s95, 7
    s_add_u32 m0, s52, 49152
    s_add_u32 s45, s45, s98
    buffer_load_dwordx4 v1, s[4:7], s45 offen offset:0 lds
    v_mfma_f32_32x32x16_bf16 v[128:143], a[196:199], v[44:47], v[128:143]
    ds_read_b64_tr_b16 v[40:41], v13 offset:16384
    ds_read_b64_tr_b16 v[42:43], v13 offset:17408
    s_waitcnt lgkmcnt(6)
    ds_read_b128 a[220:223], v9 offset:16384
    v_cndmask_b32 v39, v250, v39, vcc
    s_mul_i32 s47, s44, 5
    v_mfma_f32_32x32x16_bf16 v[144:159], a[196:199], v[48:51], v[144:159]
    ds_read_b64_tr_b16 v[44:45], v15 offset:16384
    ds_read_b64_tr_b16 v[46:47], v15 offset:17408
    buffer_load_dwordx4 v2, s[4:7], s45 offen offset:1024 lds
    v_mfma_f32_32x32x16_bf16 v[160:175], a[196:199], v[52:55], v[160:175]
    ds_read_b64_tr_b16 v[48:49], v17 offset:16384
    ds_read_b64_tr_b16 v[50:51], v17 offset:17408
    buffer_load_dwordx4 v3, s[4:7], s45 offen offset:2048 lds
    v_mfma_f32_32x32x16_bf16 v[112:127], a[200:203], v[56:59], v[112:127]
    ds_read_b64_tr_b16 v[52:53], v19 offset:16384
    ds_read_b64_tr_b16 v[54:55], v19 offset:17408
    buffer_load_dwordx4 v4, s[4:7], s45 offen offset:3072 lds
    v_mfma_f32_32x32x16_bf16 v[128:143], a[200:203], v[60:63], v[128:143]
    ds_read_b64_tr_b16 v[56:57], v13 offset:20480
    ds_read_b64_tr_b16 v[58:59], v13 offset:21504
    s_waitcnt lgkmcnt(8)
    ds_read_b128 a[224:227], v10 offset:16384
    s_mul_i32 s46, s95, 245760
    s_add_u32 m0, s51, 49152
    s_add_u32 s46, s46, s99
    buffer_load_dwordx4 v5, s[8:11], s46 offen offset:0 lds
    v_mfma_f32_32x32x16_bf16 v[144:159], a[200:203], v[64:67], v[144:159]
    ds_read_b64_tr_b16 v[60:61], v15 offset:20480
    ds_read_b64_tr_b16 v[62:63], v15 offset:21504
    s_add_u32 s47, s47, 5
    v_mov_b32 v250, s47
    v_cndmask_b32_e64 v250, 0, v250, vcc
    v_add_u32 v250, v250, v38
    v_mfma_f32_32x32x16_bf16 v[160:175], a[200:203], v[68:71], v[160:175]
    ds_read_b64_tr_b16 v[64:65], v17 offset:20480
    ds_read_b64_tr_b16 v[66:67], v17 offset:21504
    buffer_load_dwordx4 v6, s[8:11], s46 offen offset:1024 lds
    v_mfma_f32_32x32x16_bf16 v[112:127], a[220:223], v[40:43], v[112:127]
    ds_read_b64_tr_b16 v[68:69], v19 offset:20480
    ds_read_b64_tr_b16 v[70:71], v19 offset:21504
    buffer_load_dwordx4 v7, s[8:11], s46 offen offset:2048 lds
    v_mfma_f32_16x16x32_bf16 v[26:29], v[40:43], a[252:255], v[26:29]
    v_lshlrev_b32 v250, 4, v250
    v_lshl_add_u32 v250, v39, 8, v250
    s_waitcnt lgkmcnt(6)
    v_mfma_f32_32x32x16_bf16 v[128:143], a[220:223], v[44:47], v[128:143]
    ds_read_b64_tr_b16 v[40:41], v14 offset:16384
    ds_read_b64_tr_b16 v[42:43], v14 offset:17408
    ds_read_b128 a[228:231], v11 offset:16384
    buffer_load_dwordx4 v8, s[8:11], s46 offen offset:3072 lds
    v_mfma_f32_32x32x16_bf16 v[144:159], a[220:223], v[48:51], v[144:159]
    ds_read_b64_tr_b16 v[44:45], v16 offset:16384
    ds_read_b64_tr_b16 v[46:47], v16 offset:17408
    s_mul_i32 s46, s93, 221184
    s_add_u32 m0, s51, 131072
    s_add_u32 s46, s46, s59
    buffer_load_dwordx4 v236, s[12:15], s46 offen offset:0 lds
    v_mfma_f32_16x16x32_bf16 v[80:83], v[48:51], a[252:255], v[80:83]
    v_add_u32 v250, 20594688, v250
    v_cmp_gt_i32 s[62:63], 0, v39
    v_mfma_f32_32x32x16_bf16 v[160:175], a[220:223], v[52:55], v[160:175]
    ds_read_b64_tr_b16 v[48:49], v18 offset:16384
    ds_read_b64_tr_b16 v[50:51], v18 offset:17408
    s_mul_i32 s47, s40, 40
    s_add_u32 s48, s47, 39
    s_lshr_b32 s47, s47, 7
    s_lshr_b32 s48, s48, 7
    v_mfma_f32_32x32x16_bf16 v[112:127], a[224:227], v[56:59], v[112:127]
    ds_read_b64_tr_b16 v[52:53], v20 offset:16384
    ds_read_b64_tr_b16 v[54:55], v20 offset:17408
    buffer_load_dwordx4 v237, s[12:15], s46 offen offset:1024 lds
    v_mfma_f32_16x16x32_bf16 v[26:29], v[56:59], a[252:255], v[26:29]
    v_cmp_gt_u32 vcc, s47, v38
    s_waitcnt lgkmcnt(4)
    v_mfma_f32_32x32x16_bf16 v[128:143], a[224:227], v[60:63], v[128:143]
    ds_read_b64_tr_b16 v[56:57], v14 offset:20480
    ds_read_b64_tr_b16 v[58:59], v14 offset:21504
    ds_read_b128 a[232:235], v12 offset:16384
    buffer_load_dwordx4 v238, s[12:15], s46 offen offset:2048 lds
    v_mfma_f32_32x32x16_bf16 v[144:159], a[224:227], v[64:67], v[144:159]
    ds_read_b64_tr_b16 v[60:61], v16 offset:20480
    ds_read_b64_tr_b16 v[62:63], v16 offset:21504
    buffer_load_dwordx4 v239, s[12:15], s46 offen offset:3072 lds
    v_mfma_f32_16x16x32_bf16 v[80:83], v[64:67], a[252:255], v[80:83]
    s_or_b64 s[62:63], s[62:63], vcc
    v_cmp_lt_u32 vcc, s48, v38
    v_mfma_f32_32x32x16_bf16 v[160:175], a[224:227], v[68:71], v[160:175]
    ds_read_b64_tr_b16 v[64:65], v18 offset:20480
    ds_read_b64_tr_b16 v[66:67], v18 offset:21504
    s_or_b64 s[62:63], s[62:63], vcc
    s_or_b32 s63, s63, 0xff000000
    v_cndmask_b32_e64 v250, v250, v252, s[62:63]
    v_mfma_f32_32x32x16_bf16 v[112:127], a[228:231], v[40:43], v[112:127]
    ds_read_b64_tr_b16 v[68:69], v20 offset:20480
    ds_read_b64_tr_b16 v[70:71], v20 offset:21504
    s_waitcnt vmcnt(12)
    s_barrier
    v_mfma_f32_32x32x16_bf16 v[128:143], a[228:231], v[44:47], v[128:143]
    ds_read_b64_tr_b16 v[40:41], v13 offset:32768
    ds_read_b64_tr_b16 v[42:43], v13 offset:33792
    s_waitcnt lgkmcnt(6)
    ds_read_b128 a[140:143], v9 offset:32768
    s_lshl_b32 s45, s96, 7
    s_add_u32 m0, s52, 0
    s_add_u32 s45, s45, s98
    buffer_load_dwordx4 v1, s[4:7], s45 offen offset:0 lds
    v_mfma_f32_32x32x16_bf16 v[144:159], a[228:231], v[48:51], v[144:159]
    ds_read_b64_tr_b16 v[44:45], v15 offset:32768
    ds_read_b64_tr_b16 v[46:47], v15 offset:33792
    v_mfma_f32_32x32x16_bf16 v[160:175], a[228:231], v[52:55], v[160:175]
    ds_read_b64_tr_b16 v[48:49], v17 offset:32768
    ds_read_b64_tr_b16 v[50:51], v17 offset:33792
    buffer_load_dwordx4 v2, s[4:7], s45 offen offset:1024 lds
    v_mfma_f32_32x32x16_bf16 v[112:127], a[232:235], v[56:59], v[112:127]
    ds_read_b64_tr_b16 v[52:53], v19 offset:32768
    ds_read_b64_tr_b16 v[54:55], v19 offset:33792
    v_mfma_f32_32x32x16_bf16 v[128:143], a[232:235], v[60:63], v[128:143]
    ds_read_b64_tr_b16 v[56:57], v13 offset:36864
    ds_read_b64_tr_b16 v[58:59], v13 offset:37888
    s_waitcnt lgkmcnt(8)
    ds_read_b128 a[144:147], v10 offset:32768
    buffer_load_dwordx4 v3, s[4:7], s45 offen offset:2048 lds
    v_mfma_f32_32x32x16_bf16 v[144:159], a[232:235], v[64:67], v[144:159]
    ds_read_b64_tr_b16 v[60:61], v15 offset:36864
    ds_read_b64_tr_b16 v[62:63], v15 offset:37888
    buffer_load_dwordx4 v4, s[4:7], s45 offen offset:3072 lds
    v_mfma_f32_32x32x16_bf16 v[160:175], a[232:235], v[68:71], v[160:175]
    ds_read_b64_tr_b16 v[64:65], v17 offset:36864
    ds_read_b64_tr_b16 v[66:67], v17 offset:37888
    v_mfma_f32_32x32x16_bf16 v[112:127], a[140:143], v[40:43], v[112:127]
    ds_read_b64_tr_b16 v[68:69], v19 offset:36864
    ds_read_b64_tr_b16 v[70:71], v19 offset:37888
    s_mul_i32 s46, s96, 245760
    s_add_u32 m0, s51, 0
    s_add_u32 s46, s46, s99
    buffer_load_dwordx4 v5, s[8:11], s46 offen offset:0 lds
    v_mfma_f32_16x16x32_bf16 v[26:29], v[40:43], a[252:255], v[26:29]
    s_waitcnt lgkmcnt(6)
    v_mfma_f32_32x32x16_bf16 v[128:143], a[140:143], v[44:47], v[128:143]
    ds_read_b64_tr_b16 v[40:41], v14 offset:32768
    ds_read_b64_tr_b16 v[42:43], v14 offset:33792
    ds_read_b128 a[148:151], v11 offset:32768
    v_mfma_f32_32x32x16_bf16 v[144:159], a[140:143], v[48:51], v[144:159]
    ds_read_b64_tr_b16 v[44:45], v16 offset:32768
    ds_read_b64_tr_b16 v[46:47], v16 offset:33792
    s_mul_i32 s76, s44, 1229
    s_add_u32 s76, s76, 410
    s_lshl_b32 s82, s44, 1
    s_lshr_b32 s77, 160, s82
    s_lshr_b32 s80, 2560, s82
    s_lshr_b32 s79, 163840, s44
    s_add_u32 s82, s82, s44
    s_lshr_b32 s78, 81920, s82
    s_mul_i32 s81, s44, 5201920
    s_add_u32 s81, s81, 40960
    s_mul_i32 s80, s80, s40
    s_add_u32 s81, s81, s80
    s_lshl_b32 s82, s39, 1
    s_mul_i32 s80, s43, 3
    s_add_u32 s82, s82, s80
    s_sub_u32 s82, s82, 4
    s_mul_i32 s80, s36, 15360
    s_add_u32 s80, s80, 65536
    v_mfma_f32_16x16x32_bf16 v[80:83], v[48:51], a[252:255], v[80:83]
    v_mfma_f32_32x32x16_bf16 v[160:175], a[140:143], v[52:55], v[160:175]
    ds_read_b64_tr_b16 v[48:49], v18 offset:32768
    ds_read_b64_tr_b16 v[50:51], v18 offset:33792
    buffer_load_dwordx4 v6, s[8:11], s46 offen offset:1024 lds
    v_mfma_f32_32x32x16_bf16 v[112:127], a[144:147], v[56:59], v[112:127]
    ds_read_b64_tr_b16 v[52:53], v20 offset:32768
    ds_read_b64_tr_b16 v[54:55], v20 offset:33792
    buffer_load_dwordx4 v7, s[8:11], s46 offen offset:2048 lds
    v_mfma_f32_16x16x32_bf16 v[26:29], v[56:59], a[252:255], v[26:29]
    s_waitcnt lgkmcnt(4)
    v_mfma_f32_32x32x16_bf16 v[128:143], a[144:147], v[60:63], v[128:143]
    ds_read_b64_tr_b16 v[56:57], v14 offset:36864
    ds_read_b64_tr_b16 v[58:59], v14 offset:37888
    ds_read_b128 a[152:155], v12 offset:32768
    v_mfma_f32_32x32x16_bf16 v[144:159], a[144:147], v[64:67], v[144:159]
    ds_read_b64_tr_b16 v[60:61], v16 offset:36864
    ds_read_b64_tr_b16 v[62:63], v16 offset:37888
    buffer_load_dwordx4 v8, s[8:11], s46 offen offset:3072 lds
    v_mfma_f32_16x16x32_bf16 v[80:83], v[64:67], a[252:255], v[80:83]
    v_mfma_f32_32x32x16_bf16 v[160:175], a[144:147], v[68:71], v[160:175]
    ds_read_b64_tr_b16 v[64:65], v18 offset:36864
    ds_read_b64_tr_b16 v[66:67], v18 offset:37888
    v_mfma_f32_32x32x16_bf16 v[112:127], a[148:151], v[40:43], v[112:127]
    ds_read_b64_tr_b16 v[68:69], v20 offset:36864
    ds_read_b64_tr_b16 v[70:71], v20 offset:37888
    s_waitcnt vmcnt(12)
    s_barrier
    v_mfma_f32_32x32x16_bf16 v[128:143], a[148:151], v[44:47], v[128:143]
    ds_read_b64_tr_b16 v[40:41], v13 offset:49152
    ds_read_b64_tr_b16 v[42:43], v13 offset:50176
    s_waitcnt lgkmcnt(8)
    ds_read_b128 a[172:175], v9 offset:49152
    s_lshl_b32 s45, s97, 7
    s_add_u32 m0, s52, 16384
    s_add_u32 s45, s45, s98
    buffer_load_dwordx4 v1, s[4:7], s45 offen offset:0 lds
    v_mfma_f32_32x32x16_bf16 v[144:159], a[148:151], v[48:51], v[144:159]
    ds_read_b64_tr_b16 v[44:45], v15 offset:49152
    ds_read_b64_tr_b16 v[46:47], v15 offset:50176
    v_mfma_f32_32x32x16_bf16 v[160:175], a[148:151], v[52:55], v[160:175]
    ds_read_b64_tr_b16 v[48:49], v17 offset:49152
    ds_read_b64_tr_b16 v[50:51], v17 offset:50176
    buffer_load_dwordx4 v2, s[4:7], s45 offen offset:1024 lds
    v_mfma_f32_32x32x16_bf16 v[112:127], a[152:155], v[56:59], v[112:127]
    ds_read_b64_tr_b16 v[52:53], v19 offset:49152
    ds_read_b64_tr_b16 v[54:55], v19 offset:50176
    s_waitcnt lgkmcnt(8)
    v_mfma_f32_32x32x16_bf16 v[128:143], a[152:155], v[60:63], v[128:143]
    ds_read_b64_tr_b16 v[56:57], v13 offset:53248
    ds_read_b64_tr_b16 v[58:59], v13 offset:54272
    ds_read_b128 a[176:179], v10 offset:49152
    buffer_load_dwordx4 v3, s[4:7], s45 offen offset:2048 lds
    v_mfma_f32_32x32x16_bf16 v[144:159], a[152:155], v[64:67], v[144:159]
    ds_read_b64_tr_b16 v[60:61], v15 offset:53248
    ds_read_b64_tr_b16 v[62:63], v15 offset:54272
    buffer_load_dwordx4 v4, s[4:7], s45 offen offset:3072 lds
    v_mfma_f32_32x32x16_bf16 v[160:175], a[152:155], v[68:71], v[160:175]
    ds_read_b64_tr_b16 v[64:65], v17 offset:53248
    ds_read_b64_tr_b16 v[66:67], v17 offset:54272
    s_waitcnt lgkmcnt(9)
    v_mfma_f32_32x32x16_bf16 v[112:127], a[172:175], v[40:43], v[112:127]
    ds_read_b64_tr_b16 v[68:69], v19 offset:53248
    ds_read_b64_tr_b16 v[70:71], v19 offset:54272
    s_mul_i32 s46, s97, 245760
    s_add_u32 m0, s51, 16384
    s_add_u32 s46, s46, s99
    buffer_load_dwordx4 v5, s[8:11], s46 offen offset:0 lds
    buffer_load_dwordx2 v[72:73], v30, s[16:19], 0 offen sc1
    v_mfma_f32_16x16x32_bf16 v[26:29], v[40:43], a[252:255], v[26:29]
    v_mfma_f32_32x32x16_bf16 v[128:143], a[172:175], v[44:47], v[128:143]
    ds_read_b64_tr_b16 v[40:41], v14 offset:49152
    ds_read_b64_tr_b16 v[42:43], v14 offset:50176
    ds_read_b128 a[180:183], v11 offset:49152
    v_mfma_f32_32x32x16_bf16 v[144:159], a[172:175], v[48:51], v[144:159]
    ds_read_b64_tr_b16 v[44:45], v16 offset:49152
    s_waitcnt lgkmcnt(6)
    ds_read_b64_tr_b16 v[46:47], v16 offset:50176
    v_mfma_f32_16x16x32_bf16 v[80:83], v[48:51], a[252:255], v[80:83]
    v_mfma_f32_32x32x16_bf16 v[160:175], a[172:175], v[52:55], v[160:175]
    ds_read_b64_tr_b16 v[48:49], v18 offset:49152
    ds_read_b64_tr_b16 v[50:51], v18 offset:50176
    buffer_load_dwordx4 v6, s[8:11], s46 offen offset:1024 lds
    v_mfma_f32_32x32x16_bf16 v[112:127], a[176:179], v[56:59], v[112:127]
    ds_read_b64_tr_b16 v[52:53], v20 offset:49152
    ds_read_b64_tr_b16 v[54:55], v20 offset:50176
    buffer_load_dwordx4 v7, s[8:11], s46 offen offset:2048 lds
    v_mfma_f32_16x16x32_bf16 v[26:29], v[56:59], a[252:255], v[26:29]
    v_mfma_f32_32x32x16_bf16 v[128:143], a[176:179], v[60:63], v[128:143]
    ds_read_b64_tr_b16 v[56:57], v14 offset:53248
    ds_read_b64_tr_b16 v[58:59], v14 offset:54272
    ds_read_b128 a[184:187], v12 offset:49152
    v_mfma_f32_32x32x16_bf16 v[144:159], a[176:179], v[64:67], v[144:159]
    ds_read_b64_tr_b16 v[60:61], v16 offset:53248
    s_waitcnt lgkmcnt(8)
    ds_read_b64_tr_b16 v[62:63], v16 offset:54272
    buffer_load_dwordx4 v8, s[8:11], s46 offen offset:3072 lds
    v_mfma_f32_16x16x32_bf16 v[80:83], v[64:67], a[252:255], v[80:83]
    v_mfma_f32_32x32x16_bf16 v[160:175], a[176:179], v[68:71], v[160:175]
    ds_read_b64_tr_b16 v[64:65], v18 offset:53248
    ds_read_b64_tr_b16 v[66:67], v18 offset:54272
    v_mfma_f32_32x32x16_bf16 v[112:127], a[180:183], v[40:43], v[112:127]
    ds_read_b64_tr_b16 v[68:69], v20 offset:53248
    ds_read_b64_tr_b16 v[70:71], v20 offset:54272
    s_waitcnt vmcnt(9)
    s_barrier
    v_add_u32 v105, 0, v0
    v_mfma_f32_32x32x16_bf16 v[128:143], a[180:183], v[44:47], v[128:143]
    ds_read_b64_tr_b16 v[40:41], v13 offset:0
    ds_read_b64_tr_b16 v[42:43], v13 offset:1024
    s_waitcnt lgkmcnt(7)
    ds_read_b128 a[204:207], v9 offset:0
    v_mul_u32_u24 v106, s76, v105
    v_lshrrev_b32 v106, 16, v106
    v_mfma_f32_32x32x16_bf16 v[144:159], a[180:183], v[48:51], v[144:159]
    ds_read_b64_tr_b16 v[44:45], v15 offset:0
    ds_read_b64_tr_b16 v[46:47], v15 offset:1024
    s_mul_i32 s46, s94, 221184
    s_add_u32 m0, s51, 32768
    s_add_u32 s46, s46, s59
    buffer_load_dwordx4 v236, s[12:15], s46 offen offset:0 lds
    v_mul_u32_u24 v107, s77, v106
    v_mfma_f32_32x32x16_bf16 v[160:175], a[180:183], v[52:55], v[160:175]
    ds_read_b64_tr_b16 v[48:49], v17 offset:0
    ds_read_b64_tr_b16 v[50:51], v17 offset:1024
    v_sub_u32 v105, v105, v107
    v_mul_u32_u24 v106, s78, v106
    v_lshl_add_u32 v1, v105, 4, v106
    v_add_u32 v105, 64, v0
    v_mfma_f32_32x32x16_bf16 v[112:127], a[184:187], v[56:59], v[112:127]
    ds_read_b64_tr_b16 v[52:53], v19 offset:0
    ds_read_b64_tr_b16 v[54:55], v19 offset:1024
    v_mul_u32_u24 v106, s76, v105
    v_lshrrev_b32 v106, 16, v106
    v_mul_u32_u24 v107, s77, v106
    v_sub_u32 v105, v105, v107
    s_waitcnt lgkmcnt(4)
    v_mfma_f32_32x32x16_bf16 v[128:143], a[184:187], v[60:63], v[128:143]
    ds_read_b64_tr_b16 v[56:57], v13 offset:4096
    ds_read_b64_tr_b16 v[58:59], v13 offset:5120
    ds_read_b128 a[208:211], v10 offset:0
    v_mul_u32_u24 v106, s78, v106
    v_lshl_add_u32 v2, v105, 4, v106
    v_mfma_f32_32x32x16_bf16 v[144:159], a[184:187], v[64:67], v[144:159]
    ds_read_b64_tr_b16 v[60:61], v15 offset:4096
    ds_read_b64_tr_b16 v[62:63], v15 offset:5120
    v_subrev_u32 v2, 1024, v2
    v_add_u32 v105, 128, v0
    v_mul_u32_u24 v106, s76, v105
    v_lshrrev_b32 v106, 16, v106
    v_mfma_f32_32x32x16_bf16 v[160:175], a[184:187], v[68:71], v[160:175]
    ds_read_b64_tr_b16 v[64:65], v17 offset:4096
    ds_read_b64_tr_b16 v[66:67], v17 offset:5120
    buffer_load_dwordx4 v237, s[12:15], s46 offen offset:1024 lds
    v_mul_u32_u24 v107, s77, v106
    v_mfma_f32_32x32x16_bf16 v[112:127], a[204:207], v[40:43], v[112:127]
    ds_read_b64_tr_b16 v[68:69], v19 offset:4096
    ds_read_b64_tr_b16 v[70:71], v19 offset:5120
    v_sub_u32 v105, v105, v107
    v_mul_u32_u24 v106, s78, v106
    v_lshl_add_u32 v3, v105, 4, v106
    v_subrev_u32 v3, 2048, v3
    v_mfma_f32_16x16x32_bf16 v[26:29], v[40:43], a[252:255], v[26:29]
    v_add_u32 v105, 192, v0
    v_mul_u32_u24 v106, s76, v105
    v_mfma_f32_32x32x16_bf16 v[128:143], a[204:207], v[44:47], v[128:143]
    ds_read_b64_tr_b16 v[40:41], v14 offset:0
    ds_read_b64_tr_b16 v[42:43], v14 offset:1024
    s_waitcnt lgkmcnt(6)
    ds_read_b128 a[212:215], v11 offset:0
    v_lshrrev_b32 v106, 16, v106
    v_mul_u32_u24 v107, s77, v106
    v_mfma_f32_32x32x16_bf16 v[144:159], a[204:207], v[48:51], v[144:159]
    ds_read_b64_tr_b16 v[44:45], v16 offset:0
    ds_read_b64_tr_b16 v[46:47], v16 offset:1024
    buffer_load_dwordx4 v238, s[12:15], s46 offen offset:2048 lds
    v_mfma_f32_16x16x32_bf16 v[80:83], v[48:51], a[252:255], v[80:83]
    v_sub_u32 v105, v105, v107
    v_mul_u32_u24 v106, s78, v106
    v_mfma_f32_32x32x16_bf16 v[160:175], a[204:207], v[52:55], v[160:175]
    ds_read_b64_tr_b16 v[48:49], v18 offset:0
    ds_read_b64_tr_b16 v[50:51], v18 offset:1024
    v_lshl_add_u32 v4, v105, 4, v106
    v_subrev_u32 v4, 3072, v4
    v_add_u32 v105, 256, v0
    v_mul_u32_u24 v106, s76, v105
    v_mfma_f32_32x32x16_bf16 v[112:127], a[208:211], v[56:59], v[112:127]
    ds_read_b64_tr_b16 v[52:53], v20 offset:0
    ds_read_b64_tr_b16 v[54:55], v20 offset:1024
    v_lshrrev_b32 v106, 16, v106
    v_mul_u32_u24 v107, s77, v106
    v_sub_u32 v105, v105, v107
    v_mul_u32_u24 v106, s78, v106
    v_mfma_f32_16x16x32_bf16 v[26:29], v[56:59], a[252:255], v[26:29]
    v_lshl_add_u32 v87, v105, 4, v106
    v_mfma_f32_32x32x16_bf16 v[128:143], a[208:211], v[60:63], v[128:143]
    ds_read_b64_tr_b16 v[56:57], v14 offset:4096
    ds_read_b64_tr_b16 v[58:59], v14 offset:5120
    s_waitcnt lgkmcnt(5)
    ds_read_b128 a[216:219], v12 offset:0
    buffer_load_dwordx4 v239, s[12:15], s46 offen offset:3072 lds
    v_mfma_f32_32x32x16_bf16 v[144:159], a[208:211], v[64:67], v[144:159]
    ds_read_b64_tr_b16 v[60:61], v16 offset:4096
    ds_read_b64_tr_b16 v[62:63], v16 offset:5120
    s_mul_i32 s65, s42, 74
    s_add_u32 s65, s65, s36
    s_mul_i32 s65, s65, 5120
    s_add_u32 s65, s65, 17563648
    v_mfma_f32_16x16x32_bf16 v[80:83], v[64:67], a[252:255], v[80:83]
    v_mfma_f32_32x32x16_bf16 v[160:175], a[208:211], v[68:71], v[160:175]
    ds_read_b64_tr_b16 v[64:65], v18 offset:4096
    ds_read_b64_tr_b16 v[66:67], v18 offset:5120
    v_mfma_f32_32x32x16_bf16 v[112:127], a[212:215], v[40:43], v[112:127]
    ds_read_b64_tr_b16 v[68:69], v20 offset:4096
    ds_read_b64_tr_b16 v[70:71], v20 offset:5120
    s_waitcnt vmcnt(4)
    s_barrier
    v_mfma_f32_32x32x16_bf16 v[128:143], a[212:215], v[44:47], v[128:143]
    ds_read_b64_tr_b16 v[40:41], v13 offset:16384
    ds_read_b64_tr_b16 v[42:43], v13 offset:17408
    ds_read_b128 a[236:239], v9 offset:16384
    s_waitcnt lgkmcnt(7)
    v_mfma_f32_32x32x16_bf16 v[144:159], a[212:215], v[48:51], v[144:159]
    ds_read_b64_tr_b16 v[44:45], v15 offset:16384
    ds_read_b64_tr_b16 v[46:47], v15 offset:17408
    s_mul_i32 s46, s95, 221184
    s_add_u32 m0, s51, 49152
    s_add_u32 s46, s46, s59
    buffer_load_dwordx4 v236, s[12:15], s46 offen offset:0 lds
    v_mfma_f32_32x32x16_bf16 v[160:175], a[212:215], v[52:55], v[160:175]
    ds_read_b64_tr_b16 v[48:49], v17 offset:16384
    ds_read_b64_tr_b16 v[50:51], v17 offset:17408
    v_mfma_f32_32x32x16_bf16 v[112:127], a[216:219], v[56:59], v[112:127]
    ds_read_b64_tr_b16 v[52:53], v19 offset:16384
    ds_read_b64_tr_b16 v[54:55], v19 offset:17408
    v_cmp_ne_u32 vcc, 0, v73
    s_nop 0
    s_cmp_eq_u64 vcc, -1
    s_cbranch_scc0 L_spin7
L_back7:
    v_mfma_f32_32x32x16_bf16 v[128:143], a[216:219], v[60:63], v[128:143]
    ds_read_b64_tr_b16 v[56:57], v13 offset:20480
    ds_read_b64_tr_b16 v[58:59], v13 offset:21504
    s_waitcnt lgkmcnt(6)
    ds_read_b128 a[240:243], v10 offset:16384
    v_rcp_f32 v39, v73
    v_mfma_f32_32x32x16_bf16 v[144:159], a[216:219], v[64:67], v[144:159]
    ds_read_b64_tr_b16 v[60:61], v15 offset:20480
    ds_read_b64_tr_b16 v[62:63], v15 offset:21504
    v_cmp_gt_u32 vcc, 32, v0
    v_mov_b32 v32, v73
    v_mul_f32 v31, s57, v39
    v_cndmask_b32_e64 v233, 0, v72, vcc
    v_mfma_f32_32x32x16_bf16 v[160:175], a[216:219], v[68:71], v[160:175]
    ds_read_b64_tr_b16 v[64:65], v17 offset:20480
    ds_read_b64_tr_b16 v[66:67], v17 offset:21504
    buffer_load_dwordx4 v237, s[12:15], s46 offen offset:1024 lds
    v_mfma_f32_32x32x16_bf16 v[112:127], a[236:239], v[40:43], v[112:127]
    ds_read_b64_tr_b16 v[68:69], v19 offset:20480
    ds_read_b64_tr_b16 v[70:71], v19 offset:21504
    v_mul_f32 v33, 0xbfb8aa3b, v39
    v_lshl_or_b32 v232, v233, 16, v233
    v_mfma_f32_16x16x32_bf16 v[26:29], v[40:43], a[252:255], v[26:29]
    v_mfma_f32_32x32x16_bf16 v[128:143], a[236:239], v[44:47], v[128:143]
    ds_read_b64_tr_b16 v[40:41], v14 offset:16384
    ds_read_b64_tr_b16 v[42:43], v14 offset:17408
    s_waitcnt lgkmcnt(6)
    ds_read_b128 a[244:247], v11 offset:16384
    s_lshl_b32 s47, s36, 7
    s_add_u32 s47, s47, 161792
    v_and_b32 v37, 31, v0
    v_lshl_add_u32 v37, v37, 2, s47
    v_lshrrev_b32 v38, 5, v0
    v_lshl_add_u32 v38, v38, 4, s47
    v_mfma_f32_32x32x16_bf16 v[144:159], a[236:239], v[48:51], v[144:159]
    ds_read_b64_tr_b16 v[44:45], v16 offset:16384
    ds_read_b64_tr_b16 v[46:47], v16 offset:17408
    buffer_load_dwordx4 v238, s[12:15], s46 offen offset:2048 lds
    v_mfma_f32_16x16x32_bf16 v[80:83], v[48:51], a[252:255], v[80:83]
    ds_write_b32 v37, v31 offset:0
    ds_read_b128 v[208:211], v38 offset:0
    v_mfma_f32_32x32x16_bf16 v[160:175], a[236:239], v[52:55], v[160:175]
    ds_read_b64_tr_b16 v[48:49], v18 offset:16384
    ds_read_b64_tr_b16 v[50:51], v18 offset:17408
    ds_read_b128 v[212:215], v38 offset:32
    ds_read_b128 v[216:219], v38 offset:64
    s_waitcnt lgkmcnt(8)
    ds_read_b128 v[220:223], v38 offset:96
    v_mfma_f32_32x32x16_bf16 v[112:127], a[240:243], v[56:59], v[112:127]
    ds_read_b64_tr_b16 v[52:53], v20 offset:16384
    ds_read_b64_tr_b16 v[54:55], v20 offset:17408
    v_mfma_f32_16x16x32_bf16 v[26:29], v[56:59], a[252:255], v[26:29]
    v_mfma_f32_32x32x16_bf16 v[128:143], a[240:243], v[60:63], v[128:143]
    ds_read_b64_tr_b16 v[56:57], v14 offset:20480
    ds_read_b64_tr_b16 v[58:59], v14 offset:21504
    ds_read_b128 a[248:251], v12 offset:16384
    buffer_load_dwordx4 v239, s[12:15], s46 offen offset:3072 lds
    v_mfma_f32_32x32x16_bf16 v[144:159], a[240:243], v[64:67], v[144:159]
    ds_read_b64_tr_b16 v[60:61], v16 offset:20480
    s_waitcnt lgkmcnt(10)
    ds_read_b64_tr_b16 v[62:63], v16 offset:21504
    v_add_u32 v72, 0x20000, v13
    v_add_u32 v73, 0x20000, v14
    v_add_u32 v74, 0x20000, v15
    v_add_u32 v75, 0x20000, v16
    v_mfma_f32_16x16x32_bf16 v[80:83], v[64:67], a[252:255], v[80:83]
    v_add_u32 v76, 0x20000, v17
    v_add_u32 v77, 0x20000, v18
    v_mfma_f32_32x32x16_bf16 v[160:175], a[240:243], v[68:71], v[160:175]
    ds_read_b64_tr_b16 v[64:65], v18 offset:20480
    ds_read_b64_tr_b16 v[66:67], v18 offset:21504
    v_add_u32 v78, 0x20000, v19
    v_add_u32 v79, 0x20000, v20
    v_mfma_f32_32x32x16_bf16 v[112:127], a[244:247], v[40:43], v[112:127]
    ds_read_b64_tr_b16 v[68:69], v20 offset:20480
    ds_read_b64_tr_b16 v[70:71], v20 offset:21504
    s_barrier
    s_mul_i32 s46, s96, 221184
    s_add_u32 m0, s51, 0
    s_add_u32 s46, s46, s59
    buffer_load_dwordx4 v236, s[12:15], s46 offen offset:0 lds
    v_mfma_f32_32x32x16_bf16 v[128:143], a[244:247], v[44:47], v[128:143]
    s_waitcnt lgkmcnt(4)
    ds_read_b64_tr_b16 v[40:41], v72 offset:0
    ds_read_b64_tr_b16 v[42:43], v72 offset:1024
    buffer_load_dwordx4 v237, s[12:15], s46 offen offset:1024 lds
    ds_write_b128 v25, v[26:29] offset:0
    v_mfma_f32_32x32x16_bf16 v[144:159], a[244:247], v[48:51], v[144:159]
    ds_read_b64_tr_b16 v[44:45], v74 offset:0
    ds_read_b64_tr_b16 v[46:47], v74 offset:1024
    buffer_load_dwordx4 v238, s[12:15], s46 offen offset:2048 lds
    ds_write_b128 v25, v[80:83] offset:256
    v_mfma_f32_32x32x16_bf16 v[160:175], a[244:247], v[52:55], v[160:175]
    ds_read_b64_tr_b16 v[48:49], v76 offset:0
    ds_read_b64_tr_b16 v[50:51], v76 offset:1024
    buffer_load_dwordx4 v239, s[12:15], s46 offen offset:3072 lds
    v_mfma_f32_32x32x16_bf16 v[112:127], a[248:251], v[56:59], v[112:127]
    ds_read_b64_tr_b16 v[52:53], v78 offset:0
    ds_read_b64_tr_b16 v[54:55], v78 offset:1024
    s_waitcnt lgkmcnt(4)
    s_barrier
    ds_read_b32 v224, v23 offset:0
    ds_read_b32 v225, v23 offset:1024
    ds_read_b32 v228, v24 offset:128
    ds_read_b32 v229, v24 offset:1152
    v_mfma_f32_32x32x16_bf16 v[128:143], a[248:251], v[60:63], v[128:143]
    ds_read_b64_tr_b16 v[56:57], v72 offset:4096
    ds_read_b64_tr_b16 v[58:59], v72 offset:5120
    v_mfma_f32_32x32x16_bf16 v[144:159], a[248:251], v[64:67], v[144:159]
    ds_read_b64_tr_b16 v[60:61], v74 offset:4096
    ds_read_b64_tr_b16 v[62:63], v74 offset:5120
    v_mfma_f32_32x32x16_bf16 v[160:175], a[248:251], v[68:71], v[160:175]
    ds_read_b64_tr_b16 v[64:65], v76 offset:4096
    ds_read_b64_tr_b16 v[66:67], v76 offset:5120
    s_mul_i32 s46, s93, 221184
    s_add_u32 m0, s51, 65536
    s_add_u32 s46, s46, s60
    buffer_load_dwordx4 v236, s[12:15], s46 offen offset:0 lds
    s_waitcnt lgkmcnt(8)
    v_add_f32 v224, v224, v225
    v_and_b32 v35, 0xffff0000, v224
    v_mfma_f32_32x32x16_bf16 v[176:191], v[40:43], a[92:95], 0
    ds_read_b64_tr_b16 v[68:69], v78 offset:4096
    ds_read_b64_tr_b16 v[70:71], v78 offset:5120
    v_sub_f32 v225, v224, v35
    v_and_b32 v35, 0xffff0000, v225
    v_alignbit_b32 v224, v35, v224, 16
    v_sub_f32 v225, v225, v35
    v_mfma_f32_16x16x32_bf16 v[26:29], v[40:43], a[252:255], 0
    v_or_b32 v224, v224, v35
    v_lshrrev_b32 v225, 16, v225
    v_mfma_f32_32x32x16_bf16 v[192:207], v[44:47], a[92:95], 0
    ds_read_b64_tr_b16 v[40:41], v73 offset:0
    ds_read_b64_tr_b16 v[42:43], v73 offset:1024
    s_waitcnt lgkmcnt(4)
    v_add_f32 v228, v228, v229
    v_and_b32 v36, 0xffff0000, v228
    v_sub_f32 v229, v228, v36
    v_and_b32 v36, 0xffff0000, v229
    v_mfma_f32_32x32x16_bf16 v[176:191], v[48:51], a[108:111], v[176:191]
    ds_read_b64_tr_b16 v[44:45], v75 offset:0
    ds_read_b64_tr_b16 v[46:47], v75 offset:1024
    buffer_load_dwordx4 v237, s[12:15], s46 offen offset:1024 lds
    v_alignbit_b32 v228, v36, v228, 16
    v_sub_f32 v229, v229, v36
    v_mfma_f32_16x16x32_bf16 v[26:29], v[48:51], a[252:255], v[26:29]
    v_or_b32 v228, v228, v36
    v_lshrrev_b32 v229, 16, v229
    v_mfma_f32_32x32x16_bf16 v[192:207], v[52:55], a[108:111], v[192:207]
    ds_read_b64_tr_b16 v[48:49], v77 offset:0
    ds_read_b64_tr_b16 v[50:51], v77 offset:1024
    v_mfma_f32_32x32x16_bf16 v[176:191], v[56:59], a[96:99], v[176:191]
    ds_read_b64_tr_b16 v[52:53], v79 offset:0
    ds_read_b64_tr_b16 v[54:55], v79 offset:1024
    buffer_load_dwordx4 v238, s[12:15], s46 offen offset:2048 lds
    v_add_u32 v248, 20660224, v21
    buffer_load_dword v249, v248, s[16:19], 0 offen sc1
    v_mfma_f32_32x32x16_bf16 v[112:127], v[232:235], v[224:227], v[112:127]
    ds_read_b32 v224, v23 offset:256
    ds_read_b32 v225, v23 offset:1280
    v_mfma_f32_16x16x32_bf16 v[26:29], v[56:59], a[252:255], v[26:29]
    v_mfma_f32_32x32x16_bf16 v[192:207], v[60:63], a[96:99], v[192:207]
    ds_read_b64_tr_b16 v[56:57], v73 offset:4096
    ds_read_b64_tr_b16 v[58:59], v73 offset:5120
    v_mfma_f32_32x32x16_bf16 v[128:143], v[232:235], v[228:231], v[128:143]
    ds_read_b32 v228, v24 offset:384
    s_waitcnt lgkmcnt(7)
    ds_read_b32 v229, v24 offset:1408
    v_mfma_f32_32x32x16_bf16 v[176:191], v[64:67], a[112:115], v[176:191]
    ds_read_b64_tr_b16 v[60:61], v75 offset:4096
    ds_read_b64_tr_b16 v[62:63], v75 offset:5120
    buffer_load_dwordx4 v239, s[12:15], s46 offen offset:3072 lds
    v_mul_f32 v112, v208, v112
    v_mul_f32 v113, v209, v113
    v_mul_f32 v114, v210, v114
    v_mul_f32 v115, v211, v115
    v_mfma_f32_16x16x32_bf16 v[26:29], v[64:67], a[252:255], v[26:29]
    v_mul_f32 v116, v212, v116
    v_mul_f32 v117, v213, v117
    v_mfma_f32_32x32x16_bf16 v[192:207], v[68:71], a[112:115], v[192:207]
    ds_read_b64_tr_b16 v[64:65], v77 offset:4096
    ds_read_b64_tr_b16 v[66:67], v77 offset:5120
    v_mul_f32 v118, v214, v118
    v_mul_f32 v119, v215, v119
    v_mul_f32 v120, v216, v120
    v_mul_f32 v121, v217, v121
    v_mfma_f32_32x32x16_bf16 v[176:191], v[40:43], a[100:103], v[176:191]
    ds_read_b64_tr_b16 v[68:69], v79 offset:4096
    ds_read_b64_tr_b16 v[70:71], v79 offset:5120
    s_waitcnt vmcnt(13)
    s_barrier
    s_mul_i32 s46, s97, 221184
    s_add_u32 m0, s51, 16384
    s_add_u32 s46, s46, s59
    buffer_load_dwordx4 v236, s[12:15], s46 offen offset:0 lds
    v_mul_f32 v122, v218, v122
    v_mul_f32 v123, v219, v123
    v_mul_f32 v124, v220, v124
    v_mul_f32 v125, v221, v125
    v_mfma_f32_32x32x16_bf16 v[192:207], v[44:47], a[100:103], v[192:207]
    ds_read_b64_tr_b16 v[40:41], v13 offset:32768
    s_waitcnt lgkmcnt(3)
    ds_read_b64_tr_b16 v[42:43], v13 offset:33792
    buffer_load_dwordx4 v237, s[12:15], s46 offen offset:1024 lds
    v_mul_f32 v126, v222, v126
    v_mul_f32 v127, v223, v127
    v_add_f32 v224, v224, v225
    v_and_b32 v35, 0xffff0000, v224
    v_mfma_f32_32x32x16_bf16 v[176:191], v[48:51], a[116:119], v[176:191]
    ds_read_b64_tr_b16 v[44:45], v15 offset:32768
    ds_read_b64_tr_b16 v[46:47], v15 offset:33792
    buffer_load_dwordx4 v238, s[12:15], s46 offen offset:2048 lds
    v_sub_f32 v225, v224, v35
    v_and_b32 v35, 0xffff0000, v225
    v_alignbit_b32 v224, v35, v224, 16
    v_sub_f32 v225, v225, v35
    v_mfma_f32_32x32x16_bf16 v[192:207], v[52:55], a[116:119], v[192:207]
    ds_read_b64_tr_b16 v[48:49], v17 offset:32768
    ds_read_b64_tr_b16 v[50:51], v17 offset:33792
    buffer_load_dwordx4 v239, s[12:15], s46 offen offset:3072 lds
    v_or_b32 v224, v224, v35
    v_lshrrev_b32 v225, 16, v225
    v_add_f32 v228, v228, v229
    v_and_b32 v36, 0xffff0000, v228
    v_mfma_f32_32x32x16_bf16 v[176:191], v[56:59], a[104:107], v[176:191]
    ds_read_b64_tr_b16 v[52:53], v19 offset:32768
    ds_read_b64_tr_b16 v[54:55], v19 offset:33792
    v_sub_f32 v229, v228, v36
    v_and_b32 v36, 0xffff0000, v229
    v_alignbit_b32 v228, v36, v228, 16
    v_sub_f32 v229, v229, v36
    v_mfma_f32_32x32x16_bf16 v[192:207], v[60:63], a[104:107], v[192:207]
    ds_read_b64_tr_b16 v[56:57], v13 offset:36864
    ds_read_b64_tr_b16 v[58:59], v13 offset:37888
    v_or_b32 v228, v228, v36
    v_lshrrev_b32 v229, 16, v229
    v_mfma_f32_32x32x16_bf16 v[176:191], v[64:67], a[120:123], v[176:191]
    ds_read_b64_tr_b16 v[60:61], v15 offset:36864
    ds_read_b64_tr_b16 v[62:63], v15 offset:37888
    s_waitcnt lgkmcnt(6)
    v_mfma_f32_32x32x16_bf16 v[192:207], v[68:71], a[120:123], v[192:207]
    ds_read_b64_tr_b16 v[64:65], v17 offset:36864
    ds_read_b64_tr_b16 v[66:67], v17 offset:37888
    v_mfma_f32_32x32x16_bf16 v[176:191], v[40:43], a[124:127], v[176:191]
    ds_read_b64_tr_b16 v[68:69], v19 offset:36864
    ds_read_b64_tr_b16 v[70:71], v19 offset:37888
    v_add_u32 v72, 0x10000, v13
    v_add_u32 v73, 0x10000, v14
    v_add_u32 v74, 0x10000, v15
    v_mfma_f32_32x32x16_bf16 v[144:159], v[232:235], v[224:227], v[144:159]
    v_cvt_pk_bf16_f32 v104, v112, v113
    v_cvt_pk_bf16_f32 v105, v114, v115
    v_cvt_pk_bf16_f32 v106, v116, v117
    v_cvt_pk_bf16_f32 v107, v118, v119
    v_add_u32 v75, 0x10000, v16
    v_add_u32 v76, 0x10000, v17
    v_mfma_f32_16x16x32_bf16 v[26:29], v[40:43], a[252:255], v[26:29]
    v_add_u32 v77, 0x10000, v18
    v_add_u32 v78, 0x10000, v19
    v_mfma_f32_32x32x16_bf16 v[192:207], v[44:47], a[124:127], v[192:207]
    ds_read_b64_tr_b16 v[40:41], v14 offset:32768
    ds_read_b64_tr_b16 v[42:43], v14 offset:33792
    buffer_store_dwordx4 v[104:107], v22, s[16:19], s53 offen sc1
    v_mfma_f32_32x32x16_bf16 v[160:175], v[232:235], v[228:231], v[160:175]
    v_cvt_pk_bf16_f32 v108, v120, v121
    v_cvt_pk_bf16_f32 v109, v122, v123
    v_cvt_pk_bf16_f32 v110, v124, v125
    v_cvt_pk_bf16_f32 v111, v126, v127
    v_add_u32 v79, 0x10000, v20
    v_mfma_f32_32x32x16_bf16 v[176:191], v[48:51], a[140:143], v[176:191]
    ds_read_b64_tr_b16 v[44:45], v16 offset:32768
    ds_read_b64_tr_b16 v[46:47], v16 offset:33792
    buffer_store_dwordx4 v[108:111], v34, s[16:19], s53 offen sc1
    v_mul_f32 v128, v208, v128
    v_mfma_f32_16x16x32_bf16 v[26:29], v[48:51], a[252:255], v[26:29]
    v_mul_f32 v129, v209, v129
    v_mul_f32 v130, v210, v130
    s_waitcnt lgkmcnt(4)
    v_mfma_f32_32x32x16_bf16 v[192:207], v[52:55], a[140:143], v[192:207]
    ds_read_b64_tr_b16 v[48:49], v18 offset:32768
    ds_read_b64_tr_b16 v[50:51], v18 offset:33792
    v_mul_f32 v131, v211, v131
    v_mul_f32 v132, v212, v132
    v_mul_f32 v133, v213, v133
    v_mul_f32 v134, v214, v134
    v_mul_f32 v135, v215, v135
    v_mfma_f32_32x32x16_bf16 v[176:191], v[56:59], a[128:131], v[176:191]
    ds_read_b64_tr_b16 v[52:53], v20 offset:32768
    ds_read_b64_tr_b16 v[54:55], v20 offset:33792
    v_mul_f32 v136, v216, v136
    v_mul_f32 v137, v217, v137
    v_mul_f32 v138, v218, v138
    v_mul_f32 v139, v219, v139
    v_mul_f32 v140, v220, v140
    v_mfma_f32_16x16x32_bf16 v[26:29], v[56:59], a[252:255], v[26:29]
    v_mul_f32 v141, v221, v141
    v_mul_f32 v142, v222, v142
    v_mfma_f32_32x32x16_bf16 v[192:207], v[60:63], a[128:131], v[192:207]
    ds_read_b64_tr_b16 v[56:57], v14 offset:36864
    ds_read_b64_tr_b16 v[58:59], v14 offset:37888
    v_mul_f32 v143, v223, v143
    v_cvt_pk_bf16_f32 v104, v128, v129
    v_cvt_pk_bf16_f32 v105, v130, v131
    v_cvt_pk_bf16_f32 v106, v132, v133
    v_cvt_pk_bf16_f32 v107, v134, v135
    buffer_store_dwordx4 v[104:107], v22, s[16:19], s54 offen sc1
    v_mfma_f32_32x32x16_bf16 v[176:191], v[64:67], a[144:147], v[176:191]
    ds_read_b64_tr_b16 v[60:61], v16 offset:36864
    ds_read_b64_tr_b16 v[62:63], v16 offset:37888
    v_cvt_pk_bf16_f32 v108, v136, v137
    v_cvt_pk_bf16_f32 v109, v138, v139
    v_cvt_pk_bf16_f32 v110, v140, v141
    v_cvt_pk_bf16_f32 v111, v142, v143
    buffer_store_dwordx4 v[108:111], v34, s[16:19], s54 offen sc1
    v_mfma_f32_16x16x32_bf16 v[26:29], v[64:67], a[252:255], v[26:29]
    v_mul_f32 v144, v208, v144
    v_mul_f32 v145, v209, v145
    v_mfma_f32_32x32x16_bf16 v[192:207], v[68:71], a[144:147], v[192:207]
    ds_read_b64_tr_b16 v[64:65], v18 offset:36864
    ds_read_b64_tr_b16 v[66:67], v18 offset:37888
    v_mul_f32 v146, v210, v146
    v_mul_f32 v147, v211, v147
    v_mul_f32 v148, v212, v148
    v_mul_f32 v149, v213, v149
    v_mul_f32 v150, v214, v150
    s_waitcnt lgkmcnt(4)
    v_mfma_f32_32x32x16_bf16 v[176:191], v[40:43], a[132:135], v[176:191]
    ds_read_b64_tr_b16 v[68:69], v20 offset:36864
    ds_read_b64_tr_b16 v[70:71], v20 offset:37888
    s_waitcnt vmcnt(17)
    s_barrier
    v_mul_f32 v151, v215, v151
    v_mul_f32 v152, v216, v152
    v_mul_f32 v153, v217, v153
    v_mul_f32 v154, v218, v154
    v_mul_f32 v155, v219, v155
    v_mul_f32 v156, v220, v156
    v_mfma_f32_32x32x16_bf16 v[192:207], v[44:47], a[132:135], v[192:207]
    ds_read_b64_tr_b16 v[40:41], v13 offset:49152
    ds_read_b64_tr_b16 v[42:43], v13 offset:50176
    v_mul_f32 v157, v221, v157
    v_mul_f32 v158, v222, v158
    v_mul_f32 v159, v223, v159
    v_cvt_pk_bf16_f32 v104, v144, v145
    v_cvt_pk_bf16_f32 v105, v146, v147
    v_cvt_pk_bf16_f32 v106, v148, v149
    v_mfma_f32_32x32x16_bf16 v[176:191], v[48:51], a[148:151], v[176:191]
    ds_read_b64_tr_b16 v[44:45], v15 offset:49152
    ds_read_b64_tr_b16 v[46:47], v15 offset:50176
    v_cvt_pk_bf16_f32 v107, v150, v151
    buffer_store_dwordx4 v[104:107], v22, s[16:19], s55 offen sc1
    v_cvt_pk_bf16_f32 v108, v152, v153
    v_mfma_f32_32x32x16_bf16 v[192:207], v[52:55], a[148:151], v[192:207]
    ds_read_b64_tr_b16 v[48:49], v17 offset:49152
    ds_read_b64_tr_b16 v[50:51], v17 offset:50176
    v_cvt_pk_bf16_f32 v109, v154, v155
    v_cvt_pk_bf16_f32 v110, v156, v157
    v_cvt_pk_bf16_f32 v111, v158, v159
    buffer_store_dwordx4 v[108:111], v34, s[16:19], s55 offen sc1
    v_mfma_f32_32x32x16_bf16 v[176:191], v[56:59], a[136:139], v[176:191]
    ds_read_b64_tr_b16 v[52:53], v19 offset:49152
    ds_read_b64_tr_b16 v[54:55], v19 offset:50176
    v_mul_f32 v160, v208, v160
    v_mul_f32 v161, v209, v161
    v_mul_f32 v162, v210, v162
    v_mul_f32 v163, v211, v163
    v_mul_f32 v164, v212, v164
    v_mul_f32 v165, v213, v165
    v_mul_f32 v166, v214, v166
    s_waitcnt lgkmcnt(4)
    v_mfma_f32_32x32x16_bf16 v[192:207], v[60:63], a[136:139], v[192:207]
    ds_read_b64_tr_b16 v[56:57], v13 offset:53248
    ds_read_b64_tr_b16 v[58:59], v13 offset:54272
    v_mul_f32 v167, v215, v167
    v_mul_f32 v168, v216, v168
    v_mul_f32 v169, v217, v169
    v_mul_f32 v170, v218, v170
    v_mul_f32 v171, v219, v171
    v_mul_f32 v172, v220, v172
    v_mul_f32 v173, v221, v173
    v_mfma_f32_32x32x16_bf16 v[176:191], v[64:67], a[152:155], v[176:191]
    ds_read_b64_tr_b16 v[60:61], v15 offset:53248
    ds_read_b64_tr_b16 v[62:63], v15 offset:54272
    v_mul_f32 v174, v222, v174
    v_mul_f32 v175, v223, v175
    v_cvt_pk_bf16_f32 v104, v160, v161
    v_cvt_pk_bf16_f32 v105, v162, v163
    v_cvt_pk_bf16_f32 v106, v164, v165
    v_cvt_pk_bf16_f32 v107, v166, v167
    buffer_store_dwordx4 v[104:107], v22, s[16:19], s56 offen sc1
    v_mfma_f32_32x32x16_bf16 v[192:207], v[68:71], a[152:155], v[192:207]
    ds_read_b64_tr_b16 v[64:65], v17 offset:53248
    ds_read_b64_tr_b16 v[66:67], v17 offset:54272
    v_cvt_pk_bf16_f32 v108, v168, v169
    v_cvt_pk_bf16_f32 v109, v170, v171
    v_cvt_pk_bf16_f32 v110, v172, v173
    v_cvt_pk_bf16_f32 v111, v174, v175
    buffer_store_dwordx4 v[108:111], v34, s[16:19], s56 offen sc1
    v_mfma_f32_32x32x16_bf16 v[176:191], v[40:43], a[156:159], v[176:191]
    ds_read_b64_tr_b16 v[68:69], v19 offset:53248
    ds_read_b64_tr_b16 v[70:71], v19 offset:54272
    s_waitcnt vmcnt(13)
    v_cmp_ne_u32 vcc, 0, v249
    s_nop 0
    s_cmp_eq_u64 vcc, -1
    s_cbranch_scc0 L_spin9
L_back9:
    v_mfma_f32_16x16x32_bf16 v[26:29], v[40:43], a[252:255], v[26:29]
    v_mfma_f32_32x32x16_bf16 v[192:207], v[44:47], a[156:159], v[192:207]
    ds_read_b64_tr_b16 v[40:41], v14 offset:49152
    ds_read_b64_tr_b16 v[42:43], v14 offset:50176
    s_waitcnt lgkmcnt(4)
    v_mfma_f32_32x32x16_bf16 v[176:191], v[48:51], a[172:175], v[176:191]
    ds_read_b64_tr_b16 v[44:45], v16 offset:49152
    ds_read_b64_tr_b16 v[46:47], v16 offset:50176
    v_mfma_f32_16x16x32_bf16 v[26:29], v[48:51], a[252:255], v[26:29]
    v_mfma_f32_32x32x16_bf16 v[192:207], v[52:55], a[172:175], v[192:207]
    ds_read_b64_tr_b16 v[48:49], v18 offset:49152
    ds_read_b64_tr_b16 v[50:51], v18 offset:50176
    s_add_u32 s67, s65, 0
    buffer_load_dwordx4 a[0:3], v21, s[16:19], s67 offen offset:0 sc1
    v_mfma_f32_32x32x16_bf16 v[176:191], v[56:59], a[160:163], v[176:191]
    ds_read_b64_tr_b16 v[52:53], v20 offset:49152
    ds_read_b64_tr_b16 v[54:55], v20 offset:50176
    v_mfma_f32_16x16x32_bf16 v[26:29], v[56:59], a[252:255], v[26:29]
    v_mfma_f32_32x32x16_bf16 v[192:207], v[60:63], a[160:163], v[192:207]
    ds_read_b64_tr_b16 v[56:57], v14 offset:53248
    ds_read_b64_tr_b16 v[58:59], v14 offset:54272
    v_mfma_f32_32x32x16_bf16 v[176:191], v[64:67], a[176:179], v[176:191]
    ds_read_b64_tr_b16 v[60:61], v16 offset:53248
    ds_read_b64_tr_b16 v[62:63], v16 offset:54272
    v_mfma_f32_16x16x32_bf16 v[26:29], v[64:67], a[252:255], v[26:29]
    s_waitcnt lgkmcnt(8)
    v_mfma_f32_32x32x16_bf16 v[192:207], v[68:71], a[176:179], v[192:207]
    ds_read_b64_tr_b16 v[64:65], v18 offset:53248
    ds_read_b64_tr_b16 v[66:67], v18 offset:54272
    v_mfma_f32_32x32x16_bf16 v[176:191], v[40:43], a[164:167], v[176:191]
    ds_read_b64_tr_b16 v[68:69], v20 offset:53248
    ds_read_b64_tr_b16 v[70:71], v20 offset:54272
    s_barrier
    v_mfma_f32_32x32x16_bf16 v[192:207], v[44:47], a[164:167], v[192:207]
    ds_read_b64_tr_b16 v[40:41], v13 offset:0
    ds_read_b64_tr_b16 v[42:43], v13 offset:1024
    buffer_load_dwordx4 a[4:7], v21, s[16:19], s67 offen offset:1024 sc1
    s_waitcnt lgkmcnt(8)
    v_mfma_f32_32x32x16_bf16 v[176:191], v[48:51], a[180:183], v[176:191]
    ds_read_b64_tr_b16 v[44:45], v15 offset:0
    ds_read_b64_tr_b16 v[46:47], v15 offset:1024
    s_mul_i32 s46, s94, 221184
    s_add_u32 m0, s51, 32768
    s_add_u32 s46, s46, s60
    buffer_load_dwordx4 v236, s[12:15], s46 offen offset:0 lds
    v_mfma_f32_32x32x16_bf16 v[192:207], v[52:55], a[180:183], v[192:207]
    ds_read_b64_tr_b16 v[48:49], v17 offset:0
    ds_read_b64_tr_b16 v[50:51], v17 offset:1024
    v_mfma_f32_32x32x16_bf16 v[176:191], v[56:59], a[168:171], v[176:191]
    ds_read_b64_tr_b16 v[52:53], v19 offset:0
    ds_read_b64_tr_b16 v[54:55], v19 offset:1024
    s_waitcnt lgkmcnt(8)
    v_mfma_f32_32x32x16_bf16 v[192:207], v[60:63], a[168:171], v[192:207]
    ds_read_b64_tr_b16 v[56:57], v13 offset:4096
    ds_read_b64_tr_b16 v[58:59], v13 offset:5120
    buffer_load_dwordx4 a[8:11], v21, s[16:19], s67 offen offset:2048 sc1
    v_mfma_f32_32x32x16_bf16 v[176:191], v[64:67], a[184:187], v[176:191]
    ds_read_b64_tr_b16 v[60:61], v15 offset:4096
    ds_read_b64_tr_b16 v[62:63], v15 offset:5120
    v_mfma_f32_32x32x16_bf16 v[192:207], v[68:71], a[184:187], v[192:207]
    ds_read_b64_tr_b16 v[64:65], v17 offset:4096
    ds_read_b64_tr_b16 v[66:67], v17 offset:5120
    buffer_load_dwordx4 v237, s[12:15], s46 offen offset:1024 lds
    s_waitcnt lgkmcnt(9)
    v_mfma_f32_32x32x16_bf16 v[176:191], v[40:43], a[188:191], v[176:191]
    ds_read_b64_tr_b16 v[68:69], v19 offset:4096
    ds_read_b64_tr_b16 v[70:71], v19 offset:5120
    v_mfma_f32_16x16x32_bf16 v[26:29], v[40:43], a[252:255], v[26:29]
    v_mfma_f32_32x32x16_bf16 v[192:207], v[44:47], a[188:191], v[192:207]
    ds_read_b64_tr_b16 v[40:41], v14 offset:0
    ds_read_b64_tr_b16 v[42:43], v14 offset:1024
    s_waitcnt lgkmcnt(8)
    v_mfma_f32_32x32x16_bf16 v[176:191], v[48:51], a[204:207], v[176:191]
    ds_read_b64_tr_b16 v[44:45], v16 offset:0
    ds_read_b64_tr_b16 v[46:47], v16 offset:1024
    buffer_load_dwordx4 v238, s[12:15], s46 offen offset:2048 lds
    buffer_load_dwordx4 a[12:15], v21, s[16:19], s67 offen offset:3072 sc1
    s_lshl_b32 s47, s37, 2
    s_add_u32 s47, s47, s36
    s_mul_i32 s47, s47, 151552
    s_add_u32 s47, s47, 7864320
    s_lshl_b32 s48, s43, 11
    s_lshl_b32 s74, s74, 12
    s_lshl_b32 s75, s75, 12
    s_add_u32 s74, s74, s47
    s_add_u32 s75, s75, s47
    s_cmp_lt_u32 s38, 12
    s_cselect_b32 s75, s75, 2146435072
    s_add_u32 s53, s74, s48
    s_add_u32 s55, s75, s48
    s_xor_b32 s48, s48, 0x800
    s_add_u32 s54, s74, s48
    s_add_u32 s56, s75, s48
    v_mfma_f32_16x16x32_bf16 v[26:29], v[48:51], a[252:255], v[26:29]
    v_lshrrev_b32 v37, 1, v0
    v_min_u32 v37, 11, v37
    v_mfma_f32_32x32x16_bf16 v[192:207], v[52:55], a[204:207], v[192:207]
    ds_read_b64_tr_b16 v[48:49], v18 offset:0
    ds_read_b64_tr_b16 v[50:51], v18 offset:1024
    v_mul_u32_u24 v37, 2560, v37
    v_and_b32 v38, 1, v0
    v_mul_u32_u24 v38, 1280, v38
    s_mov_b32 s47, 126992
    v_mfma_f32_32x32x16_bf16 v[176:191], v[56:59], a[192:195], v[176:191]
    ds_read_b64_tr_b16 v[52:53], v20 offset:0
    ds_read_b64_tr_b16 v[54:55], v20 offset:1024
    v_add3_u32 v37, v37, v38, s47
    v_mov_b32 v100, s58
    v_mov_b32 v101, s58
    v_mov_b32 v102, s58
    v_mfma_f32_16x16x32_bf16 v[26:29], v[56:59], a[252:255], v[26:29]
    v_mov_b32 v103, s58
    ds_write_b128 v37, v[100:103]
    s_waitcnt lgkmcnt(5)
    v_mfma_f32_32x32x16_bf16 v[192:207], v[60:63], a[192:195], v[192:207]
    ds_read_b64_tr_b16 v[56:57], v14 offset:4096
    ds_read_b64_tr_b16 v[58:59], v14 offset:5120
    buffer_load_dwordx4 v239, s[12:15], s46 offen offset:3072 lds
    v_mfma_f32_32x32x16_bf16 v[176:191], v[64:67], a[208:211], v[176:191]
    ds_read_b64_tr_b16 v[60:61], v16 offset:4096
    ds_read_b64_tr_b16 v[62:63], v16 offset:5120
    s_getreg_b32 s86, hwreg(HW_REG_IB_STS, 30, 2)
    s_getreg_b32 s87, hwreg(HW_REG_IB_STS, 0, 4)
    s_mov_b32 s3, 0
    s_lshl4_add_u32 s86, s86, s87
    s_cmp_le_u32 s86, 7
    s_cbranch_scc0 L_tf6
    buffer_store_dword v253, v252, s[16:19], s92 offen sc1
    s_mov_b32 s3, 0x100
L_tf6:
    v_mfma_f32_16x16x32_bf16 v[26:29], v[64:67], a[252:255], v[26:29]
    s_lshl_b32 s47, s39, 2
    v_min_u32 v38, 11, v0
    v_mfma_f32_32x32x16_bf16 v[192:207], v[68:71], a[208:211], v[192:207]
    ds_read_b64_tr_b16 v[64:65], v18 offset:4096
    ds_read_b64_tr_b16 v[66:67], v18 offset:5120
    s_add_u32 s67, s67, 4096
    buffer_load_dwordx4 a[16:19], v21, s[16:19], s67 offen offset:0 sc1
    v_mfma_f32_32x32x16_bf16 v[176:191], v[40:43], a[196:199], v[176:191]
    ds_read_b64_tr_b16 v[68:69], v20 offset:4096
    ds_read_b64_tr_b16 v[70:71], v20 offset:5120
    s_waitcnt vmcnt(17)
    s_barrier
    v_add_u32 v39, s47, v38
    v_mfma_f32_32x32x16_bf16 v[192:207], v[44:47], a[196:199], v[192:207]
    ds_read_b64_tr_b16 v[40:41], v13 offset:16384
    ds_read_b64_tr_b16 v[42:43], v13 offset:17408
    v_cmp_gt_u32 s[90:91], 8, v39
    v_mul_u32_u24 v38, 2560, v38
    v_add_u32 v38, 126976, v38
    v_mov_b32 v39, 0xf149
    s_waitcnt lgkmcnt(6)
    v_mfma_f32_32x32x16_bf16 v[176:191], v[48:51], a[212:215], v[176:191]
    ds_read_b64_tr_b16 v[44:45], v15 offset:16384
    ds_read_b64_tr_b16 v[46:47], v15 offset:17408
    s_mul_i32 s46, s95, 221184
    s_add_u32 m0, s51, 49152
    s_add_u32 s46, s46, s60
    buffer_load_dwordx4 v236, s[12:15], s46 offen offset:0 lds
    v_mfma_f32_32x32x16_bf16 v[192:207], v[52:55], a[212:215], v[192:207]
    ds_read_b64_tr_b16 v[48:49], v17 offset:16384
    ds_read_b64_tr_b16 v[50:51], v17 offset:17408
    v_cndmask_b32_e64 v96, 0, v39, s[90:91]
    v_mov_b32 v97, 0
    v_mov_b32 v98, 0
    v_mov_b32 v99, 0
    v_mfma_f32_32x32x16_bf16 v[176:191], v[56:59], a[200:203], v[176:191]
    ds_read_b64_tr_b16 v[52:53], v19 offset:16384
    ds_read_b64_tr_b16 v[54:55], v19 offset:17408
    ds_write_b128 v38, v[96:99]
    v_mfma_f32_32x32x16_bf16 v[192:207], v[60:63], a[200:203], v[192:207]
    ds_read_b64_tr_b16 v[56:57], v13 offset:20480
    ds_read_b64_tr_b16 v[58:59], v13 offset:21504
    s_add_u32 s67, s65, 20480
    buffer_load_dwordx4 a[20:23], v21, s[16:19], s67 offen offset:0 sc1
    s_waitcnt lgkmcnt(7)
    v_mfma_f32_32x32x16_bf16 v[176:191], v[64:67], a[216:219], v[176:191]
    ds_read_b64_tr_b16 v[60:61], v15 offset:20480
    ds_read_b64_tr_b16 v[62:63], v15 offset:21504
    v_mfma_f32_32x32x16_bf16 v[192:207], v[68:71], a[216:219], v[192:207]
    ds_read_b64_tr_b16 v[64:65], v17 offset:20480
    ds_read_b64_tr_b16 v[66:67], v17 offset:21504
    buffer_load_dwordx4 v237, s[12:15], s46 offen offset:1024 lds
    v_mfma_f32_32x32x16_bf16 v[176:191], v[40:43], a[220:223], v[176:191]
    ds_read_b64_tr_b16 v[68:69], v19 offset:20480
    ds_read_b64_tr_b16 v[70:71], v19 offset:21504
    v_mfma_f32_16x16x32_bf16 v[26:29], v[40:43], a[252:255], v[26:29]
    v_mfma_f32_32x32x16_bf16 v[192:207], v[44:47], a[220:223], v[192:207]
    ds_read_b64_tr_b16 v[40:41], v14 offset:16384
    ds_read_b64_tr_b16 v[42:43], v14 offset:17408
    s_waitcnt lgkmcnt(8)
    v_mfma_f32_32x32x16_bf16 v[176:191], v[48:51], a[236:239], v[176:191]
    ds_read_b64_tr_b16 v[44:45], v16 offset:16384
    ds_read_b64_tr_b16 v[46:47], v16 offset:17408
    buffer_load_dwordx4 v238, s[12:15], s46 offen offset:2048 lds
    s_getreg_b32 s86, hwreg(HW_REG_IB_STS, 30, 2)
    s_getreg_b32 s87, hwreg(HW_REG_IB_STS, 0, 4)
    s_lshl4_add_u32 s86, s86, s87
    s_or_b32 s86, s86, s3
    s_cmp_le_u32 s86, 12
    s_cbranch_scc0 L_tf7
    buffer_store_dword v253, v252, s[16:19], s92 offen sc1
    s_mov_b32 s3, 0x100
L_tf7:
    buffer_load_dwordx4 a[24:27], v21, s[16:19], s67 offen offset:1024 sc1
    v_mfma_f32_16x16x32_bf16 v[26:29], v[48:51], a[252:255], v[26:29]
    v_mfma_f32_32x32x16_bf16 v[192:207], v[52:55], a[236:239], v[192:207]
    ds_read_b64_tr_b16 v[48:49], v18 offset:16384
    ds_read_b64_tr_b16 v[50:51], v18 offset:17408
    v_mfma_f32_32x32x16_bf16 v[176:191], v[56:59], a[224:227], v[176:191]
    ds_read_b64_tr_b16 v[52:53], v20 offset:16384
    ds_read_b64_tr_b16 v[54:55], v20 offset:17408
    v_mfma_f32_16x16x32_bf16 v[26:29], v[56:59], a[252:255], v[26:29]
    s_waitcnt lgkmcnt(4)
    v_mfma_f32_32x32x16_bf16 v[192:207], v[60:63], a[224:227], v[192:207]
    ds_read_b64_tr_b16 v[56:57], v14 offset:20480
    ds_read_b64_tr_b16 v[58:59], v14 offset:21504
    buffer_load_dwordx4 v239, s[12:15], s46 offen offset:3072 lds
    v_mfma_f32_32x32x16_bf16 v[176:191], v[64:67], a[240:243], v[176:191]
    ds_read_b64_tr_b16 v[60:61], v16 offset:20480
    ds_read_b64_tr_b16 v[62:63], v16 offset:21504
    v_mfma_f32_16x16x32_bf16 v[26:29], v[64:67], a[252:255], v[26:29]
    v_mfma_f32_32x32x16_bf16 v[192:207], v[68:71], a[240:243], v[192:207]
    ds_read_b64_tr_b16 v[64:65], v18 offset:20480
    ds_read_b64_tr_b16 v[66:67], v18 offset:21504
    buffer_load_dwordx4 a[28:31], v21, s[16:19], s67 offen offset:2048 sc1
    v_mfma_f32_32x32x16_bf16 v[176:191], v[40:43], a[228:231], v[176:191]
    ds_read_b64_tr_b16 v[68:69], v20 offset:20480
    ds_read_b64_tr_b16 v[70:71], v20 offset:21504
    s_barrier
    v_mfma_f32_32x32x16_bf16 v[192:207], v[44:47], a[228:231], v[192:207]
    ds_read_b64_tr_b16 v[40:41], v72 offset:0
    ds_read_b64_tr_b16 v[42:43], v72 offset:1024
    ds_write_b128 v25, v[26:29] offset:512
    s_waitcnt lgkmcnt(9)
    v_mfma_f32_32x32x16_bf16 v[176:191], v[48:51], a[244:247], v[176:191]
    ds_read_b64_tr_b16 v[44:45], v74 offset:0
    ds_read_b64_tr_b16 v[46:47], v74 offset:1024
    s_mul_i32 s46, s96, 221184
    s_add_u32 m0, s51, 0
    s_add_u32 s46, s46, s60
    buffer_load_dwordx4 v236, s[12:15], s46 offen offset:0 lds
    v_mfma_f32_32x32x16_bf16 v[192:207], v[52:55], a[244:247], v[192:207]
    ds_read_b64_tr_b16 v[48:49], v76 offset:0
    ds_read_b64_tr_b16 v[50:51], v76 offset:1024
    v_mfma_f32_32x32x16_bf16 v[176:191], v[56:59], a[232:235], v[176:191]
    ds_read_b64_tr_b16 v[52:53], v78 offset:0
    ds_read_b64_tr_b16 v[54:55], v78 offset:1024
    s_waitcnt lgkmcnt(6)
    s_barrier
    ds_read_b32 v224, v23 offset:512
    ds_read_b32 v225, v23 offset:1536
    ds_read_b32 v228, v24 offset:640
    ds_read_b32 v229, v24 offset:1664
    buffer_load_dwordx4 a[32:35], v21, s[16:19], s67 offen offset:3072 sc1
    v_mfma_f32_32x32x16_bf16 v[192:207], v[60:63], a[232:235], v[192:207]
    ds_read_b64_tr_b16 v[56:57], v72 offset:4096
    ds_read_b64_tr_b16 v[58:59], v72 offset:5120
    v_mfma_f32_32x32x16_bf16 v[176:191], v[64:67], a[248:251], v[176:191]
    ds_read_b64_tr_b16 v[60:61], v74 offset:4096
    ds_read_b64_tr_b16 v[62:63], v74 offset:5120
    s_getreg_b32 s86, hwreg(HW_REG_IB_STS, 30, 2)
    s_getreg_b32 s87, hwreg(HW_REG_IB_STS, 0, 4)
    s_lshl4_add_u32 s86, s86, s87
    s_or_b32 s86, s86, s3
    s_cmp_le_u32 s86, 17
    s_cbranch_scc0 L_tf8
    buffer_store_dword v253, v252, s[16:19], s92 offen sc1
    s_mov_b32 s3, 0x100
L_tf8:
    v_mfma_f32_32x32x16_bf16 v[192:207], v[68:71], a[248:251], v[192:207]
    ds_read_b64_tr_b16 v[64:65], v76 offset:4096
    s_waitcnt lgkmcnt(5)
    ds_read_b64_tr_b16 v[66:67], v76 offset:5120
    buffer_load_dwordx4 v237, s[12:15], s46 offen offset:1024 lds
    v_add_f32 v224, v224, v225
    v_and_b32 v35, 0xffff0000, v224
    v_mfma_f32_32x32x16_bf16 v[112:127], v[40:43], a[92:95], 0
    ds_read_b64_tr_b16 v[68:69], v78 offset:4096
    ds_read_b64_tr_b16 v[70:71], v78 offset:5120
    v_sub_f32 v225, v224, v35
    v_and_b32 v35, 0xffff0000, v225
    v_alignbit_b32 v224, v35, v224, 16
    v_sub_f32 v225, v225, v35
    v_mfma_f32_16x16x32_bf16 v[26:29], v[40:43], a[252:255], 0
    v_or_b32 v224, v224, v35
    v_lshrrev_b32 v225, 16, v225
    v_mfma_f32_32x32x16_bf16 v[128:143], v[44:47], a[92:95], 0
    ds_read_b64_tr_b16 v[40:41], v73 offset:0
    ds_read_b64_tr_b16 v[42:43], v73 offset:1024
    s_add_u32 s67, s67, 4096
    buffer_load_dwordx4 a[36:39], v21, s[16:19], s67 offen offset:0 sc1
    v_add_f32 v228, v228, v229
    v_and_b32 v36, 0xffff0000, v228
    v_mfma_f32_32x32x16_bf16 v[112:127], v[48:51], a[108:111], v[112:127]
    ds_read_b64_tr_b16 v[44:45], v75 offset:0
    ds_read_b64_tr_b16 v[46:47], v75 offset:1024
    buffer_load_dwordx4 v238, s[12:15], s46 offen offset:2048 lds
    v_sub_f32 v229, v228, v36
    v_and_b32 v36, 0xffff0000, v229
    v_mfma_f32_16x16x32_bf16 v[26:29], v[48:51], a[252:255], v[26:29]
    v_alignbit_b32 v228, v36, v228, 16
    v_sub_f32 v229, v229, v36
    v_mfma_f32_32x32x16_bf16 v[128:143], v[52:55], a[108:111], v[128:143]
    ds_read_b64_tr_b16 v[48:49], v77 offset:0
    ds_read_b64_tr_b16 v[50:51], v77 offset:1024
    v_or_b32 v228, v228, v36
    v_lshrrev_b32 v229, 16, v229
    s_waitcnt lgkmcnt(4)
    v_mfma_f32_32x32x16_bf16 v[112:127], v[56:59], a[96:99], v[112:127]
    ds_read_b64_tr_b16 v[52:53], v79 offset:0
    ds_read_b64_tr_b16 v[54:55], v79 offset:1024
    v_mfma_f32_16x16x32_bf16 v[26:29], v[56:59], a[252:255], v[26:29]
    v_mfma_f32_32x32x16_bf16 v[128:143], v[60:63], a[96:99], v[128:143]
    ds_read_b64_tr_b16 v[56:57], v73 offset:4096
    ds_read_b64_tr_b16 v[58:59], v73 offset:5120
    buffer_load_dwordx4 v239, s[12:15], s46 offen offset:3072 lds
    v_mfma_f32_32x32x16_bf16 v[176:191], v[224:227], v[232:235], v[176:191]
    v_mfma_f32_32x32x16_bf16 v[112:127], v[64:67], a[112:115], v[112:127]
    ds_read_b64_tr_b16 v[60:61], v75 offset:4096
    ds_read_b64_tr_b16 v[62:63], v75 offset:5120
    v_mfma_f32_16x16x32_bf16 v[26:29], v[64:67], a[252:255], v[26:29]
    v_mfma_f32_32x32x16_bf16 v[128:143], v[68:71], a[112:115], v[128:143]
    ds_read_b64_tr_b16 v[64:65], v77 offset:4096
    ds_read_b64_tr_b16 v[66:67], v77 offset:5120
    s_add_u32 s67, s65, 40960
    buffer_load_dwordx4 a[40:43], v21, s[16:19], s67 offen offset:0 sc1
    v_mfma_f32_32x32x16_bf16 v[192:207], v[228:231], v[232:235], v[192:207]
    s_nop 1
    v_mul_f32 v88, v33, v176
    v_mul_f32 v89, v33, v177
    v_mul_f32 v90, v33, v178
    v_mul_f32 v91, v33, v179
    v_mul_f32 v92, v33, v180
    v_mul_f32 v93, v33, v181
    v_mfma_f32_32x32x16_bf16 v[112:127], v[40:43], a[100:103], v[112:127]
    ds_read_b64_tr_b16 v[68:69], v79 offset:4096
    ds_read_b64_tr_b16 v[70:71], v79 offset:5120
    s_waitcnt vmcnt(15)
    s_barrier
    v_mul_f32 v94, v33, v182
    v_mul_f32 v95, v33, v183
    s_waitcnt lgkmcnt(2)
    v_mfma_f32_32x32x16_bf16 v[128:143], v[44:47], a[100:103], v[128:143]
    ds_read_b64_tr_b16 v[40:41], v13 offset:32768
    ds_read_b64_tr_b16 v[42:43], v13 offset:33792
    v_exp_f32 v88, v88
    v_exp_f32 v89, v89
    v_mfma_f32_32x32x16_bf16 v[112:127], v[48:51], a[116:119], v[112:127]
    ds_read_b64_tr_b16 v[44:45], v15 offset:32768
    ds_read_b64_tr_b16 v[46:47], v15 offset:33792
    s_mul_i32 s46, s97, 221184
    s_add_u32 m0, s51, 16384
    s_add_u32 s46, s46, s60
    buffer_load_dwordx4 v236, s[12:15], s46 offen offset:0 lds
    s_cmp_lg_u32 s3, 0
    s_cbranch_scc1 L_tf9
    buffer_store_dword v253, v252, s[16:19], s92 offen sc1
    s_mov_b32 s3, 0x100
L_tf9:
    v_exp_f32 v90, v90
    v_mfma_f32_32x32x16_bf16 v[128:143], v[52:55], a[116:119], v[128:143]
    ds_read_b64_tr_b16 v[48:49], v17 offset:32768
    ds_read_b64_tr_b16 v[50:51], v17 offset:33792
    v_exp_f32 v91, v91
    v_exp_f32 v92, v92
    v_mfma_f32_32x32x16_bf16 v[112:127], v[56:59], a[104:107], v[112:127]
    ds_read_b64_tr_b16 v[52:53], v19 offset:32768
    ds_read_b64_tr_b16 v[54:55], v19 offset:33792
    buffer_load_dwordx4 a[44:47], v21, s[16:19], s67 offen offset:1024 sc1
    v_exp_f32 v93, v93
    v_mfma_f32_32x32x16_bf16 v[128:143], v[60:63], a[104:107], v[128:143]
    ds_read_b64_tr_b16 v[56:57], v13 offset:36864
    ds_read_b64_tr_b16 v[58:59], v13 offset:37888
    v_exp_f32 v94, v94
    v_exp_f32 v95, v95
    v_mfma_f32_32x32x16_bf16 v[112:127], v[64:67], a[120:123], v[112:127]
    ds_read_b64_tr_b16 v[60:61], v15 offset:36864
    ds_read_b64_tr_b16 v[62:63], v15 offset:37888
    v_fma_f32 v88, v88, v32, v32
    v_fma_f32 v89, v89, v32, v32
    v_fma_f32 v90, v90, v32, v32
    v_fma_f32 v91, v91, v32, v32
    s_waitcnt lgkmcnt(5)
    v_mfma_f32_32x32x16_bf16 v[128:143], v[68:71], a[120:123], v[128:143]
    ds_read_b64_tr_b16 v[64:65], v17 offset:36864
    ds_read_b64_tr_b16 v[66:67], v17 offset:37888
    buffer_load_dwordx4 v237, s[12:15], s46 offen offset:1024 lds
    v_fma_f32 v92, v92, v32, v32
    v_fma_f32 v93, v93, v32, v32
    v_mfma_f32_32x32x16_bf16 v[112:127], v[40:43], a[124:127], v[112:127]
    ds_read_b64_tr_b16 v[68:69], v19 offset:36864
    ds_read_b64_tr_b16 v[70:71], v19 offset:37888
    v_fma_f32 v94, v94, v32, v32
    v_fma_f32 v95, v95, v32, v32
    v_rcp_f32 v88, v88
    v_mfma_f32_16x16x32_bf16 v[26:29], v[40:43], a[252:255], v[26:29]
    v_rcp_f32 v89, v89
    v_mfma_f32_32x32x16_bf16 v[128:143], v[44:47], a[124:127], v[128:143]
    ds_read_b64_tr_b16 v[40:41], v14 offset:32768
    ds_read_b64_tr_b16 v[42:43], v14 offset:33792
    buffer_load_dwordx4 a[48:51], v21, s[16:19], s67 offen offset:2048 sc1
    v_rcp_f32 v90, v90
    v_rcp_f32 v91, v91
    v_mfma_f32_32x32x16_bf16 v[112:127], v[48:51], a[140:143], v[112:127]
    ds_read_b64_tr_b16 v[44:45], v16 offset:32768
    ds_read_b64_tr_b16 v[46:47], v16 offset:33792
    buffer_load_dwordx4 v238, s[12:15], s46 offen offset:2048 lds
    v_rcp_f32 v92, v92
    v_mfma_f32_16x16x32_bf16 v[26:29], v[48:51], a[252:255], v[26:29]
    v_rcp_f32 v93, v93
    s_waitcnt lgkmcnt(4)
    v_mfma_f32_32x32x16_bf16 v[128:143], v[52:55], a[140:143], v[128:143]
    ds_read_b64_tr_b16 v[48:49], v18 offset:32768
    ds_read_b64_tr_b16 v[50:51], v18 offset:33792
    v_rcp_f32 v94, v94
    v_rcp_f32 v95, v95
    v_mfma_f32_32x32x16_bf16 v[112:127], v[56:59], a[128:131], v[112:127]
    ds_read_b64_tr_b16 v[52:53], v20 offset:32768
    ds_read_b64_tr_b16 v[54:55], v20 offset:33792
    v_mul_f32 v176, v176, v88
    v_mul_f32 v177, v177, v89
    v_mul_f32 v178, v178, v90
    v_mul_f32 v179, v179, v91
    v_mfma_f32_16x16x32_bf16 v[26:29], v[56:59], a[252:255], v[26:29]
    v_mul_f32 v180, v180, v92
    v_mul_f32 v181, v181, v93
    v_mfma_f32_32x32x16_bf16 v[128:143], v[60:63], a[128:131], v[128:143]
    ds_read_b64_tr_b16 v[56:57], v14 offset:36864
    ds_read_b64_tr_b16 v[58:59], v14 offset:37888
    buffer_load_dwordx4 v239, s[12:15], s46 offen offset:3072 lds
    v_mul_f32 v182, v182, v94
    v_mul_f32 v183, v183, v95
    v_mfma_f32_32x32x16_bf16 v[112:127], v[64:67], a[144:147], v[112:127]
    ds_read_b64_tr_b16 v[60:61], v16 offset:36864
    ds_read_b64_tr_b16 v[62:63], v16 offset:37888
    buffer_load_dwordx4 a[52:55], v21, s[16:19], s67 offen offset:3072 sc1
    v_cvt_pk_bf16_f32 v104, v176, v177
    v_cvt_pk_bf16_f32 v105, v178, v179
    v_mfma_f32_16x16x32_bf16 v[26:29], v[64:67], a[252:255], v[26:29]
    v_cvt_pk_bf16_f32 v106, v180, v181
    v_cvt_pk_bf16_f32 v107, v182, v183
    v_mfma_f32_32x32x16_bf16 v[128:143], v[68:71], a[144:147], v[128:143]
    ds_read_b64_tr_b16 v[64:65], v18 offset:36864
    ds_read_b64_tr_b16 v[66:67], v18 offset:37888
    buffer_store_dwordx4 v[104:107], v21, s[16:19], s53 offen offset:0 sc1
    s_waitcnt lgkmcnt(5)
    v_mfma_f32_32x32x16_bf16 v[112:127], v[40:43], a[132:135], v[112:127]
    ds_read_b64_tr_b16 v[68:69], v20 offset:36864
    ds_read_b64_tr_b16 v[70:71], v20 offset:37888
    s_waitcnt vmcnt(16)
    s_barrier
    v_mul_f32 v96, v33, v184
    v_mul_f32 v97, v33, v185
    v_mfma_f32_32x32x16_bf16 v[128:143], v[44:47], a[132:135], v[128:143]
    ds_read_b64_tr_b16 v[40:41], v13 offset:49152
    ds_read_b64_tr_b16 v[42:43], v13 offset:50176
    v_mul_f32 v98, v33, v186
    v_mul_f32 v99, v33, v187
    v_mul_f32 v100, v33, v188
    v_mul_f32 v101, v33, v189
    v_mfma_f32_32x32x16_bf16 v[112:127], v[48:51], a[148:151], v[112:127]
    ds_read_b64_tr_b16 v[44:45], v15 offset:49152
    ds_read_b64_tr_b16 v[46:47], v15 offset:50176
    v_mul_f32 v102, v33, v190
    v_mul_f32 v103, v33, v191
    v_exp_f32 v96, v96
    v_mfma_f32_32x32x16_bf16 v[128:143], v[52:55], a[148:151], v[128:143]
    ds_read_b64_tr_b16 v[48:49], v17 offset:49152
    ds_read_b64_tr_b16 v[50:51], v17 offset:50176
    s_add_u32 s67, s67, 4096
    buffer_load_dwordx4 a[56:59], v21, s[16:19], s67 offen offset:0 sc1
    v_exp_f32 v97, v97
    v_exp_f32 v98, v98
    s_waitcnt lgkmcnt(4)
    v_mfma_f32_32x32x16_bf16 v[112:127], v[56:59], a[136:139], v[112:127]
    ds_read_b64_tr_b16 v[52:53], v19 offset:49152
    ds_read_b64_tr_b16 v[54:55], v19 offset:50176
    v_exp_f32 v99, v99
    v_exp_f32 v100, v100
    v_mfma_f32_32x32x16_bf16 v[128:143], v[60:63], a[136:139], v[128:143]
    ds_read_b64_tr_b16 v[56:57], v13 offset:53248
    ds_read_b64_tr_b16 v[58:59], v13 offset:54272
    v_exp_f32 v101, v101
    v_exp_f32 v102, v102
    v_mfma_f32_32x32x16_bf16 v[112:127], v[64:67], a[152:155], v[112:127]
    ds_read_b64_tr_b16 v[60:61], v15 offset:53248
    ds_read_b64_tr_b16 v[62:63], v15 offset:54272
    v_exp_f32 v103, v103
    v_fma_f32 v96, v96, v32, v32
    v_fma_f32 v97, v97, v32, v32
    v_mfma_f32_32x32x16_bf16 v[128:143], v[68:71], a[152:155], v[128:143]
    ds_read_b64_tr_b16 v[64:65], v17 offset:53248
    ds_read_b64_tr_b16 v[66:67], v17 offset:54272
    v_fma_f32 v98, v98, v32, v32
    v_fma_f32 v99, v99, v32, v32
    v_fma_f32 v100, v100, v32, v32
    v_fma_f32 v101, v101, v32, v32
    v_mfma_f32_32x32x16_bf16 v[112:127], v[40:43], a[156:159], v[112:127]
    ds_read_b64_tr_b16 v[68:69], v19 offset:53248
    ds_read_b64_tr_b16 v[70:71], v19 offset:54272
    v_fma_f32 v102, v102, v32, v32
    v_fma_f32 v103, v103, v32, v32
    v_rcp_f32 v96, v96
    v_mfma_f32_16x16x32_bf16 v[26:29], v[40:43], a[252:255], v[26:29]
    v_rcp_f32 v97, v97
    s_waitcnt lgkmcnt(4)
    v_mfma_f32_32x32x16_bf16 v[128:143], v[44:47], a[156:159], v[128:143]
    ds_read_b64_tr_b16 v[40:41], v14 offset:49152
    ds_read_b64_tr_b16 v[42:43], v14 offset:50176
    s_add_u32 s67, s65, 61440
    buffer_load_dwordx4 a[60:63], v21, s[16:19], s67 offen offset:0 sc1
    v_rcp_f32 v98, v98
    v_rcp_f32 v99, v99
    v_mfma_f32_32x32x16_bf16 v[112:127], v[48:51], a[172:175], v[112:127]
    ds_read_b64_tr_b16 v[44:45], v16 offset:49152
    ds_read_b64_tr_b16 v[46:47], v16 offset:50176
    v_rcp_f32 v100, v100
    v_rcp_f32 v101, v101
    v_mfma_f32_16x16x32_bf16 v[26:29], v[48:51], a[252:255], v[26:29]
    v_rcp_f32 v102, v102
    v_mfma_f32_32x32x16_bf16 v[128:143], v[52:55], a[172:175], v[128:143]
    ds_read_b64_tr_b16 v[48:49], v18 offset:49152
    ds_read_b64_tr_b16 v[50:51], v18 offset:50176
    v_rcp_f32 v103, v103
    v_mul_f32 v184, v184, v96
    v_mul_f32 v185, v185, v97
    v_mfma_f32_32x32x16_bf16 v[112:127], v[56:59], a[160:163], v[112:127]
    ds_read_b64_tr_b16 v[52:53], v20 offset:49152
    ds_read_b64_tr_b16 v[54:55], v20 offset:50176
    buffer_load_dword v251, v250, s[16:19], 0 offen sc1
    v_mul_f32 v186, v186, v98
    v_mul_f32 v187, v187, v99
    v_mfma_f32_16x16x32_bf16 v[26:29], v[56:59], a[252:255], v[26:29]
    v_mul_f32 v188, v188, v100
    v_mul_f32 v189, v189, v101
    v_mfma_f32_32x32x16_bf16 v[128:143], v[60:63], a[160:163], v[128:143]
    ds_read_b64_tr_b16 v[56:57], v14 offset:53248
    ds_read_b64_tr_b16 v[58:59], v14 offset:54272
    v_mul_f32 v190, v190, v102
    v_mul_f32 v191, v191, v103
    v_cvt_pk_bf16_f32 v108, v184, v185
    v_cvt_pk_bf16_f32 v109, v186, v187
    s_waitcnt lgkmcnt(4)
    v_mfma_f32_32x32x16_bf16 v[112:127], v[64:67], a[176:179], v[112:127]
    ds_read_b64_tr_b16 v[60:61], v16 offset:53248
    ds_read_b64_tr_b16 v[62:63], v16 offset:54272
    buffer_load_dwordx4 a[64:67], v21, s[16:19], s67 offen offset:1024 sc1
    v_cvt_pk_bf16_f32 v110, v188, v189
    v_cvt_pk_bf16_f32 v111, v190, v191
    v_mfma_f32_16x16x32_bf16 v[26:29], v[64:67], a[252:255], v[26:29]
    v_mfma_f32_32x32x16_bf16 v[128:143], v[68:71], a[176:179], v[128:143]
    ds_read_b64_tr_b16 v[64:65], v18 offset:53248
    ds_read_b64_tr_b16 v[66:67], v18 offset:54272
    buffer_store_dwordx4 v[108:111], v21, s[16:19], s53 offen offset:1024 sc1
    v_mfma_f32_32x32x16_bf16 v[112:127], v[40:43], a[164:167], v[112:127]
    ds_read_b64_tr_b16 v[68:69], v20 offset:53248
    ds_read_b64_tr_b16 v[70:71], v20 offset:54272
    s_waitcnt vmcnt(14)
    s_barrier
    v_mul_f32 v88, v33, v192
    v_mul_f32 v89, v33, v193
    v_mul_f32 v90, v33, v194
    v_mfma_f32_32x32x16_bf16 v[128:143], v[44:47], a[164:167], v[128:143]
    ds_read_b64_tr_b16 v[40:41], v13 offset:0
    ds_read_b64_tr_b16 v[42:43], v13 offset:1024
    v_mul_f32 v91, v33, v195
    v_mul_f32 v92, v33, v196
    v_mul_f32 v93, v33, v197
    v_mul_f32 v94, v33, v198
    v_mfma_f32_32x32x16_bf16 v[112:127], v[48:51], a[180:183], v[112:127]
    ds_read_b64_tr_b16 v[44:45], v15 offset:0
    ds_read_b64_tr_b16 v[46:47], v15 offset:1024
    v_mul_f32 v95, v33, v199
    v_exp_f32 v88, v88
    s_waitcnt lgkmcnt(4)
    v_mfma_f32_32x32x16_bf16 v[128:143], v[52:55], a[180:183], v[128:143]
    ds_read_b64_tr_b16 v[48:49], v17 offset:0
    ds_read_b64_tr_b16 v[50:51], v17 offset:1024
    buffer_load_dwordx4 a[68:71], v21, s[16:19], s67 offen offset:2048 sc1
    v_exp_f32 v89, v89
    v_exp_f32 v90, v90
    v_mfma_f32_32x32x16_bf16 v[112:127], v[56:59], a[168:171], v[112:127]
    ds_read_b64_tr_b16 v[52:53], v19 offset:0
    ds_read_b64_tr_b16 v[54:55], v19 offset:1024
    v_exp_f32 v91, v91
    v_exp_f32 v92, v92
    v_mfma_f32_32x32x16_bf16 v[128:143], v[60:63], a[168:171], v[128:143]
    ds_read_b64_tr_b16 v[56:57], v13 offset:4096
    ds_read_b64_tr_b16 v[58:59], v13 offset:5120
    v_exp_f32 v93, v93
    v_exp_f32 v94, v94
    v_mfma_f32_32x32x16_bf16 v[112:127], v[64:67], a[184:187], v[112:127]
    ds_read_b64_tr_b16 v[60:61], v15 offset:4096
    ds_read_b64_tr_b16 v[62:63], v15 offset:5120
    v_exp_f32 v95, v95
    v_fma_f32 v88, v88, v32, v32
    v_fma_f32 v89, v89, v32, v32
    v_mfma_f32_32x32x16_bf16 v[128:143], v[68:71], a[184:187], v[128:143]
    ds_read_b64_tr_b16 v[64:65], v17 offset:4096
    ds_read_b64_tr_b16 v[66:67], v17 offset:5120
    buffer_load_dwordx4 a[72:75], v21, s[16:19], s67 offen offset:3072 sc1
    v_fma_f32 v90, v90, v32, v32
    v_fma_f32 v91, v91, v32, v32
    v_fma_f32 v92, v92, v32, v32
    s_waitcnt lgkmcnt(4)
    v_mfma_f32_32x32x16_bf16 v[112:127], v[40:43], a[188:191], v[112:127]
    ds_read_b64_tr_b16 v[68:69], v19 offset:4096
    ds_read_b64_tr_b16 v[70:71], v19 offset:5120
    v_fma_f32 v93, v93, v32, v32
    v_fma_f32 v94, v94, v32, v32
    v_fma_f32 v95, v95, v32, v32
    v_mfma_f32_16x16x32_bf16 v[26:29], v[40:43], a[252:255], v[26:29]
    v_rcp_f32 v88, v88
    v_mfma_f32_32x32x16_bf16 v[128:143], v[44:47], a[188:191], v[128:143]
    ds_read_b64_tr_b16 v[40:41], v14 offset:0
    ds_read_b64_tr_b16 v[42:43], v14 offset:1024
    v_rcp_f32 v89, v89
    v_rcp_f32 v90, v90
    v_mfma_f32_32x32x16_bf16 v[112:127], v[48:51], a[204:207], v[112:127]
    ds_read_b64_tr_b16 v[44:45], v16 offset:0
    ds_read_b64_tr_b16 v[46:47], v16 offset:1024
    v_rcp_f32 v91, v91
    v_rcp_f32 v92, v92
    v_mfma_f32_16x16x32_bf16 v[26:29], v[48:51], a[252:255], v[26:29]
    v_rcp_f32 v93, v93
    v_mfma_f32_32x32x16_bf16 v[128:143], v[52:55], a[204:207], v[128:143]
    ds_read_b64_tr_b16 v[48:49], v18 offset:0
    ds_read_b64_tr_b16 v[50:51], v18 offset:1024
    v_rcp_f32 v94, v94
    v_rcp_f32 v95, v95
    v_mfma_f32_32x32x16_bf16 v[112:127], v[56:59], a[192:195], v[112:127]
    ds_read_b64_tr_b16 v[52:53], v20 offset:0
    ds_read_b64_tr_b16 v[54:55], v20 offset:1024
    v_mul_f32 v192, v192, v88
    v_mul_f32 v193, v193, v89
    v_mul_f32 v194, v194, v90
    v_mul_f32 v195, v195, v91
    v_mfma_f32_16x16x32_bf16 v[26:29], v[56:59], a[252:255], v[26:29]
    v_mul_f32 v196, v196, v92
    v_mul_f32 v197, v197, v93
    s_waitcnt lgkmcnt(4)
    v_mfma_f32_32x32x16_bf16 v[128:143], v[60:63], a[192:195], v[128:143]
    ds_read_b64_tr_b16 v[56:57], v14 offset:4096
    ds_read_b64_tr_b16 v[58:59], v14 offset:5120
    s_add_u32 s67, s67, 4096
    buffer_load_dwordx4 a[76:79], v21, s[16:19], s67 offen offset:0 sc1
    v_mul_f32 v198, v198, v94
    v_mul_f32 v199, v199, v95
    v_cvt_pk_bf16_f32 v104, v192, v193
    v_mfma_f32_32x32x16_bf16 v[112:127], v[64:67], a[208:211], v[112:127]
    ds_read_b64_tr_b16 v[60:61], v16 offset:4096
    ds_read_b64_tr_b16 v[62:63], v16 offset:5120
    v_cvt_pk_bf16_f32 v105, v194, v195
    v_cvt_pk_bf16_f32 v106, v196, v197
    v_cvt_pk_bf16_f32 v107, v198, v199
    v_mfma_f32_16x16x32_bf16 v[26:29], v[64:67], a[252:255], v[26:29]
    v_mfma_f32_32x32x16_bf16 v[128:143], v[68:71], a[208:211], v[128:143]
    ds_read_b64_tr_b16 v[64:65], v18 offset:4096
    ds_read_b64_tr_b16 v[66:67], v18 offset:5120
    buffer_store_dwordx4 v[104:107], v21, s[16:19], s54 offen offset:0 sc1
    v_mfma_f32_32x32x16_bf16 v[112:127], v[40:43], a[196:199], v[112:127]
    ds_read_b64_tr_b16 v[68:69], v20 offset:4096
    ds_read_b64_tr_b16 v[70:71], v20 offset:5120
    s_waitcnt vmcnt(11)
    s_barrier
    s_waitcnt vmcnt(6)
    v_cmp_ne_u32 vcc, 0, v251
    s_nop 0
    s_or_b64 vcc, vcc, s[62:63]
    s_cmp_eq_u64 vcc, -1
    s_cbranch_scc0 L_spin8
L_back8:
    v_mul_f32 v96, v33, v200
    v_mul_f32 v97, v33, v201
    v_mul_f32 v98, v33, v202
    v_mfma_f32_32x32x16_bf16 v[128:143], v[44:47], a[196:199], v[128:143]
    ds_read_b64_tr_b16 v[40:41], v13 offset:16384
    ds_read_b64_tr_b16 v[42:43], v13 offset:17408
    v_mul_f32 v99, v33, v203
    v_mul_f32 v100, v33, v204
    v_mul_f32 v101, v33, v205
    v_mul_f32 v102, v33, v206
    s_waitcnt lgkmcnt(3)
    v_mfma_f32_32x32x16_bf16 v[112:127], v[48:51], a[212:215], v[112:127]
    ds_read_b64_tr_b16 v[44:45], v15 offset:16384
    ds_read_b64_tr_b16 v[46:47], v15 offset:17408
    s_lshl_b32 s83, s39, 2
    s_add_u32 s83, s83, s36
    s_mul_i32 s83, s83, 81920
    s_mul_i32 s84, s40, 2560
    s_add_u32 s83, s83, s84
    v_and_b32 v37, 0x1ff, v21
    buffer_load_dwordx4 v[240:243], v21, s[16:19], s83 offen sc1
    v_mul_f32 v103, v33, v207
    v_exp_f32 v96, v96
    v_mfma_f32_32x32x16_bf16 v[128:143], v[52:55], a[212:215], v[128:143]
    ds_read_b64_tr_b16 v[48:49], v17 offset:16384
    ds_read_b64_tr_b16 v[50:51], v17 offset:17408
    v_exp_f32 v97, v97
    v_exp_f32 v98, v98
    v_mfma_f32_32x32x16_bf16 v[112:127], v[56:59], a[200:203], v[112:127]
    ds_read_b64_tr_b16 v[52:53], v19 offset:16384
    ds_read_b64_tr_b16 v[54:55], v19 offset:17408
    v_exp_f32 v99, v99
    v_exp_f32 v100, v100
    v_mfma_f32_32x32x16_bf16 v[128:143], v[60:63], a[200:203], v[128:143]
    ds_read_b64_tr_b16 v[56:57], v13 offset:20480
    ds_read_b64_tr_b16 v[58:59], v13 offset:21504
    buffer_load_dwordx4 v[248:251], v37, s[16:19], s83 offen offset:1024 sc1
    v_exp_f32 v101, v101
    v_exp_f32 v102, v102
    v_mfma_f32_32x32x16_bf16 v[112:127], v[64:67], a[216:219], v[112:127]
    ds_read_b64_tr_b16 v[60:61], v15 offset:20480
    ds_read_b64_tr_b16 v[62:63], v15 offset:21504
    buffer_load_dwordx4 v[244:247], v21, s[16:19], s83 offen offset:1536 sc1
    v_exp_f32 v103, v103
    v_fma_f32 v96, v96, v32, v32
    s_waitcnt lgkmcnt(4)
    v_mfma_f32_32x32x16_bf16 v[128:143], v[68:71], a[216:219], v[128:143]
    ds_read_b64_tr_b16 v[64:65], v17 offset:20480
    ds_read_b64_tr_b16 v[66:67], v17 offset:21504
    v_fma_f32 v97, v97, v32, v32
    v_fma_f32 v98, v98, v32, v32
    v_fma_f32 v99, v99, v32, v32
    v_fma_f32 v100, v100, v32, v32
    v_mfma_f32_32x32x16_bf16 v[112:127], v[40:43], a[220:223], v[112:127]
    ds_read_b64_tr_b16 v[68:69], v19 offset:20480
    ds_read_b64_tr_b16 v[70:71], v19 offset:21504
    s_add_u32 s84, s82, 0
    s_mul_i32 s83, s84, s79
    s_add_u32 s83, s83, s81
    s_cmp_lt_i32 s84, 0
    s_cselect_b32 s83, 2146435072, s83
    s_add_u32 m0, s80, 0
    s_nop 0
    buffer_load_dwordx4 v1, s[16:19], s83 offen offset:0 sc1 lds
    v_fma_f32 v101, v101, v32, v32
    v_fma_f32 v102, v102, v32, v32
    v_fma_f32 v103, v103, v32, v32
    v_mfma_f32_16x16x32_bf16 v[26:29], v[40:43], a[252:255], v[26:29]
    v_rcp_f32 v96, v96
    v_mfma_f32_32x32x16_bf16 v[128:143], v[44:47], a[220:223], v[128:143]
    ds_read_b64_tr_b16 v[40:41], v14 offset:16384
    ds_read_b64_tr_b16 v[42:43], v14 offset:17408
    v_rcp_f32 v97, v97
    v_rcp_f32 v98, v98
    v_mfma_f32_32x32x16_bf16 v[112:127], v[48:51], a[236:239], v[112:127]
    ds_read_b64_tr_b16 v[44:45], v16 offset:16384
    ds_read_b64_tr_b16 v[46:47], v16 offset:17408
    v_rcp_f32 v99, v99
    v_rcp_f32 v100, v100
    v_mfma_f32_16x16x32_bf16 v[26:29], v[48:51], a[252:255], v[26:29]
    v_rcp_f32 v101, v101
    v_mfma_f32_32x32x16_bf16 v[128:143], v[52:55], a[236:239], v[128:143]
    ds_read_b64_tr_b16 v[48:49], v18 offset:16384
    ds_read_b64_tr_b16 v[50:51], v18 offset:17408
    buffer_load_dwordx4 v2, s[16:19], s83 offen offset:1024 sc1 lds
    v_rcp_f32 v102, v102
    v_rcp_f32 v103, v103
    s_waitcnt lgkmcnt(4)
    v_mfma_f32_32x32x16_bf16 v[112:127], v[56:59], a[224:227], v[112:127]
    ds_read_b64_tr_b16 v[52:53], v20 offset:16384
    ds_read_b64_tr_b16 v[54:55], v20 offset:17408
    buffer_load_dwordx4 v3, s[16:19], s83 offen offset:2048 sc1 lds
    v_mul_f32 v200, v200, v96
    v_mul_f32 v201, v201, v97
    v_mul_f32 v202, v202, v98
    v_mfma_f32_16x16x32_bf16 v[26:29], v[56:59], a[252:255], v[26:29]
    v_mul_f32 v203, v203, v99
    v_mul_f32 v204, v204, v100
    v_mfma_f32_32x32x16_bf16 v[128:143], v[60:63], a[224:227], v[128:143]
    ds_read_b64_tr_b16 v[56:57], v14 offset:20480
    ds_read_b64_tr_b16 v[58:59], v14 offset:21504
    v_mul_f32 v205, v205, v101
    v_mul_f32 v206, v206, v102
    v_mul_f32 v207, v207, v103
    v_cvt_pk_bf16_f32 v108, v200, v201
    v_mfma_f32_32x32x16_bf16 v[112:127], v[64:67], a[240:243], v[112:127]
    ds_read_b64_tr_b16 v[60:61], v16 offset:20480
    ds_read_b64_tr_b16 v[62:63], v16 offset:21504
    buffer_load_dwordx4 v4, s[16:19], s83 offen offset:3072 sc1 lds
    v_cvt_pk_bf16_f32 v109, v202, v203
    v_cvt_pk_bf16_f32 v110, v204, v205
    v_cvt_pk_bf16_f32 v111, v206, v207
    v_mfma_f32_16x16x32_bf16 v[26:29], v[64:67], a[252:255], v[26:29]
    v_mfma_f32_32x32x16_bf16 v[128:143], v[68:71], a[240:243], v[128:143]
    ds_read_b64_tr_b16 v[64:65], v18 offset:20480
    ds_read_b64_tr_b16 v[66:67], v18 offset:21504
    s_add_u32 m0, s80, 4096
    s_nop 0
    buffer_load_dwordx4 v87, s[16:19], s83 offen offset:0 sc1 lds
    buffer_store_dwordx4 v[108:111], v21, s[16:19], s54 offen offset:1024 sc1
    v_mfma_f32_32x32x16_bf16 v[112:127], v[40:43], a[228:231], v[112:127]
    ds_read_b64_tr_b16 v[68:69], v20 offset:20480
    ds_read_b64_tr_b16 v[70:71], v20 offset:21504
    s_waitcnt lgkmcnt(6)
    v_mfma_f32_32x32x16_bf16 v[128:143], v[44:47], a[228:231], v[128:143]
    ds_write_b128 v25, v[26:29] offset:768
    v_mfma_f32_32x32x16_bf16 v[112:127], v[48:51], a[244:247], v[112:127]
    s_add_u32 s84, s82, 1
    s_mul_i32 s83, s84, s79
    s_add_u32 s83, s83, s81
    s_cmp_lt_i32 s84, 0
    s_cselect_b32 s83, 2146435072, s83
    s_add_u32 m0, s80, 5120
    s_nop 0
    buffer_load_dwordx4 v1, s[16:19], s83 offen offset:0 sc1 lds
    v_mfma_f32_32x32x16_bf16 v[128:143], v[52:55], a[244:247], v[128:143]
    v_mfma_f32_32x32x16_bf16 v[112:127], v[56:59], a[232:235], v[112:127]
    s_waitcnt lgkmcnt(0)
    s_barrier
    ds_read_b32 v224, v23 offset:768
    ds_read_b32 v225, v23 offset:1792
    ds_read_b32 v228, v24 offset:896
    ds_read_b32 v229, v24 offset:1920
    buffer_load_dwordx4 v2, s[16:19], s83 offen offset:1024 sc1 lds
    v_mfma_f32_32x32x16_bf16 v[128:143], v[60:63], a[232:235], v[128:143]
    buffer_load_dwordx4 v3, s[16:19], s83 offen offset:2048 sc1 lds
    v_mfma_f32_32x32x16_bf16 v[112:127], v[64:67], a[248:251], v[112:127]
    v_mfma_f32_32x32x16_bf16 v[128:143], v[68:71], a[248:251], v[128:143]
    s_waitcnt lgkmcnt(2)
    v_add_f32 v224, v224, v225
    v_and_b32 v35, 0xffff0000, v224
    v_sub_f32 v225, v224, v35
    v_and_b32 v35, 0xffff0000, v225
    v_alignbit_b32 v224, v35, v224, 16
    v_sub_f32 v225, v225, v35
    v_or_b32 v224, v224, v35
    v_lshrrev_b32 v225, 16, v225
    s_nop 1
    v_mfma_f32_32x32x16_bf16 v[112:127], v[224:227], v[232:235], v[112:127]
    s_waitcnt lgkmcnt(0)
    v_add_f32 v228, v228, v229
    v_and_b32 v36, 0xffff0000, v228
    v_sub_f32 v229, v228, v36
    v_and_b32 v36, 0xffff0000, v229
    v_alignbit_b32 v228, v36, v228, 16
    v_sub_f32 v229, v229, v36
    v_or_b32 v228, v228, v36
    v_lshrrev_b32 v229, 16, v229
    s_nop 1
    v_mfma_f32_32x32x16_bf16 v[128:143], v[228:231], v[232:235], v[128:143]
    buffer_load_dwordx4 v4, s[16:19], s83 offen offset:3072 sc1 lds
    v_mul_f32 v88, v33, v112
    v_mul_f32 v89, v33, v113
    v_mul_f32 v90, v33, v114
    v_mul_f32 v91, v33, v115
    s_add_u32 m0, s80, 9216
    s_nop 0
    buffer_load_dwordx4 v87, s[16:19], s83 offen offset:0 sc1 lds
    v_mul_f32 v92, v33, v116
    v_mul_f32 v93, v33, v117
    v_mul_f32 v94, v33, v118
    v_mul_f32 v95, v33, v119
    v_exp_f32 v88, v88
    v_exp_f32 v89, v89
    v_exp_f32 v90, v90
    v_exp_f32 v91, v91
    v_exp_f32 v92, v92
    v_exp_f32 v93, v93
    v_exp_f32 v94, v94
    v_exp_f32 v95, v95
    s_add_u32 s84, s82, 2
    s_mul_i32 s83, s84, s79
    s_add_u32 s83, s83, s81
    s_cmp_lt_i32 s84, 0
    s_cselect_b32 s83, 2146435072, s83
    s_add_u32 m0, s80, 10240
    s_nop 0
    buffer_load_dwordx4 v1, s[16:19], s83 offen offset:0 sc1 lds
    v_fma_f32 v88, v88, v32, v32
    v_fma_f32 v89, v89, v32, v32
    v_fma_f32 v90, v90, v32, v32
    v_fma_f32 v91, v91, v32, v32
    v_fma_f32 v92, v92, v32, v32
    v_fma_f32 v93, v93, v32, v32
    v_fma_f32 v94, v94, v32, v32
    v_fma_f32 v95, v95, v32, v32
    v_rcp_f32 v88, v88
    v_rcp_f32 v89, v89
    v_rcp_f32 v90, v90
    v_rcp_f32 v91, v91
    buffer_load_dwordx4 v2, s[16:19], s83 offen offset:1024 sc1 lds
    buffer_load_dwordx4 v3, s[16:19], s83 offen offset:2048 sc1 lds
    v_rcp_f32 v92, v92
    v_rcp_f32 v93, v93
    v_rcp_f32 v94, v94
    v_rcp_f32 v95, v95
    buffer_load_dwordx4 v4, s[16:19], s83 offen offset:3072 sc1 lds
    v_mul_f32 v112, v112, v88
    v_mul_f32 v113, v113, v89
    v_mul_f32 v114, v114, v90
    v_mul_f32 v115, v115, v91
    s_add_u32 m0, s80, 14336
    s_nop 0
    buffer_load_dwordx4 v87, s[16:19], s83 offen offset:0 sc1 lds
    v_mul_f32 v116, v116, v92
    v_mul_f32 v117, v117, v93
    v_mul_f32 v118, v118, v94
    v_mul_f32 v119, v119, v95
    v_cvt_pk_bf16_f32 v104, v112, v113
    v_cvt_pk_bf16_f32 v105, v114, v115
    v_cvt_pk_bf16_f32 v106, v116, v117
    v_cvt_pk_bf16_f32 v107, v118, v119
    s_add_u32 s67, s65, 81920
    buffer_load_dwordx4 a[80:83], v21, s[16:19], s67 offen offset:0 sc1
    buffer_store_dwordx4 v[104:107], v21, s[16:19], s55 offen offset:0 sc1
    v_mul_f32 v96, v33, v120
    v_mul_f32 v97, v33, v121
    v_mul_f32 v98, v33, v122
    v_mul_f32 v99, v33, v123
    v_mul_f32 v100, v33, v124
    v_mul_f32 v101, v33, v125
    v_mul_f32 v102, v33, v126
    v_mul_f32 v103, v33, v127
    v_exp_f32 v96, v96
    v_exp_f32 v97, v97
    v_exp_f32 v98, v98
    buffer_load_dwordx4 a[84:87], v21, s[16:19], s67 offen offset:1024 sc1
    v_exp_f32 v99, v99
    v_exp_f32 v100, v100
    v_exp_f32 v101, v101
    v_exp_f32 v102, v102
    v_exp_f32 v103, v103
    v_fma_f32 v96, v96, v32, v32
    v_fma_f32 v97, v97, v32, v32
    v_fma_f32 v98, v98, v32, v32
    buffer_load_dwordx4 a[88:91], v21, s[16:19], s67 offen offset:2048 sc1
    v_fma_f32 v99, v99, v32, v32
    v_fma_f32 v100, v100, v32, v32
    v_fma_f32 v101, v101, v32, v32
    v_fma_f32 v102, v102, v32, v32
    buffer_load_dwordx4 a[92:95], v21, s[16:19], s67 offen offset:3072 sc1
    v_fma_f32 v103, v103, v32, v32
    v_rcp_f32 v96, v96
    v_rcp_f32 v97, v97
    v_rcp_f32 v98, v98
    v_rcp_f32 v99, v99
    v_rcp_f32 v100, v100
    v_rcp_f32 v101, v101
    v_rcp_f32 v102, v102
    v_rcp_f32 v103, v103
    v_mul_f32 v120, v120, v96
    v_mul_f32 v121, v121, v97
    v_mul_f32 v122, v122, v98
    s_add_u32 s67, s67, 4096
    buffer_load_dwordx4 a[96:99], v21, s[16:19], s67 offen offset:0 sc1
    v_mul_f32 v123, v123, v99
    v_mul_f32 v124, v124, v100
    v_mul_f32 v125, v125, v101
    v_mul_f32 v126, v126, v102
    v_mul_f32 v127, v127, v103
    v_cvt_pk_bf16_f32 v108, v120, v121
    v_cvt_pk_bf16_f32 v109, v122, v123
    v_cvt_pk_bf16_f32 v110, v124, v125
    v_cvt_pk_bf16_f32 v111, v126, v127
    buffer_store_dwordx4 v[108:111], v21, s[16:19], s55 offen offset:1024 sc1
    v_mul_f32 v88, v33, v128
    v_mul_f32 v89, v33, v129
    v_mul_f32 v90, v33, v130
    v_mul_f32 v91, v33, v131
    v_mul_f32 v92, v33, v132
    v_mul_f32 v93, v33, v133
    v_mul_f32 v94, v33, v134
    v_mul_f32 v95, v33, v135
    v_exp_f32 v88, v88
    v_exp_f32 v89, v89
    v_exp_f32 v90, v90
    v_exp_f32 v91, v91
    v_exp_f32 v92, v92
    v_exp_f32 v93, v93
    v_exp_f32 v94, v94
    v_exp_f32 v95, v95
    v_fma_f32 v88, v88, v32, v32
    v_fma_f32 v89, v89, v32, v32
    v_fma_f32 v90, v90, v32, v32
    v_fma_f32 v91, v91, v32, v32
    v_fma_f32 v92, v92, v32, v32
    v_fma_f32 v93, v93, v32, v32
    v_fma_f32 v94, v94, v32, v32
    v_fma_f32 v95, v95, v32, v32
    v_rcp_f32 v88, v88
    v_rcp_f32 v89, v89
    v_rcp_f32 v90, v90
    v_rcp_f32 v91, v91
    v_rcp_f32 v92, v92
    v_rcp_f32 v93, v93
    v_rcp_f32 v94, v94
    v_rcp_f32 v95, v95
    v_mul_f32 v128, v128, v88
    v_mul_f32 v129, v129, v89
    v_mul_f32 v130, v130, v90
    v_mul_f32 v131, v131, v91
    v_mul_f32 v132, v132, v92
    v_mul_f32 v133, v133, v93
    v_mul_f32 v134, v134, v94
    v_mul_f32 v135, v135, v95
    v_cvt_pk_bf16_f32 v104, v128, v129
    v_cvt_pk_bf16_f32 v105, v130, v131
    v_cvt_pk_bf16_f32 v106, v132, v133
    v_cvt_pk_bf16_f32 v107, v134, v135
    buffer_store_dwordx4 v[104:107], v21, s[16:19], s56 offen offset:0 sc1
    v_mul_f32 v96, v33, v136
    v_mul_f32 v97, v33, v137
    v_mul_f32 v98, v33, v138
    v_mul_f32 v99, v33, v139
    v_mul_f32 v100, v33, v140
    v_mul_f32 v101, v33, v141
    v_mul_f32 v102, v33, v142
    v_mul_f32 v103, v33, v143
    v_exp_f32 v96, v96
    v_exp_f32 v97, v97
    v_exp_f32 v98, v98
    v_exp_f32 v99, v99
    v_exp_f32 v100, v100
    v_exp_f32 v101, v101
    v_exp_f32 v102, v102
    v_exp_f32 v103, v103
    v_fma_f32 v96, v96, v32, v32
    v_fma_f32 v97, v97, v32, v32
    v_fma_f32 v98, v98, v32, v32
    v_fma_f32 v99, v99, v32, v32
    v_fma_f32 v100, v100, v32, v32
    v_fma_f32 v101, v101, v32, v32
    v_fma_f32 v102, v102, v32, v32
    v_fma_f32 v103, v103, v32, v32
    v_rcp_f32 v96, v96
    v_rcp_f32 v97, v97
    v_rcp_f32 v98, v98
    v_rcp_f32 v99, v99
    v_rcp_f32 v100, v100
    v_rcp_f32 v101, v101
    v_rcp_f32 v102, v102
    v_rcp_f32 v103, v103
    v_mul_f32 v136, v136, v96
    v_mul_f32 v137, v137, v97
    v_mul_f32 v138, v138, v98
    v_mul_f32 v139, v139, v99
    v_mul_f32 v140, v140, v100
    v_mul_f32 v141, v141, v101
    v_mul_f32 v142, v142, v102
    v_mul_f32 v143, v143, v103
    v_cvt_pk_bf16_f32 v108, v136, v137
    v_cvt_pk_bf16_f32 v109, v138, v139
    v_cvt_pk_bf16_f32 v110, v140, v141
    v_cvt_pk_bf16_f32 v111, v142, v143
    buffer_store_dwordx4 v[108:111], v21, s[16:19], s56 offen offset:1024 sc1
    s_waitcnt vmcnt(9)
    s_branch L_att
L_retile:
    s_getpc_b64 s[66:67]
L_pc10:
    s_sub_u32 s66, s66, L_pc10-parallel_sum__sliding_block__dense_activation_silu__prompt_kernel
    s_subb_u32 s67, s67, 0
    s_lshr_b32 s65, s2, 3
    s_lshl_b32 s65, s65, 2
    s_add_u32 s65, s65, s36
    s_lshl_b32 s65, s65, 10
    s_min_u32 s65, s65, (L_codeend-parallel_sum__sliding_block__dense_activation_silu__prompt_kernel-1024)&0xffffff80
    v_add_u32 v249, s65, v21
    global_load_dwordx4 v[244:247], v249, s[66:67]
    s_mov_b32 s14, 2211840
    s_mov_b32 s15, 0x20000
    s_mov_b32 s18, 20795392
    s_mov_b32 s19, 0x20000
    s_mov_b32 s22, 2621440
    s_mov_b32 s23, 0x20000
    s_mov_b32 s26, 256
    s_mov_b32 s27, 0x20000
    s_mov_b32 s30, 2211840
    s_mov_b32 s31, 0x20000
    s_mov_b32 s34, 819200
    s_mov_b32 s35, 0x20000
    s_and_b32 s90, s2, 7
    s_lshr_b32 s91, s2, 3
    s_lshr_b32 s48, s91, 2
    s_lshr_b32 s47, s90, 1
    s_lshl_b32 s47, s47, 3
    s_add_u32 s41, s47, s48
    s_and_b32 s48, s91, 3
    s_and_b32 s47, s90, 1
    s_lshl_b32 s47, s47, 2
    s_add_u32 s42, s47, s48
    s_lshr_b32 s39, s91, 1
    s_and_b32 s48, s91, 1
    s_lshl_b32 s47, s90, 1
    s_add_u32 s40, s47, s48
    s_and_b32 s43, s36, 1
    s_lshr_b32 s44, s36, 1
    s_mov_b32 s58, 0x3f803f80
    v_cmp_eq_u32 vcc, 0, v0
    v_mov_b32 v252, 0x7ff00000
    v_mov_b32 v253, 1
    v_cndmask_b32_e64 v252, v252, 0, vcc
    s_waitcnt lgkmcnt(0)
    s_cmp_ge_u32 s37, 4
    s_cbranch_scc1 L_noclear
    v_mov_b32 v4, 0
    v_mov_b32 v5, 0
    v_mov_b32 v6, 0
    v_mov_b32 v7, 0
    s_lshl2_add_u32 s46, s37, s36
    s_lshl_b32 s45, s46, 12
    s_add_u32 s45, s45, 20594688
    s_lshl_b32 s46, s46, 8
    s_add_u32 s46, s46, 20660224
    s_lshl_b32 s47, s37, 2
    v_lshlrev_b32 v8, 2, v0
    buffer_store_dwordx4 v[4:7], v21, s[16:19], s45 offen offset:0 sc1
    buffer_store_dwordx4 v[4:7], v21, s[16:19], s45 offen offset:1024 sc1
    buffer_store_dwordx4 v[4:7], v21, s[16:19], s45 offen offset:2048 sc1
    buffer_store_dwordx4 v[4:7], v21, s[16:19], s45 offen offset:3072 sc1
    buffer_store_dword v4, v8, s[16:19], s46 offen sc1
    s_waitcnt vmcnt(0)
    s_barrier
    s_cmp_lg_u32 s36, 0
    s_cbranch_scc1 L_noclear
    buffer_store_dword v253, v252, s[24:27], s47 offen sc1
L_noclear:
    v_and_b32 v88, 31, v0
    v_lshrrev_b32 v89, 5, v0
    v_mul_u32_u24 v90, 1280, v89
    v_lshl_add_u32 v90, v88, 4, v90
    v_bfe_u32 v91, v0, 4, 1
    v_lshl_add_u32 v91, v91, 30, v90
    s_lshl_b32 s86, s37, 4
    s_add_u32 s86, s86, s38
    s_lshl_b32 s86, s86, 2
    s_add_u32 s86, s86, s36
    s_mul_i32 s87, s86, 2560
    buffer_load_dwordx4 v[92:95], v90, s[4:7], s87 offen
    buffer_load_dwordx4 v[96:99], v90, s[4:7], s87 offen offset:512
    buffer_load_dwordx4 v[100:103], v91, s[4:7], s87 offen offset:1024
    v_add_u32 v10, 0, v0
    v_mul_u32_u24 v11, 1639, v10
    v_lshrrev_b32 v11, 16, v11
    v_mul_u32_u24 v12, 40, v11
    v_sub_u32 v12, v10, v12
    v_mul_u32_u24 v11, 1280, v11
    v_lshl_add_u32 v13, v12, 4, v11
    v_add_u32 v10, 64, v0
    v_mul_u32_u24 v11, 1639, v10
    v_lshrrev_b32 v11, 16, v11
    v_mul_u32_u24 v12, 40, v11
    v_sub_u32 v12, v10, v12
    v_mul_u32_u24 v11, 1280, v11
    v_lshl_add_u32 v14, v12, 4, v11
    v_add_u32 v10, 128, v0
    v_mul_u32_u24 v11, 1639, v10
    v_lshrrev_b32 v11, 16, v11
    v_mul_u32_u24 v12, 40, v11
    v_sub_u32 v12, v10, v12
    v_mul_u32_u24 v11, 1280, v11
    v_lshl_add_u32 v15, v12, 4, v11
    v_add_u32 v10, 192, v0
    v_mul_u32_u24 v11, 1639, v10
    v_lshrrev_b32 v11, 16, v11
    v_mul_u32_u24 v12, 40, v11
    v_sub_u32 v12, v10, v12
    v_mul_u32_u24 v11, 1280, v11
    v_lshl_add_u32 v16, v12, 4, v11
    v_add_u32 v10, 256, v0
    v_mul_u32_u24 v11, 1639, v10
    v_lshrrev_b32 v11, 16, v11
    v_mul_u32_u24 v12, 40, v11
    v_sub_u32 v12, v10, v12
    v_mul_u32_u24 v11, 1280, v11
    v_lshl_add_u32 v17, v12, 4, v11
    v_lshrrev_b32 v10, 4, v0
    v_bfe_u32 v11, v0, 2, 2
    v_lshl_add_u32 v10, v10, 3, v11
    v_mul_u32_u24 v10, 640, v10
    v_and_b32 v11, 3, v0
    v_mul_u32_u24 v11, 40, v11
    s_mul_i32 s52, s36, 40960
    v_add3_u32 v9, v10, v11, s52
    s_lshl_b32 s59, s36, 4
    s_add_u32 s59, s59, s37
    s_add_u32 s45, s59, 0
    s_lshr_b32 s46, s45, 1
    s_and_b32 s47, s45, 1
    s_mul_i32 s47, s47, 640
    s_sub_u32 s48, s46, 54
    s_cmp_lt_u32 s46, 54
    s_cselect_b32 s48, s46, s48
    s_cselect_b32 s8, s28, s32
    s_cselect_b32 s9, s29, s33
    s_cselect_b32 s10, s30, s34
    s_mul_i32 s48, s48, 40960
    s_add_u32 s49, s48, s47
    s_cmp_lt_u32 s45, 148
    s_cselect_b32 s49, s49, 2146435072
    s_add_u32 m0, s52, 0
    s_add_u32 s45, s49, 0
    buffer_load_dwordx4 v13, s[8:11], s45 offen lds
    s_add_u32 m0, s52, 1024
    s_add_u32 s45, s49, 0
    buffer_load_dwordx4 v14, s[8:11], s45 offen lds
    s_add_u32 m0, s52, 2048
    s_add_u32 s45, s49, 0
    buffer_load_dwordx4 v15, s[8:11], s45 offen lds
    s_add_u32 m0, s52, 3072
    s_add_u32 s45, s49, 0
    buffer_load_dwordx4 v16, s[8:11], s45 offen lds
    s_add_u32 m0, s52, 4096
    s_add_u32 s45, s49, 0
    buffer_load_dwordx4 v17, s[8:11], s45 offen lds
    s_add_u32 m0, s52, 5120
    s_add_u32 s45, s49, 10240
    buffer_load_dwordx4 v13, s[8:11], s45 offen lds
    s_add_u32 m0, s52, 6144
    s_add_u32 s45, s49, 10240
    buffer_load_dwordx4 v14, s[8:11], s45 offen lds
    s_add_u32 m0, s52, 7168
    s_add_u32 s45, s49, 10240
    buffer_load_dwordx4 v15, s[8:11], s45 offen lds
    s_add_u32 m0, s52, 8192
    s_add_u32 s45, s49, 10240
    buffer_load_dwordx4 v16, s[8:11], s45 offen lds
    s_add_u32 m0, s52, 9216
    s_add_u32 s45, s49, 10240
    buffer_load_dwordx4 v17, s[8:11], s45 offen lds
    s_add_u32 m0, s52, 10240
    s_add_u32 s45, s49, 20480
    buffer_load_dwordx4 v13, s[8:11], s45 offen lds
    s_add_u32 m0, s52, 11264
    s_add_u32 s45, s49, 20480
    buffer_load_dwordx4 v14, s[8:11], s45 offen lds
    s_add_u32 m0, s52, 12288
    s_add_u32 s45, s49, 20480
    buffer_load_dwordx4 v15, s[8:11], s45 offen lds
    s_add_u32 m0, s52, 13312
    s_add_u32 s45, s49, 20480
    buffer_load_dwordx4 v16, s[8:11], s45 offen lds
    s_add_u32 m0, s52, 14336
    s_add_u32 s45, s49, 20480
    buffer_load_dwordx4 v17, s[8:11], s45 offen lds
    s_add_u32 m0, s52, 15360
    s_add_u32 s45, s49, 30720
    buffer_load_dwordx4 v13, s[8:11], s45 offen lds
    s_add_u32 m0, s52, 16384
    s_add_u32 s45, s49, 30720
    buffer_load_dwordx4 v14, s[8:11], s45 offen lds
    s_add_u32 m0, s52, 17408
    s_add_u32 s45, s49, 30720
    buffer_load_dwordx4 v15, s[8:11], s45 offen lds
    s_add_u32 m0, s52, 18432
    s_add_u32 s45, s49, 30720
    buffer_load_dwordx4 v16, s[8:11], s45 offen lds
    s_add_u32 m0, s52, 19456
    s_add_u32 s45, s49, 30720
    buffer_load_dwordx4 v17, s[8:11], s45 offen lds
    v_mov_b32 v90, 0
    v_mov_b32 v91, 0
    v_cmp_ne_u32 vcc, 0, v88
    v_lshlrev_b32 v89, 3, v89
    s_lshl_b32 s86, s86, 4
    s_add_u32 s86, s86, 20643840
    v_mov_b32 v88, 0x7ff00000
    v_cndmask_b32 v86, v89, v88, vcc
    s_waitcnt vmcnt(22)
    v_dot2c_f32_bf16 v90, s58, v92
    v_dot2c_f32_bf16 v91, v92, v92
    v_dot2c_f32_bf16 v90, s58, v93
    v_dot2c_f32_bf16 v91, v93, v93
    v_dot2c_f32_bf16 v90, s58, v94
    v_dot2c_f32_bf16 v91, v94, v94
    v_dot2c_f32_bf16 v90, s58, v95
    v_dot2c_f32_bf16 v91, v95, v95
    s_waitcnt vmcnt(21)
    v_dot2c_f32_bf16 v90, s58, v96
    v_dot2c_f32_bf16 v91, v96, v96
    v_dot2c_f32_bf16 v90, s58, v97
    v_dot2c_f32_bf16 v91, v97, v97
    v_dot2c_f32_bf16 v90, s58, v98
    v_dot2c_f32_bf16 v91, v98, v98
    v_dot2c_f32_bf16 v90, s58, v99
    v_dot2c_f32_bf16 v91, v99, v99
    s_waitcnt vmcnt(20)
    v_dot2c_f32_bf16 v90, s58, v100
    v_dot2c_f32_bf16 v91, v100, v100
    v_dot2c_f32_bf16 v90, s58, v101
    v_dot2c_f32_bf16 v91, v101, v101
    v_dot2c_f32_bf16 v90, s58, v102
    v_dot2c_f32_bf16 v91, v102, v102
    v_dot2c_f32_bf16 v90, s58, v103
    v_dot2c_f32_bf16 v91, v103, v103
    s_nop 1
    v_add_f32_dpp v90, v90, v90 quad_perm:[1,0,3,2] row_mask:0xf bank_mask:0xf
    v_add_f32_dpp v91, v91, v91 quad_perm:[1,0,3,2] row_mask:0xf bank_mask:0xf
    s_nop 0
    v_add_f32_dpp v90, v90, v90 quad_perm:[2,3,0,1] row_mask:0xf bank_mask:0xf
    v_add_f32_dpp v91, v91, v91 quad_perm:[2,3,0,1] row_mask:0xf bank_mask:0xf
    s_nop 0
    v_add_f32_dpp v90, v90, v90 row_half_mirror row_mask:0xf bank_mask:0xf
    v_add_f32_dpp v91, v91, v91 row_half_mirror row_mask:0xf bank_mask:0xf
    s_nop 0
    v_add_f32_dpp v90, v90, v90 row_mirror row_mask:0xf bank_mask:0xf
    v_add_f32_dpp v91, v91, v91 row_mirror row_mask:0xf bank_mask:0xf
    v_mov_b32 v92, v90
    v_mov_b32 v93, v91
    s_nop 0
    v_permlane16_swap_b32 v90, v92
    v_permlane16_swap_b32 v91, v93
    v_add_f32 v90, v90, v92
    v_add_f32 v91, v91, v93
    v_mul_f32 v90, 0x3acccccd, v90
    v_mul_f32 v91, 0x3acccccd, v91
    v_fma_f32 v91, -v90, v90, v91
    v_max_f32 v91, 0, v91
    v_cvt_pk_bf16_f32 v84, v90, v91
    v_and_b32 v85, 0xffff0000, v84
    v_and_b32 v84, 0xffff, v84
    v_add_f32 v85, 0x3727c5ac, v85
    v_xor_b32 v84, 0x8000, v84
    v_cvt_pk_bf16_f32 v85, v85, v85
    v_lshlrev_b32 v85, 16, v85
    v_sqrt_f32 v85, v85
    s_nop 0
    v_cvt_pk_bf16_f32 v85, v85, v85
    v_lshlrev_b32 v85, 16, v85
    s_mul_i32 s76, s44, 1229
    s_add_u32 s76, s76, 410
    s_lshl_b32 s82, s44, 1
    s_lshr_b32 s77, 160, s82
    s_lshr_b32 s80, 2560, s82
    s_lshr_b32 s79, 163840, s44
    s_add_u32 s82, s82, s44
    s_lshr_b32 s78, 81920, s82
    s_mul_i32 s81, s44, 5201920
    s_add_u32 s81, s81, 40960
    s_mul_i32 s80, s80, s40
    s_add_u32 s81, s81, s80
    s_lshl_b32 s82, s39, 1
    s_mul_i32 s80, s43, 3
    s_add_u32 s82, s82, s80
    s_sub_u32 s82, s82, 4
    s_mul_i32 s80, s36, 15360
    s_add_u32 s80, s80, 65536
    v_add_u32 v105, 0, v0
    v_mul_u32_u24 v106, s76, v105
    v_lshrrev_b32 v106, 16, v106
    v_mul_u32_u24 v107, s77, v106
    v_sub_u32 v105, v105, v107
    v_mul_u32_u24 v106, s78, v106
    v_lshl_add_u32 v1, v105, 4, v106
    v_add_u32 v105, 64, v0
    v_mul_u32_u24 v106, s76, v105
    v_lshrrev_b32 v106, 16, v106
    v_mul_u32_u24 v107, s77, v106
    v_sub_u32 v105, v105, v107
    v_mul_u32_u24 v106, s78, v106
    v_lshl_add_u32 v2, v105, 4, v106
    v_subrev_u32 v2, 1024, v2
    v_add_u32 v105, 128, v0
    v_mul_u32_u24 v106, s76, v105
    v_lshrrev_b32 v106, 16, v106
    v_mul_u32_u24 v107, s77, v106
    v_sub_u32 v105, v105, v107
    v_mul_u32_u24 v106, s78, v106
    v_lshl_add_u32 v3, v105, 4, v106
    v_subrev_u32 v3, 2048, v3
    v_add_u32 v105, 192, v0
    v_mul_u32_u24 v106, s76, v105
    v_lshrrev_b32 v106, 16, v106
    v_mul_u32_u24 v107, s77, v106
    v_sub_u32 v105, v105, v107
    v_mul_u32_u24 v106, s78, v106
    v_lshl_add_u32 v4, v105, 4, v106
    v_subrev_u32 v4, 3072, v4
    v_add_u32 v105, 256, v0
    v_mul_u32_u24 v106, s76, v105
    v_lshrrev_b32 v106, 16, v106
    v_mul_u32_u24 v107, s77, v106
    v_sub_u32 v105, v105, v107
    v_mul_u32_u24 v106, s78, v106
    v_lshl_add_u32 v87, v105, 4, v106
    s_mul_i32 s65, s42, 74
    s_add_u32 s65, s65, s36
    s_mul_i32 s65, s65, 5120
    s_add_u32 s65, s65, 17563648
    v_and_b32 v250, 3, v0
    v_lshlrev_b32 v250, 2, v250
    buffer_load_dword v251, v250, s[24:27], 0 offen sc1
    s_add_u32 s45, s59, 0
    s_lshr_b32 s46, s45, 1
    s_and_b32 s47, s45, 1
    s_mul_i32 s47, s47, 1515520
    s_mul_i32 s46, s46, 5120
    s_add_u32 s50, s46, s47
    s_add_u32 s50, s50, 17563648
    s_cmp_lt_u32 s45, 148
    s_cselect_b32 s50, s50, 2146435072
    s_waitcnt vmcnt(1)
    ds_read_b64_tr_b16 v[104:105], v9 offset:0
    ds_read_b64_tr_b16 v[106:107], v9 offset:2560
    ds_read_b64_tr_b16 v[108:109], v9 offset:8
    ds_read_b64_tr_b16 v[110:111], v9 offset:2568
    ds_read_b64_tr_b16 v[112:113], v9 offset:16
    ds_read_b64_tr_b16 v[114:115], v9 offset:2576
    ds_read_b64_tr_b16 v[116:117], v9 offset:24
    ds_read_b64_tr_b16 v[118:119], v9 offset:2584
    ds_read_b64_tr_b16 v[120:121], v9 offset:32
    ds_read_b64_tr_b16 v[122:123], v9 offset:2592
    ds_read_b64_tr_b16 v[124:125], v9 offset:160
    ds_read_b64_tr_b16 v[126:127], v9 offset:2720
    ds_read_b64_tr_b16 v[128:129], v9 offset:168
    ds_read_b64_tr_b16 v[130:131], v9 offset:2728
    ds_read_b64_tr_b16 v[132:133], v9 offset:176
    s_waitcnt lgkmcnt(14)
    ds_read_b64_tr_b16 v[134:135], v9 offset:2736
    s_waitcnt lgkmcnt(14)
    ds_read_b64_tr_b16 v[136:137], v9 offset:184
    s_waitcnt lgkmcnt(14)
    ds_read_b64_tr_b16 v[138:139], v9 offset:2744
    s_waitcnt lgkmcnt(14)
    ds_read_b64_tr_b16 v[140:141], v9 offset:192
    s_waitcnt lgkmcnt(14)
    ds_read_b64_tr_b16 v[142:143], v9 offset:2752
    s_waitcnt lgkmcnt(14)
    ds_read_b64_tr_b16 v[144:145], v9 offset:320
    s_waitcnt lgkmcnt(14)
    ds_read_b64_tr_b16 v[146:147], v9 offset:2880
    s_waitcnt lgkmcnt(13)
    ds_read_b64_tr_b16 v[148:149], v9 offset:328
    ds_read_b64_tr_b16 v[150:151], v9 offset:2888
    s_waitcnt lgkmcnt(12)
    ds_read_b64_tr_b16 v[152:153], v9 offset:336
    ds_read_b64_tr_b16 v[154:155], v9 offset:2896
    ds_read_b64_tr_b16 v[156:157], v9 offset:344
    s_waitcnt lgkmcnt(12)
    ds_read_b64_tr_b16 v[158:159], v9 offset:2904
    ds_read_b64_tr_b16 v[160:161], v9 offset:352
    ds_read_b64_tr_b16 v[162:163], v9 offset:2912
    s_waitcnt lgkmcnt(13)
    ds_read_b64_tr_b16 v[164:165], v9 offset:480
    ds_read_b64_tr_b16 v[166:167], v9 offset:3040
    s_waitcnt lgkmcnt(13)
    ds_read_b64_tr_b16 v[168:169], v9 offset:488
    ds_read_b64_tr_b16 v[170:171], v9 offset:3048
    s_waitcnt lgkmcnt(14)
    ds_read_b64_tr_b16 v[172:173], v9 offset:496
    s_waitcnt lgkmcnt(14)
    ds_read_b64_tr_b16 v[174:175], v9 offset:3056
    s_waitcnt lgkmcnt(14)
    ds_read_b64_tr_b16 v[176:177], v9 offset:504
    s_waitcnt lgkmcnt(13)
    ds_read_b64_tr_b16 v[178:179], v9 offset:3064
    ds_read_b64_tr_b16 v[180:181], v9 offset:512
    s_waitcnt lgkmcnt(13)
    ds_read_b64_tr_b16 v[182:183], v9 offset:3072
    s_add_u32 s45, s50, 0
    buffer_store_dwordx4 v[104:107], v21, s[16:19], s45 offen sc1
    s_add_u32 s45, s50, 1024
    buffer_store_dwordx4 v[108:111], v21, s[16:19], s45 offen sc1
    s_add_u32 s45, s50, 2048
    buffer_store_dwordx4 v[112:115], v21, s[16:19], s45 offen sc1
    s_add_u32 s45, s50, 3072
    buffer_store_dwordx4 v[116:119], v21, s[16:19], s45 offen sc1
    s_add_u32 s45, s50, 4096
    buffer_store_dwordx4 v[120:123], v21, s[16:19], s45 offen sc1
    s_add_u32 s45, s50, 378880
    buffer_store_dwordx4 v[124:127], v21, s[16:19], s45 offen sc1
    s_add_u32 s45, s50, 379904
    buffer_store_dwordx4 v[128:131], v21, s[16:19], s45 offen sc1
    s_add_u32 s45, s50, 380928
    buffer_store_dwordx4 v[132:135], v21, s[16:19], s45 offen sc1
    s_add_u32 s45, s50, 381952
    buffer_store_dwordx4 v[136:139], v21, s[16:19], s45 offen sc1
    s_add_u32 s45, s50, 382976
    buffer_store_dwordx4 v[140:143], v21, s[16:19], s45 offen sc1
    s_add_u32 s45, s50, 757760
    buffer_store_dwordx4 v[144:147], v21, s[16:19], s45 offen sc1
    s_add_u32 s45, s50, 758784
    buffer_store_dwordx4 v[148:151], v21, s[16:19], s45 offen sc1
    s_add_u32 s45, s50, 759808
    buffer_store_dwordx4 v[152:155], v21, s[16:19], s45 offen sc1
    s_add_u32 s45, s50, 760832
    s_waitcnt lgkmcnt(0)
    buffer_store_dwordx4 v[156:159], v21, s[16:19], s45 offen sc1
    s_add_u32 s45, s50, 761856
    buffer_store_dwordx4 v[160:163], v21, s[16:19], s45 offen sc1
    s_add_u32 s45, s50, 1136640
    buffer_store_dwordx4 v[164:167], v21, s[16:19], s45 offen sc1
    s_add_u32 s45, s50, 1137664
    buffer_store_dwordx4 v[168:171], v21, s[16:19], s45 offen sc1
    s_add_u32 s45, s50, 1138688
    buffer_store_dwordx4 v[172:175], v21, s[16:19], s45 offen sc1
    s_add_u32 s45, s50, 1139712
    buffer_store_dwordx4 v[176:179], v21, s[16:19], s45 offen sc1
    s_add_u32 s45, s50, 1140736
    buffer_store_dwordx4 v[180:183], v21, s[16:19], s45 offen sc1
    s_waitcnt vmcnt(20)
    v_cmp_ne_u32 vcc, 0, v251
    s_nop 0
    s_cmp_eq_u64 vcc, -1
    s_cbranch_scc0 L_spin11
L_back11:
    buffer_store_dwordx2 v[84:85], v86, s[16:19], s86 offen sc1
    s_add_u32 s45, s59, 64
    s_lshr_b32 s46, s45, 1
    s_and_b32 s47, s45, 1
    s_mul_i32 s47, s47, 640
    s_sub_u32 s48, s46, 54
    s_cmp_lt_u32 s46, 54
    s_cselect_b32 s48, s46, s48
    s_cselect_b32 s8, s28, s32
    s_cselect_b32 s9, s29, s33
    s_cselect_b32 s10, s30, s34
    s_mul_i32 s48, s48, 40960
    s_add_u32 s49, s48, s47
    s_cmp_lt_u32 s45, 148
    s_cselect_b32 s49, s49, 2146435072
    s_add_u32 m0, s52, 20480
    s_add_u32 s45, s49, 0
    buffer_load_dwordx4 v13, s[8:11], s45 offen lds
    s_add_u32 m0, s52, 21504
    s_add_u32 s45, s49, 0
    buffer_load_dwordx4 v14, s[8:11], s45 offen lds
    s_add_u32 m0, s52, 22528
    s_add_u32 s45, s49, 0
    buffer_load_dwordx4 v15, s[8:11], s45 offen lds
    s_add_u32 m0, s52, 23552
    s_add_u32 s45, s49, 0
    buffer_load_dwordx4 v16, s[8:11], s45 offen lds
    s_add_u32 m0, s52, 24576
    s_add_u32 s45, s49, 0
    buffer_load_dwordx4 v17, s[8:11], s45 offen lds
    s_add_u32 m0, s52, 25600
    s_add_u32 s45, s49, 10240
    buffer_load_dwordx4 v13, s[8:11], s45 offen lds
    v_lshrrev_b32 v37, 3, v0
    v_and_b32 v38, 7, v0
    s_mul_i32 s47, s43, 6
    s_lshl_b32 s48, s39, 2
    s_add_u32 s47, s47, s48
    s_sub_u32 s47, s47, 8
    s_add_u32 s48, s48, s36
    v_add_u32 v39, s47, v37
    v_mov_b32 v250, s48
    v_cmp_gt_u32 vcc, 6, v37
    s_nop 1
    v_cndmask_b32 v39, v250, v39, vcc
    s_mul_i32 s47, s44, 5
    s_add_u32 s47, s47, 5
    v_mov_b32 v250, s47
    v_cndmask_b32_e64 v250, 0, v250, vcc
    v_add_u32 v250, v250, v38
    v_lshlrev_b32 v250, 4, v250
    v_lshl_add_u32 v250, v39, 8, v250
    v_add_u32 v250, 20594688, v250
    v_cmp_gt_i32 s[62:63], 0, v39
    s_mul_i32 s47, s40, 40
    s_add_u32 s48, s47, 39
    s_lshr_b32 s47, s47, 7
    s_lshr_b32 s48, s48, 7
    v_cmp_gt_u32 vcc, s47, v38
    s_nop 0
    s_or_b64 s[62:63], s[62:63], vcc
    v_cmp_lt_u32 vcc, s48, v38
    s_nop 0
    s_or_b64 s[62:63], s[62:63], vcc
    s_or_b32 s63, s63, 0xff000000
    v_cndmask_b32_e64 v250, v250, v252, s[62:63]
    s_lshl_b32 s47, s59, 4
    s_add_u32 s47, s47, 20660224
    s_waitcnt vmcnt(7)
    buffer_store_dword v253, v252, s[16:19], s47 offen sc1
    s_add_u32 m0, s52, 26624
    s_add_u32 s45, s49, 10240
    buffer_load_dwordx4 v14, s[8:11], s45 offen lds
    s_add_u32 m0, s52, 27648
    s_add_u32 s45, s49, 10240
    buffer_load_dwordx4 v15, s[8:11], s45 offen lds
    s_add_u32 m0, s52, 28672
    s_add_u32 s45, s49, 10240
    buffer_load_dwordx4 v16, s[8:11], s45 offen lds
    s_add_u32 m0, s52, 29696
    s_add_u32 s45, s49, 10240
    buffer_load_dwordx4 v17, s[8:11], s45 offen lds
    s_add_u32 m0, s52, 30720
    s_add_u32 s45, s49, 20480
    buffer_load_dwordx4 v13, s[8:11], s45 offen lds
    s_add_u32 m0, s52, 31744
    s_add_u32 s45, s49, 20480
    buffer_load_dwordx4 v14, s[8:11], s45 offen lds
    s_add_u32 m0, s52, 32768
    s_add_u32 s45, s49, 20480
    buffer_load_dwordx4 v15, s[8:11], s45 offen lds
    s_add_u32 m0, s52, 33792
    s_add_u32 s45, s49, 20480
    buffer_load_dwordx4 v16, s[8:11], s45 offen lds
    s_add_u32 m0, s52, 34816
    s_add_u32 s45, s49, 20480
    buffer_load_dwordx4 v17, s[8:11], s45 offen lds
    s_add_u32 m0, s52, 35840
    s_add_u32 s45, s49, 30720
    buffer_load_dwordx4 v13, s[8:11], s45 offen lds
    s_add_u32 m0, s52, 36864
    s_add_u32 s45, s49, 30720
    buffer_load_dwordx4 v14, s[8:11], s45 offen lds
    s_add_u32 m0, s52, 37888
    s_add_u32 s45, s49, 30720
    buffer_load_dwordx4 v15, s[8:11], s45 offen lds
    s_add_u32 m0, s52, 38912
    s_add_u32 s45, s49, 30720
    buffer_load_dwordx4 v16, s[8:11], s45 offen lds
    s_add_u32 m0, s52, 39936
    s_add_u32 s45, s49, 30720
    buffer_load_dwordx4 v17, s[8:11], s45 offen lds
    s_add_u32 s45, s59, 128
    s_lshr_b32 s46, s45, 1
    s_and_b32 s47, s45, 1
    s_mul_i32 s47, s47, 640
    s_sub_u32 s48, s46, 54
    s_cmp_lt_u32 s46, 54
    s_cselect_b32 s48, s46, s48
    s_cselect_b32 s8, s28, s32
    s_cselect_b32 s9, s29, s33
    s_cselect_b32 s10, s30, s34
    s_mul_i32 s48, s48, 40960
    s_add_u32 s49, s48, s47
    s_cmp_lt_u32 s45, 148
    s_cselect_b32 s49, s49, 2146435072
    s_add_u32 m0, s52, 0
    s_add_u32 s45, s49, 0
    buffer_load_dwordx4 v13, s[8:11], s45 offen lds
    s_add_u32 m0, s52, 1024
    s_add_u32 s45, s49, 0
    buffer_load_dwordx4 v14, s[8:11], s45 offen lds
    s_add_u32 m0, s52, 2048
    s_add_u32 s45, s49, 0
    buffer_load_dwordx4 v15, s[8:11], s45 offen lds
    s_add_u32 m0, s52, 3072
    s_add_u32 s45, s49, 0
    buffer_load_dwordx4 v16, s[8:11], s45 offen lds
    s_add_u32 m0, s52, 4096
    s_add_u32 s45, s49, 0
    buffer_load_dwordx4 v17, s[8:11], s45 offen lds
    s_add_u32 m0, s52, 5120
    s_add_u32 s45, s49, 10240
    buffer_load_dwordx4 v13, s[8:11], s45 offen lds
    s_add_u32 m0, s52, 6144
    s_add_u32 s45, s49, 10240
    buffer_load_dwordx4 v14, s[8:11], s45 offen lds
    s_add_u32 m0, s52, 7168
    s_add_u32 s45, s49, 10240
    buffer_load_dwordx4 v15, s[8:11], s45 offen lds
    s_add_u32 m0, s52, 8192
    s_add_u32 s45, s49, 10240
    buffer_load_dwordx4 v16, s[8:11], s45 offen lds
    s_add_u32 m0, s52, 9216
    s_add_u32 s45, s49, 10240
    buffer_load_dwordx4 v17, s[8:11], s45 offen lds
    s_add_u32 m0, s52, 10240
    s_add_u32 s45, s49, 20480
    buffer_load_dwordx4 v13, s[8:11], s45 offen lds
    s_add_u32 m0, s52, 11264
    s_add_u32 s45, s49, 20480
    buffer_load_dwordx4 v14, s[8:11], s45 offen lds
    s_add_u32 m0, s52, 12288
    s_add_u32 s45, s49, 20480
    buffer_load_dwordx4 v15, s[8:11], s45 offen lds
    s_add_u32 m0, s52, 13312
    s_add_u32 s45, s49, 20480
    buffer_load_dwordx4 v16, s[8:11], s45 offen lds
    s_add_u32 m0, s52, 14336
    s_add_u32 s45, s49, 20480
    buffer_load_dwordx4 v17, s[8:11], s45 offen lds
    s_add_u32 m0, s52, 15360
    s_add_u32 s45, s49, 30720
    buffer_load_dwordx4 v13, s[8:11], s45 offen lds
    s_add_u32 m0, s52, 16384
    s_add_u32 s45, s49, 30720
    buffer_load_dwordx4 v14, s[8:11], s45 offen lds
    s_add_u32 m0, s52, 17408
    s_add_u32 s45, s49, 30720
    buffer_load_dwordx4 v15, s[8:11], s45 offen lds
    s_add_u32 m0, s52, 18432
    s_add_u32 s45, s49, 30720
    buffer_load_dwordx4 v16, s[8:11], s45 offen lds
    s_add_u32 m0, s52, 19456
    s_add_u32 s45, s49, 30720
    buffer_load_dwordx4 v17, s[8:11], s45 offen lds
    s_add_u32 s45, s59, 64
    s_lshr_b32 s46, s45, 1
    s_and_b32 s47, s45, 1
    s_mul_i32 s47, s47, 1515520
    s_mul_i32 s46, s46, 5120
    s_add_u32 s50, s46, s47
    s_add_u32 s50, s50, 17563648
    s_cmp_lt_u32 s45, 148
    s_cselect_b32 s50, s50, 2146435072
    s_waitcnt vmcnt(20)
    ds_read_b64_tr_b16 v[104:105], v9 offset:20480
    ds_read_b64_tr_b16 v[106:107], v9 offset:23040
    ds_read_b64_tr_b16 v[108:109], v9 offset:20488
    ds_read_b64_tr_b16 v[110:111], v9 offset:23048
    ds_read_b64_tr_b16 v[112:113], v9 offset:20496
    ds_read_b64_tr_b16 v[114:115], v9 offset:23056
    ds_read_b64_tr_b16 v[116:117], v9 offset:20504
    ds_read_b64_tr_b16 v[118:119], v9 offset:23064
    ds_read_b64_tr_b16 v[120:121], v9 offset:20512
    ds_read_b64_tr_b16 v[122:123], v9 offset:23072
    ds_read_b64_tr_b16 v[124:125], v9 offset:20640
    ds_read_b64_tr_b16 v[126:127], v9 offset:23200
    ds_read_b64_tr_b16 v[128:129], v9 offset:20648
    ds_read_b64_tr_b16 v[130:131], v9 offset:23208
    ds_read_b64_tr_b16 v[132:133], v9 offset:20656
    s_waitcnt lgkmcnt(14)
    ds_read_b64_tr_b16 v[134:135], v9 offset:23216
    s_waitcnt lgkmcnt(14)
    ds_read_b64_tr_b16 v[136:137], v9 offset:20664
    s_waitcnt lgkmcnt(14)
    ds_read_b64_tr_b16 v[138:139], v9 offset:23224
    s_waitcnt lgkmcnt(14)
    ds_read_b64_tr_b16 v[140:141], v9 offset:20672
    s_waitcnt lgkmcnt(14)
    ds_read_b64_tr_b16 v[142:143], v9 offset:23232
    s_waitcnt lgkmcnt(14)
    ds_read_b64_tr_b16 v[144:145], v9 offset:20800
    s_waitcnt lgkmcnt(14)
    ds_read_b64_tr_b16 v[146:147], v9 offset:23360
    s_waitcnt lgkmcnt(13)
    ds_read_b64_tr_b16 v[148:149], v9 offset:20808
    ds_read_b64_tr_b16 v[150:151], v9 offset:23368
    s_waitcnt lgkmcnt(12)
    ds_read_b64_tr_b16 v[152:153], v9 offset:20816
    ds_read_b64_tr_b16 v[154:155], v9 offset:23376
    ds_read_b64_tr_b16 v[156:157], v9 offset:20824
    s_waitcnt lgkmcnt(12)
    ds_read_b64_tr_b16 v[158:159], v9 offset:23384
    ds_read_b64_tr_b16 v[160:161], v9 offset:20832
    ds_read_b64_tr_b16 v[162:163], v9 offset:23392
    s_waitcnt lgkmcnt(13)
    ds_read_b64_tr_b16 v[164:165], v9 offset:20960
    ds_read_b64_tr_b16 v[166:167], v9 offset:23520
    s_waitcnt lgkmcnt(13)
    ds_read_b64_tr_b16 v[168:169], v9 offset:20968
    ds_read_b64_tr_b16 v[170:171], v9 offset:23528
    s_waitcnt lgkmcnt(14)
    ds_read_b64_tr_b16 v[172:173], v9 offset:20976
    s_waitcnt lgkmcnt(14)
    ds_read_b64_tr_b16 v[174:175], v9 offset:23536
    s_waitcnt lgkmcnt(14)
    ds_read_b64_tr_b16 v[176:177], v9 offset:20984
    s_waitcnt lgkmcnt(13)
    ds_read_b64_tr_b16 v[178:179], v9 offset:23544
    ds_read_b64_tr_b16 v[180:181], v9 offset:20992
    s_waitcnt lgkmcnt(13)
    ds_read_b64_tr_b16 v[182:183], v9 offset:23552
    s_add_u32 s45, s50, 0
    buffer_store_dwordx4 v[104:107], v21, s[16:19], s45 offen sc1
    s_add_u32 s45, s50, 1024
    buffer_store_dwordx4 v[108:111], v21, s[16:19], s45 offen sc1
    s_add_u32 s45, s50, 2048
    buffer_store_dwordx4 v[112:115], v21, s[16:19], s45 offen sc1
    s_add_u32 s45, s50, 3072
    buffer_store_dwordx4 v[116:119], v21, s[16:19], s45 offen sc1
    s_add_u32 s45, s50, 4096
    buffer_store_dwordx4 v[120:123], v21, s[16:19], s45 offen sc1
    s_add_u32 s45, s50, 378880
    buffer_store_dwordx4 v[124:127], v21, s[16:19], s45 offen sc1
    s_add_u32 s45, s50, 379904
    buffer_store_dwordx4 v[128:131], v21, s[16:19], s45 offen sc1
    s_add_u32 s45, s50, 380928
    buffer_store_dwordx4 v[132:135], v21, s[16:19], s45 offen sc1
    s_add_u32 s45, s50, 381952
    buffer_store_dwordx4 v[136:139], v21, s[16:19], s45 offen sc1
    s_add_u32 s45, s50, 382976
    buffer_store_dwordx4 v[140:143], v21, s[16:19], s45 offen sc1
    s_add_u32 s45, s50, 757760
    buffer_store_dwordx4 v[144:147], v21, s[16:19], s45 offen sc1
    s_add_u32 s45, s50, 758784
    buffer_store_dwordx4 v[148:151], v21, s[16:19], s45 offen sc1
    s_add_u32 s45, s50, 759808
    buffer_store_dwordx4 v[152:155], v21, s[16:19], s45 offen sc1
    s_add_u32 s45, s50, 760832
    s_waitcnt lgkmcnt(0)
    buffer_store_dwordx4 v[156:159], v21, s[16:19], s45 offen sc1
    s_add_u32 s45, s50, 761856
    buffer_store_dwordx4 v[160:163], v21, s[16:19], s45 offen sc1
    s_add_u32 s45, s50, 1136640
    buffer_store_dwordx4 v[164:167], v21, s[16:19], s45 offen sc1
    s_add_u32 s45, s50, 1137664
    buffer_store_dwordx4 v[168:171], v21, s[16:19], s45 offen sc1
    s_add_u32 s45, s50, 1138688
    buffer_store_dwordx4 v[172:175], v21, s[16:19], s45 offen sc1
    s_add_u32 s45, s50, 1139712
    buffer_store_dwordx4 v[176:179], v21, s[16:19], s45 offen sc1
    s_add_u32 s45, s50, 1140736
    buffer_store_dwordx4 v[180:183], v21, s[16:19], s45 offen sc1
    s_add_u32 s45, s59, 128
    s_lshr_b32 s46, s45, 1
    s_and_b32 s47, s45, 1
    s_mul_i32 s47, s47, 1515520
    s_mul_i32 s46, s46, 5120
    s_add_u32 s50, s46, s47
    s_add_u32 s50, s50, 17563648
    s_cmp_lt_u32 s45, 148
    s_cselect_b32 s50, s50, 2146435072
    s_waitcnt vmcnt(20)
    ds_read_b64_tr_b16 v[104:105], v9 offset:0
    ds_read_b64_tr_b16 v[106:107], v9 offset:2560
    ds_read_b64_tr_b16 v[108:109], v9 offset:8
    ds_read_b64_tr_b16 v[110:111], v9 offset:2568
    ds_read_b64_tr_b16 v[112:113], v9 offset:16
    ds_read_b64_tr_b16 v[114:115], v9 offset:2576
    ds_read_b64_tr_b16 v[116:117], v9 offset:24
    ds_read_b64_tr_b16 v[118:119], v9 offset:2584
    ds_read_b64_tr_b16 v[120:121], v9 offset:32
    ds_read_b64_tr_b16 v[122:123], v9 offset:2592
    ds_read_b64_tr_b16 v[124:125], v9 offset:160
    ds_read_b64_tr_b16 v[126:127], v9 offset:2720
    ds_read_b64_tr_b16 v[128:129], v9 offset:168
    ds_read_b64_tr_b16 v[130:131], v9 offset:2728
    ds_read_b64_tr_b16 v[132:133], v9 offset:176
    s_waitcnt lgkmcnt(14)
    ds_read_b64_tr_b16 v[134:135], v9 offset:2736
    s_waitcnt lgkmcnt(14)
    ds_read_b64_tr_b16 v[136:137], v9 offset:184
    s_waitcnt lgkmcnt(14)
    ds_read_b64_tr_b16 v[138:139], v9 offset:2744
    s_waitcnt lgkmcnt(14)
    ds_read_b64_tr_b16 v[140:141], v9 offset:192
    s_waitcnt lgkmcnt(14)
    ds_read_b64_tr_b16 v[142:143], v9 offset:2752
    s_waitcnt lgkmcnt(14)
    ds_read_b64_tr_b16 v[144:145], v9 offset:320
    s_waitcnt lgkmcnt(14)
    ds_read_b64_tr_b16 v[146:147], v9 offset:2880
    s_waitcnt lgkmcnt(13)
    ds_read_b64_tr_b16 v[148:149], v9 offset:328
    ds_read_b64_tr_b16 v[150:151], v9 offset:2888
    s_waitcnt lgkmcnt(12)
    ds_read_b64_tr_b16 v[152:153], v9 offset:336
    ds_read_b64_tr_b16 v[154:155], v9 offset:2896
    ds_read_b64_tr_b16 v[156:157], v9 offset:344
    s_waitcnt lgkmcnt(12)
    ds_read_b64_tr_b16 v[158:159], v9 offset:2904
    ds_read_b64_tr_b16 v[160:161], v9 offset:352
    ds_read_b64_tr_b16 v[162:163], v9 offset:2912
    s_waitcnt lgkmcnt(13)
    ds_read_b64_tr_b16 v[164:165], v9 offset:480
    ds_read_b64_tr_b16 v[166:167], v9 offset:3040
    s_waitcnt lgkmcnt(13)
    ds_read_b64_tr_b16 v[168:169], v9 offset:488
    ds_read_b64_tr_b16 v[170:171], v9 offset:3048
    s_waitcnt lgkmcnt(14)
    ds_read_b64_tr_b16 v[172:173], v9 offset:496
    s_waitcnt lgkmcnt(14)
    ds_read_b64_tr_b16 v[174:175], v9 offset:3056
    s_waitcnt lgkmcnt(14)
    ds_read_b64_tr_b16 v[176:177], v9 offset:504
    s_waitcnt lgkmcnt(13)
    ds_read_b64_tr_b16 v[178:179], v9 offset:3064
    ds_read_b64_tr_b16 v[180:181], v9 offset:512
    s_waitcnt lgkmcnt(13)
    ds_read_b64_tr_b16 v[182:183], v9 offset:3072
    s_add_u32 s45, s50, 0
    buffer_store_dwordx4 v[104:107], v21, s[16:19], s45 offen sc1
    s_add_u32 s45, s50, 1024
    buffer_store_dwordx4 v[108:111], v21, s[16:19], s45 offen sc1
    s_add_u32 s45, s50, 2048
    buffer_store_dwordx4 v[112:115], v21, s[16:19], s45 offen sc1
    s_add_u32 s45, s50, 3072
    buffer_store_dwordx4 v[116:119], v21, s[16:19], s45 offen sc1
    s_add_u32 s45, s50, 4096
    buffer_store_dwordx4 v[120:123], v21, s[16:19], s45 offen sc1
    s_add_u32 s45, s50, 378880
    buffer_store_dwordx4 v[124:127], v21, s[16:19], s45 offen sc1
    s_add_u32 s45, s50, 379904
    buffer_store_dwordx4 v[128:131], v21, s[16:19], s45 offen sc1
    s_add_u32 s45, s50, 380928
    buffer_store_dwordx4 v[132:135], v21, s[16:19], s45 offen sc1
    s_add_u32 s45, s50, 381952
    buffer_store_dwordx4 v[136:139], v21, s[16:19], s45 offen sc1
    s_add_u32 s45, s50, 382976
    buffer_store_dwordx4 v[140:143], v21, s[16:19], s45 offen sc1
    s_add_u32 s45, s50, 757760
    buffer_store_dwordx4 v[144:147], v21, s[16:19], s45 offen sc1
    s_add_u32 s45, s50, 758784
    buffer_store_dwordx4 v[148:151], v21, s[16:19], s45 offen sc1
    s_add_u32 s45, s50, 759808
    buffer_store_dwordx4 v[152:155], v21, s[16:19], s45 offen sc1
    s_add_u32 s45, s50, 760832
    s_waitcnt lgkmcnt(0)
    buffer_store_dwordx4 v[156:159], v21, s[16:19], s45 offen sc1
    s_add_u32 s45, s50, 761856
    buffer_store_dwordx4 v[160:163], v21, s[16:19], s45 offen sc1
    s_add_u32 s45, s50, 1136640
    buffer_store_dwordx4 v[164:167], v21, s[16:19], s45 offen sc1
    s_add_u32 s45, s50, 1137664
    buffer_store_dwordx4 v[168:171], v21, s[16:19], s45 offen sc1
    s_add_u32 s45, s50, 1138688
    buffer_store_dwordx4 v[172:175], v21, s[16:19], s45 offen sc1
    s_add_u32 s45, s50, 1139712
    buffer_store_dwordx4 v[176:179], v21, s[16:19], s45 offen sc1
    s_add_u32 s45, s50, 1140736
    buffer_store_dwordx4 v[180:183], v21, s[16:19], s45 offen sc1
    s_barrier
    v_lshrrev_b32 v37, 1, v0
    v_min_u32 v37, 11, v37
    v_mul_u32_u24 v37, 2560, v37
    v_and_b32 v38, 1, v0
    v_mul_u32_u24 v38, 1280, v38
    s_mov_b32 s47, 126992
    v_add3_u32 v37, v37, v38, s47
    v_mov_b32 v100, s58
    v_mov_b32 v101, s58
    v_mov_b32 v102, s58
    v_mov_b32 v103, s58
    ds_write_b128 v37, v[100:103]
    s_lshl_b32 s47, s39, 2
    v_min_u32 v38, 11, v0
    v_add_u32 v39, s47, v38
    v_cmp_gt_u32 s[90:91], 8, v39
    v_mul_u32_u24 v38, 2560, v38
    v_add_u32 v38, 126976, v38
    v_mov_b32 v39, 0xf149
    v_cndmask_b32_e64 v96, 0, v39, s[90:91]
    v_mov_b32 v97, 0
    v_mov_b32 v98, 0
    v_mov_b32 v99, 0
    ds_write_b128 v38, v[96:99]
    s_lshl_b32 s47, s59, 4
    s_add_u32 s47, s47, 20661248
    s_waitcnt vmcnt(0)
    buffer_store_dword v253, v252, s[16:19], s47 offen sc1
    buffer_load_dword v251, v250, s[16:19], 0 offen sc1
    v_add_u32 v248, 20660224, v21
    buffer_load_dword v249, v248, s[16:19], 0 offen sc1
    s_waitcnt vmcnt(1)
    v_cmp_ne_u32 vcc, 0, v251
    s_nop 0
    s_or_b64 vcc, vcc, s[62:63]
    s_cmp_eq_u64 vcc, -1
    s_cbranch_scc0 L_spin12
L_back12:
    s_waitcnt vmcnt(0)
    v_cmp_ne_u32 vcc, 0, v249
    s_nop 0
    s_cmp_eq_u64 vcc, -1
    s_cbranch_scc0 L_spin13
L_back13:
    s_lshl_b32 s83, s39, 2
    s_add_u32 s83, s83, s36
    s_mul_i32 s83, s83, 81920
    s_mul_i32 s84, s40, 2560
    s_add_u32 s83, s83, s84
    v_and_b32 v37, 0x1ff, v21
    buffer_load_dwordx4 v[240:243], v21, s[16:19], s83 offen sc1
    buffer_load_dwordx4 v[248:251], v37, s[16:19], s83 offen offset:1024 sc1
    buffer_load_dwordx4 v[244:247], v21, s[16:19], s83 offen offset:1536 sc1
    s_add_u32 s84, s82, 0
    s_mul_i32 s83, s84, s79
    s_add_u32 s83, s83, s81
    s_cmp_lt_i32 s84, 0
    s_cselect_b32 s83, 2146435072, s83
    s_add_u32 m0, s80, 0
    s_nop 0
    buffer_load_dwordx4 v1, s[16:19], s83 offen offset:0 sc1 lds
    buffer_load_dwordx4 v2, s[16:19], s83 offen offset:1024 sc1 lds
    buffer_load_dwordx4 v3, s[16:19], s83 offen offset:2048 sc1 lds
    buffer_load_dwordx4 v4, s[16:19], s83 offen offset:3072 sc1 lds
    s_add_u32 m0, s80, 4096
    s_nop 0
    buffer_load_dwordx4 v87, s[16:19], s83 offen offset:0 sc1 lds
    s_add_u32 s84, s82, 1
    s_mul_i32 s83, s84, s79
    s_add_u32 s83, s83, s81
    s_cmp_lt_i32 s84, 0
    s_cselect_b32 s83, 2146435072, s83
    s_add_u32 m0, s80, 5120
    s_nop 0
    buffer_load_dwordx4 v1, s[16:19], s83 offen offset:0 sc1 lds
    buffer_load_dwordx4 v2, s[16:19], s83 offen offset:1024 sc1 lds
    buffer_load_dwordx4 v3, s[16:19], s83 offen offset:2048 sc1 lds
    buffer_load_dwordx4 v4, s[16:19], s83 offen offset:3072 sc1 lds
    s_add_u32 m0, s80, 9216
    s_nop 0
    buffer_load_dwordx4 v87, s[16:19], s83 offen offset:0 sc1 lds
    s_add_u32 s84, s82, 2
    s_mul_i32 s83, s84, s79
    s_add_u32 s83, s83, s81
    s_cmp_lt_i32 s84, 0
    s_cselect_b32 s83, 2146435072, s83
    s_add_u32 m0, s80, 10240
    s_nop 0
    buffer_load_dwordx4 v1, s[16:19], s83 offen offset:0 sc1 lds
    buffer_load_dwordx4 v2, s[16:19], s83 offen offset:1024 sc1 lds
    buffer_load_dwordx4 v3, s[16:19], s83 offen offset:2048 sc1 lds
    buffer_load_dwordx4 v4, s[16:19], s83 offen offset:3072 sc1 lds
    s_add_u32 m0, s80, 14336
    s_nop 0
    buffer_load_dwordx4 v87, s[16:19], s83 offen offset:0 sc1 lds
    s_add_u32 s67, s65, 0
    buffer_load_dwordx4 a[0:3], v21, s[16:19], s67 offen offset:0 sc1
    buffer_load_dwordx4 a[4:7], v21, s[16:19], s67 offen offset:1024 sc1
    buffer_load_dwordx4 a[8:11], v21, s[16:19], s67 offen offset:2048 sc1
    buffer_load_dwordx4 a[12:15], v21, s[16:19], s67 offen offset:3072 sc1
    s_add_u32 s67, s67, 4096
    buffer_load_dwordx4 a[16:19], v21, s[16:19], s67 offen offset:0 sc1
    s_add_u32 s67, s65, 20480
    buffer_load_dwordx4 a[20:23], v21, s[16:19], s67 offen offset:0 sc1
    buffer_load_dwordx4 a[24:27], v21, s[16:19], s67 offen offset:1024 sc1
    buffer_load_dwordx4 a[28:31], v21, s[16:19], s67 offen offset:2048 sc1
    buffer_load_dwordx4 a[32:35], v21, s[16:19], s67 offen offset:3072 sc1
    s_add_u32 s67, s67, 4096
    buffer_load_dwordx4 a[36:39], v21, s[16:19], s67 offen offset:0 sc1
    s_add_u32 s67, s65, 40960
    buffer_load_dwordx4 a[40:43], v21, s[16:19], s67 offen offset:0 sc1
    buffer_load_dwordx4 a[44:47], v21, s[16:19], s67 offen offset:1024 sc1
    buffer_load_dwordx4 a[48:51], v21, s[16:19], s67 offen offset:2048 sc1
    buffer_load_dwordx4 a[52:55], v21, s[16:19], s67 offen offset:3072 sc1
    s_add_u32 s67, s67, 4096
    buffer_load_dwordx4 a[56:59], v21, s[16:19], s67 offen offset:0 sc1
    s_add_u32 s67, s65, 61440
    buffer_load_dwordx4 a[60:63], v21, s[16:19], s67 offen offset:0 sc1
    buffer_load_dwordx4 a[64:67], v21, s[16:19], s67 offen offset:1024 sc1
    buffer_load_dwordx4 a[68:71], v21, s[16:19], s67 offen offset:2048 sc1
    buffer_load_dwordx4 a[72:75], v21, s[16:19], s67 offen offset:3072 sc1
    s_add_u32 s67, s67, 4096
    buffer_load_dwordx4 a[76:79], v21, s[16:19], s67 offen offset:0 sc1
    s_add_u32 s67, s65, 81920
    buffer_load_dwordx4 a[80:83], v21, s[16:19], s67 offen offset:0 sc1
    buffer_load_dwordx4 a[84:87], v21, s[16:19], s67 offen offset:1024 sc1
    buffer_load_dwordx4 a[88:91], v21, s[16:19], s67 offen offset:2048 sc1
    buffer_load_dwordx4 a[92:95], v21, s[16:19], s67 offen offset:3072 sc1
    s_add_u32 s67, s67, 4096
    buffer_load_dwordx4 a[96:99], v21, s[16:19], s67 offen offset:0 sc1
    s_waitcnt vmcnt(25)
    s_waitcnt lgkmcnt(0)
    s_branch L_att
L_spin2:
    s_mov_b32 s64, 0x20000
L_spinl2:
    s_sleep 8
    buffer_load_dword v251, v250, s[24:27], 0 offen sc1
    s_sub_u32 s64, s64, 1
    s_cmp_eq_u32 s64, 0
    s_cbranch_scc1 L_back2
    s_waitcnt vmcnt(0)
    v_cmp_ne_u32 vcc, 0, v251
    s_nop 1
    s_cmp_eq_u64 vcc, -1
    s_cbranch_scc0 L_spinl2
    s_branch L_back2
L_spin3:
    s_mov_b32 s64, 0x20000
L_spinl3:
    s_sleep 8
    buffer_load_dwordx2 v[72:73], v30, s[16:19], 0 offen sc1
    s_sub_u32 s64, s64, 1
    s_cmp_eq_u32 s64, 0
    s_cbranch_scc1 L_back3
    s_waitcnt vmcnt(0)
    v_cmp_ne_u32 vcc, 0, v73
    s_nop 1
    s_cmp_eq_u64 vcc, -1
    s_cbranch_scc0 L_spinl3
    s_branch L_back3
L_spin4:
    s_mov_b32 s64, 0x20000
L_spinl4:
    s_sleep 8
    buffer_load_dword v251, v250, s[16:19], 0 offen sc1
    s_sub_u32 s64, s64, 1
    s_cmp_eq_u32 s64, 0
    s_cbranch_scc1 L_back4
    s_waitcnt vmcnt(0)
    v_cmp_ne_u32 vcc, 0, v251
    s_nop 1
    s_or_b64 vcc, vcc, s[62:63]
    s_cmp_eq_u64 vcc, -1
    s_cbranch_scc0 L_spinl4
    s_branch L_back4
L_spin5:
    s_mov_b32 s64, 0x20000
L_spinl5:
    s_sleep 8
    buffer_load_dword v249, v248, s[16:19], 0 offen sc1
    s_sub_u32 s64, s64, 1
    s_cmp_eq_u32 s64, 0
    s_cbranch_scc1 L_back5
    s_waitcnt vmcnt(0)
    v_cmp_ne_u32 vcc, 0, v249
    s_nop 1
    s_cmp_eq_u64 vcc, -1
    s_cbranch_scc0 L_spinl5
    s_branch L_back5
L_spin6:
    s_mov_b32 s64, 0x20000
L_spinl6:
    s_sleep 8
    buffer_load_dword v251, v250, s[24:27], 0 offen sc1
    s_sub_u32 s64, s64, 1
    s_cmp_eq_u32 s64, 0
    s_cbranch_scc1 L_back6
    s_waitcnt vmcnt(0)
    v_cmp_ne_u32 vcc, 0, v251
    s_nop 1
    s_cmp_eq_u64 vcc, -1
    s_cbranch_scc0 L_spinl6
    s_branch L_back6
L_spin7:
    s_mov_b32 s64, 0x20000
L_spinl7:
    s_sleep 8
    buffer_load_dwordx2 v[72:73], v30, s[16:19], 0 offen sc1
    s_sub_u32 s64, s64, 1
    s_cmp_eq_u32 s64, 0
    s_cbranch_scc1 L_back7
    s_waitcnt vmcnt(0)
    v_cmp_ne_u32 vcc, 0, v73
    s_nop 1
    s_cmp_eq_u64 vcc, -1
    s_cbranch_scc0 L_spinl7
    s_branch L_back7
L_spin8:
    s_mov_b32 s64, 0x20000
L_spinl8:
    s_sleep 8
    buffer_load_dword v251, v250, s[16:19], 0 offen sc1
    s_sub_u32 s64, s64, 1
    s_cmp_eq_u32 s64, 0
    s_cbranch_scc1 L_back8
    s_waitcnt vmcnt(0)
    v_cmp_ne_u32 vcc, 0, v251
    s_nop 1
    s_or_b64 vcc, vcc, s[62:63]
    s_cmp_eq_u64 vcc, -1
    s_cbranch_scc0 L_spinl8
    s_branch L_back8
L_spin9:
    s_mov_b32 s64, 0x20000
L_spinl9:
    s_sleep 8
    buffer_load_dword v249, v248, s[16:19], 0 offen sc1
    s_sub_u32 s64, s64, 1
    s_cmp_eq_u32 s64, 0
    s_cbranch_scc1 L_back9
    s_waitcnt vmcnt(0)
    v_cmp_ne_u32 vcc, 0, v249
    s_nop 1
    s_cmp_eq_u64 vcc, -1
    s_cbranch_scc0 L_spinl9
    s_branch L_back9
L_spin11:
    s_mov_b32 s64, 0x20000
L_spinl11:
    s_sleep 8
    buffer_load_dword v251, v250, s[24:27], 0 offen sc1
    s_sub_u32 s64, s64, 1
    s_cmp_eq_u32 s64, 0
    s_cbranch_scc1 L_back11
    s_waitcnt vmcnt(0)
    v_cmp_ne_u32 vcc, 0, v251
    s_nop 1
    s_cmp_eq_u64 vcc, -1
    s_cbranch_scc0 L_spinl11
    s_branch L_back11
L_spin12:
    s_mov_b32 s64, 0x20000
L_spinl12:
    s_sleep 16
    buffer_load_dword v251, v250, s[16:19], 0 offen sc1
    s_sub_u32 s64, s64, 1
    s_cmp_eq_u32 s64, 0
    s_cbranch_scc1 L_back12
    s_waitcnt vmcnt(0)
    v_cmp_ne_u32 vcc, 0, v251
    s_nop 1
    s_or_b64 vcc, vcc, s[62:63]
    s_cmp_eq_u64 vcc, -1
    s_cbranch_scc0 L_spinl12
    s_branch L_back12
L_spin13:
    s_mov_b32 s64, 0x20000
L_spinl13:
    s_sleep 16
    buffer_load_dword v249, v248, s[16:19], 0 offen sc1
    s_sub_u32 s64, s64, 1
    s_cmp_eq_u32 s64, 0
    s_cbranch_scc1 L_back13
    s_waitcnt vmcnt(0)
    v_cmp_ne_u32 vcc, 0, v249
    s_nop 1
    s_cmp_eq_u64 vcc, -1
    s_cbranch_scc0 L_spinl13
    s_branch L_back13
L_spin14:
    s_mov_b32 s64, 0x20000
L_spinl14:
    s_sleep 8
    buffer_load_dword v7, v6, s[16:19], 0 offen sc1
    s_sub_u32 s64, s64, 1
    s_cmp_eq_u32 s64, 0
    s_cbranch_scc1 L_back14
    s_waitcnt vmcnt(0)
    v_cmp_ne_u32 vcc, 0, v7
    s_nop 1
    s_cmp_eq_u64 vcc, -1
    s_cbranch_scc0 L_spinl14
    s_branch L_back14
L_spin15:
    s_mov_b32 s64, 0x20000
L_spinl15:
    s_sleep 8
    buffer_load_dword v7, v8, s[16:19], 0 offen sc1
    s_sub_u32 s64, s64, 1
    s_cmp_eq_u32 s64, 0
    s_cbranch_scc1 L_back15
    s_waitcnt vmcnt(0)
    v_cmp_ne_u32 vcc, 0, v7
    s_nop 1
    s_or_b64 vcc, vcc, s[62:63]
    s_cmp_eq_u64 vcc, -1
    s_cbranch_scc0 L_spinl15
    s_branch L_back15
L_spin16:
    s_mov_b32 s64, 0x20000
L_spinl16:
    s_sleep 8
    buffer_load_dword v7, v8, s[16:19], 0 offen sc1
    s_sub_u32 s64, s64, 1
    s_cmp_eq_u32 s64, 0
    s_cbranch_scc1 L_back16
    s_waitcnt vmcnt(0)
    v_cmp_ne_u32 vcc, 0, v7
    s_nop 1
    s_cmp_eq_u64 vcc, -1
    s_cbranch_scc0 L_spinl16
    s_branch L_back16
L_codeend:
L_exact:
    s_nop 15
    v_mov_b32 v8, 0xf149f2ca
    ds_read_b128 v[22:25], v18 offset:20480
    ds_read_b128 v[26:29], v19 offset:20480
    ds_read_b128 v[38:41], v62 offset:20480
    ds_read_b128 v[42:45], v62 offset:21760
    s_waitcnt lgkmcnt(3)
    v_mfma_f32_32x32x16_bf16 v[96:111], v[22:25], v[240:243], 0
    s_waitcnt lgkmcnt(2)
    v_mfma_f32_32x32x16_bf16 v[96:111], v[26:29], v[10:13], v[96:111]
    s_nop 11
    v_cndmask_b32_e64 v96, v8, v96, s[70:71]
    v_cndmask_b32_e64 v97, v8, v97, s[72:73]
    v_cndmask_b32_e64 v98, v8, v98, s[74:75]
    v_cndmask_b32_e64 v99, v8, v99, s[76:77]
    v_cndmask_b32_e64 v100, v8, v100, s[78:79]
    v_cndmask_b32_e64 v101, v8, v101, s[80:81]
    v_cndmask_b32_e64 v102, v8, v102, s[82:83]
    v_cndmask_b32_e64 v103, v8, v103, s[84:85]
    v_cndmask_b32_e64 v104, v8, v104, s[86:87]
    v_cndmask_b32_e64 v105, v8, v105, s[88:89]
    v_cndmask_b32_e64 v106, v8, v106, s[90:91]
    v_cndmask_b32_e64 v107, v8, v107, s[92:93]
    v_cndmask_b32_e64 v108, v8, v108, s[94:95]
    v_cndmask_b32_e64 v109, v8, v109, s[96:97]
    v_cndmask_b32_e64 v110, v8, v110, s[98:99]
    v_cndmask_b32_e64 v111, v8, v111, s[100:101]
    v_max_f32 v9, v96, v97
    v_max3_f32 v9, v9, v98, v99
    v_max3_f32 v9, v9, v100, v101
    v_max3_f32 v9, v9, v102, v103
    v_max3_f32 v9, v9, v104, v105
    v_max3_f32 v9, v9, v106, v107
    v_max3_f32 v9, v9, v108, v109
    v_max3_f32 v9, v9, v110, v111
    v_mov_b32 v7, v9
    s_nop 1
    v_permlane32_swap_b32 v9, v7
    v_max_f32 v9, v9, v7
    v_mov_b32 v20, v9
    v_sub_f32 v96, v96, v20
    v_sub_f32 v97, v97, v20
    v_sub_f32 v98, v98, v20
    v_sub_f32 v99, v99, v20
    v_sub_f32 v100, v100, v20
    v_sub_f32 v101, v101, v20
    v_sub_f32 v102, v102, v20
    v_sub_f32 v103, v103, v20
    v_sub_f32 v104, v104, v20
    v_sub_f32 v105, v105, v20
    v_sub_f32 v106, v106, v20
    v_sub_f32 v107, v107, v20
    v_sub_f32 v108, v108, v20
    v_sub_f32 v109, v109, v20
    v_sub_f32 v110, v110, v20
    v_sub_f32 v111, v111, v20
    v_exp_f32 v96, v96
    v_exp_f32 v97, v97
    v_exp_f32 v98, v98
    v_exp_f32 v99, v99
    v_exp_f32 v100, v100
    v_exp_f32 v101, v101
    v_exp_f32 v102, v102
    v_exp_f32 v103, v103
    v_exp_f32 v104, v104
    v_exp_f32 v105, v105
    v_exp_f32 v106, v106
    v_exp_f32 v107, v107
    v_exp_f32 v108, v108
    v_exp_f32 v109, v109
    v_exp_f32 v110, v110
    v_exp_f32 v111, v111
    v_cvt_pk_bf16_f32 v96, v96, v97
    v_cvt_pk_bf16_f32 v97, v98, v99
    v_cvt_pk_bf16_f32 v98, v100, v101
    v_cvt_pk_bf16_f32 v99, v102, v103
    v_cvt_pk_bf16_f32 v100, v104, v105
    v_cvt_pk_bf16_f32 v101, v106, v107
    v_cvt_pk_bf16_f32 v102, v108, v109
    v_cvt_pk_bf16_f32 v103, v110, v111
    s_waitcnt lgkmcnt(0)
    v_mfma_f32_32x32x16_bf16 v[64:79], v[38:41], v[96:99], 0
    v_mfma_f32_32x32x16_bf16 v[64:79], v[42:45], v[100:103], v[64:79]
    ds_read_b128 v[22:25], v18 offset:0
    ds_read_b128 v[26:29], v19 offset:0
    ds_read_b128 v[38:41], v62 offset:0
    ds_read_b128 v[42:45], v62 offset:1280
    s_waitcnt lgkmcnt(3)
    v_mfma_f32_32x32x16_bf16 v[96:111], v[22:25], v[240:243], 0
    s_waitcnt lgkmcnt(2)
    v_mfma_f32_32x32x16_bf16 v[96:111], v[26:29], v[10:13], v[96:111]
    s_nop 11
    v_cndmask_b32_e64 v96, v96, v8, s[70:71]
    v_cndmask_b32_e64 v97, v97, v8, s[72:73]
    v_cndmask_b32_e64 v98, v98, v8, s[74:75]
    v_cndmask_b32_e64 v99, v99, v8, s[76:77]
    v_cndmask_b32_e64 v100, v100, v8, s[78:79]
    v_cndmask_b32_e64 v101, v101, v8, s[80:81]
    v_cndmask_b32_e64 v102, v102, v8, s[82:83]
    v_cndmask_b32_e64 v103, v103, v8, s[84:85]
    v_cndmask_b32_e64 v104, v104, v8, s[86:87]
    v_cndmask_b32_e64 v105, v105, v8, s[88:89]
    v_cndmask_b32_e64 v106, v106, v8, s[90:91]
    v_cndmask_b32_e64 v107, v107, v8, s[92:93]
    v_cndmask_b32_e64 v108, v108, v8, s[94:95]
    v_cndmask_b32_e64 v109, v109, v8, s[96:97]
    v_cndmask_b32_e64 v110, v110, v8, s[98:99]
    v_cndmask_b32_e64 v111, v111, v8, s[100:101]
    v_max_f32 v9, v96, v97
    v_max3_f32 v9, v9, v98, v99
    v_max3_f32 v9, v9, v100, v101
    v_max3_f32 v9, v9, v102, v103
    v_max3_f32 v9, v9, v104, v105
    v_max3_f32 v9, v9, v106, v107
    v_max3_f32 v9, v9, v108, v109
    v_max3_f32 v9, v9, v110, v111
    v_mov_b32 v7, v9
    s_nop 1
    v_permlane32_swap_b32 v9, v7
    v_max_f32 v9, v9, v7
    v_max_f32 v9, v9, v20
    v_sub_f32 v7, v20, v9
    v_exp_f32 v7, v7
    s_nop 0
    v_mul_f32 v64, v7, v64
    v_mul_f32 v65, v7, v65
    v_mul_f32 v66, v7, v66
    v_mul_f32 v67, v7, v67
    v_mul_f32 v68, v7, v68
    v_mul_f32 v69, v7, v69
    v_mul_f32 v70, v7, v70
    v_mul_f32 v71, v7, v71
    v_mul_f32 v72, v7, v72
    v_mul_f32 v73, v7, v73
    v_mul_f32 v74, v7, v74
    v_mul_f32 v75, v7, v75
    v_mul_f32 v76, v7, v76
    v_mul_f32 v77, v7, v77
    v_mul_f32 v78, v7, v78
    v_mul_f32 v79, v7, v79
    v_mov_b32 v20, v9
    v_sub_f32 v96, v96, v20
    v_sub_f32 v97, v97, v20
    v_sub_f32 v98, v98, v20
    v_sub_f32 v99, v99, v20
    v_sub_f32 v100, v100, v20
    v_sub_f32 v101, v101, v20
    v_sub_f32 v102, v102, v20
    v_sub_f32 v103, v103, v20
    v_sub_f32 v104, v104, v20
    v_sub_f32 v105, v105, v20
    v_sub_f32 v106, v106, v20
    v_sub_f32 v107, v107, v20
    v_sub_f32 v108, v108, v20
    v_sub_f32 v109, v109, v20
    v_sub_f32 v110, v110, v20
    v_sub_f32 v111, v111, v20
    v_exp_f32 v96, v96
    v_exp_f32 v97, v97
    v_exp_f32 v98, v98
    v_exp_f32 v99, v99
    v_exp_f32 v100, v100
    v_exp_f32 v101, v101
    v_exp_f32 v102, v102
    v_exp_f32 v103, v103
    v_exp_f32 v104, v104
    v_exp_f32 v105, v105
    v_exp_f32 v106, v106
    v_exp_f32 v107, v107
    v_exp_f32 v108, v108
    v_exp_f32 v109, v109
    v_exp_f32 v110, v110
    v_exp_f32 v111, v111
    v_cvt_pk_bf16_f32 v96, v96, v97
    v_cvt_pk_bf16_f32 v97, v98, v99
    v_cvt_pk_bf16_f32 v98, v100, v101
    v_cvt_pk_bf16_f32 v99, v102, v103
    v_cvt_pk_bf16_f32 v100, v104, v105
    v_cvt_pk_bf16_f32 v101, v106, v107
    v_cvt_pk_bf16_f32 v102, v108, v109
    v_cvt_pk_bf16_f32 v103, v110, v111
    s_waitcnt lgkmcnt(0)
    v_mfma_f32_32x32x16_bf16 v[64:79], v[38:41], v[96:99], v[64:79]
    v_mfma_f32_32x32x16_bf16 v[64:79], v[42:45], v[100:103], v[64:79]
    ds_read_b128 v[22:25], v18 offset:2560
    ds_read_b128 v[26:29], v19 offset:2560
    ds_read_b128 v[38:41], v62 offset:2560
    ds_read_b128 v[42:45], v62 offset:3840
    s_waitcnt lgkmcnt(3)
    v_mfma_f32_32x32x16_bf16 v[96:111], v[22:25], v[240:243], 0
    s_waitcnt lgkmcnt(2)
    v_mfma_f32_32x32x16_bf16 v[96:111], v[26:29], v[10:13], v[96:111]
    s_nop 11
    v_max_f32 v9, v96, v97
    v_max3_f32 v9, v9, v98, v99
    v_max3_f32 v9, v9, v100, v101
    v_max3_f32 v9, v9, v102, v103
    v_max3_f32 v9, v9, v104, v105
    v_max3_f32 v9, v9, v106, v107
    v_max3_f32 v9, v9, v108, v109
    v_max3_f32 v9, v9, v110, v111
    v_mov_b32 v7, v9
    s_nop 1
    v_permlane32_swap_b32 v9, v7
    v_max_f32 v9, v9, v7
    v_max_f32 v9, v9, v20
    v_sub_f32 v7, v20, v9
    v_exp_f32 v7, v7
    s_nop 0
    v_mul_f32 v64, v7, v64
    v_mul_f32 v65, v7, v65
    v_mul_f32 v66, v7, v66
    v_mul_f32 v67, v7, v67
    v_mul_f32 v68, v7, v68
    v_mul_f32 v69, v7, v69
    v_mul_f32 v70, v7, v70
    v_mul_f32 v71, v7, v71
    v_mul_f32 v72, v7, v72
    v_mul_f32 v73, v7, v73
    v_mul_f32 v74, v7, v74
    v_mul_f32 v75, v7, v75
    v_mul_f32 v76, v7, v76
    v_mul_f32 v77, v7, v77
    v_mul_f32 v78, v7, v78
    v_mul_f32 v79, v7, v79
    v_mov_b32 v20, v9
    v_sub_f32 v96, v96, v20
    v_sub_f32 v97, v97, v20
    v_sub_f32 v98, v98, v20
    v_sub_f32 v99, v99, v20
    v_sub_f32 v100, v100, v20
    v_sub_f32 v101, v101, v20
    v_sub_f32 v102, v102, v20
    v_sub_f32 v103, v103, v20
    v_sub_f32 v104, v104, v20
    v_sub_f32 v105, v105, v20
    v_sub_f32 v106, v106, v20
    v_sub_f32 v107, v107, v20
    v_sub_f32 v108, v108, v20
    v_sub_f32 v109, v109, v20
    v_sub_f32 v110, v110, v20
    v_sub_f32 v111, v111, v20
    v_exp_f32 v96, v96
    v_exp_f32 v97, v97
    v_exp_f32 v98, v98
    v_exp_f32 v99, v99
    v_exp_f32 v100, v100
    v_exp_f32 v101, v101
    v_exp_f32 v102, v102
    v_exp_f32 v103, v103
    v_exp_f32 v104, v104
    v_exp_f32 v105, v105
    v_exp_f32 v106, v106
    v_exp_f32 v107, v107
    v_exp_f32 v108, v108
    v_exp_f32 v109, v109
    v_exp_f32 v110, v110
    v_exp_f32 v111, v111
    v_cvt_pk_bf16_f32 v96, v96, v97
    v_cvt_pk_bf16_f32 v97, v98, v99
    v_cvt_pk_bf16_f32 v98, v100, v101
    v_cvt_pk_bf16_f32 v99, v102, v103
    v_cvt_pk_bf16_f32 v100, v104, v105
    v_cvt_pk_bf16_f32 v101, v106, v107
    v_cvt_pk_bf16_f32 v102, v108, v109
    v_cvt_pk_bf16_f32 v103, v110, v111
    s_waitcnt lgkmcnt(0)
    v_mfma_f32_32x32x16_bf16 v[64:79], v[38:41], v[96:99], v[64:79]
    v_mfma_f32_32x32x16_bf16 v[64:79], v[42:45], v[100:103], v[64:79]
    ds_read_b128 v[22:25], v18 offset:5120
    ds_read_b128 v[26:29], v19 offset:5120
    ds_read_b128 v[38:41], v62 offset:5120
    ds_read_b128 v[42:45], v62 offset:6400
    s_waitcnt lgkmcnt(3)
    v_mfma_f32_32x32x16_bf16 v[96:111], v[22:25], v[240:243], 0
    s_waitcnt lgkmcnt(2)
    v_mfma_f32_32x32x16_bf16 v[96:111], v[26:29], v[10:13], v[96:111]
    s_nop 11
    v_max_f32 v9, v96, v97
    v_max3_f32 v9, v9, v98, v99
    v_max3_f32 v9, v9, v100, v101
    v_max3_f32 v9, v9, v102, v103
    v_max3_f32 v9, v9, v104, v105
    v_max3_f32 v9, v9, v106, v107
    v_max3_f32 v9, v9, v108, v109
    v_max3_f32 v9, v9, v110, v111
    v_mov_b32 v7, v9
    s_nop 1
    v_permlane32_swap_b32 v9, v7
    v_max_f32 v9, v9, v7
    v_max_f32 v9, v9, v20
    v_sub_f32 v7, v20, v9
    v_exp_f32 v7, v7
    s_nop 0
    v_mul_f32 v64, v7, v64
    v_mul_f32 v65, v7, v65
    v_mul_f32 v66, v7, v66
    v_mul_f32 v67, v7, v67
    v_mul_f32 v68, v7, v68
    v_mul_f32 v69, v7, v69
    v_mul_f32 v70, v7, v70
    v_mul_f32 v71, v7, v71
    v_mul_f32 v72, v7, v72
    v_mul_f32 v73, v7, v73
    v_mul_f32 v74, v7, v74
    v_mul_f32 v75, v7, v75
    v_mul_f32 v76, v7, v76
    v_mul_f32 v77, v7, v77
    v_mul_f32 v78, v7, v78
    v_mul_f32 v79, v7, v79
    v_mov_b32 v20, v9
    v_sub_f32 v96, v96, v20
    v_sub_f32 v97, v97, v20
    v_sub_f32 v98, v98, v20
    v_sub_f32 v99, v99, v20
    v_sub_f32 v100, v100, v20
    v_sub_f32 v101, v101, v20
    v_sub_f32 v102, v102, v20
    v_sub_f32 v103, v103, v20
    v_sub_f32 v104, v104, v20
    v_sub_f32 v105, v105, v20
    v_sub_f32 v106, v106, v20
    v_sub_f32 v107, v107, v20
    v_sub_f32 v108, v108, v20
    v_sub_f32 v109, v109, v20
    v_sub_f32 v110, v110, v20
    v_sub_f32 v111, v111, v20
    v_exp_f32 v96, v96
    v_exp_f32 v97, v97
    v_exp_f32 v98, v98
    v_exp_f32 v99, v99
    v_exp_f32 v100, v100
    v_exp_f32 v101, v101
    v_exp_f32 v102, v102
    v_exp_f32 v103, v103
    v_exp_f32 v104, v104
    v_exp_f32 v105, v105
    v_exp_f32 v106, v106
    v_exp_f32 v107, v107
    v_exp_f32 v108, v108
    v_exp_f32 v109, v109
    v_exp_f32 v110, v110
    v_exp_f32 v111, v111
    v_cvt_pk_bf16_f32 v96, v96, v97
    v_cvt_pk_bf16_f32 v97, v98, v99
    v_cvt_pk_bf16_f32 v98, v100, v101
    v_cvt_pk_bf16_f32 v99, v102, v103
    v_cvt_pk_bf16_f32 v100, v104, v105
    v_cvt_pk_bf16_f32 v101, v106, v107
    v_cvt_pk_bf16_f32 v102, v108, v109
    v_cvt_pk_bf16_f32 v103, v110, v111
    s_waitcnt lgkmcnt(0)
    v_mfma_f32_32x32x16_bf16 v[64:79], v[38:41], v[96:99], v[64:79]
    v_mfma_f32_32x32x16_bf16 v[64:79], v[42:45], v[100:103], v[64:79]
    ds_read_b128 v[22:25], v18 offset:7680
    ds_read_b128 v[26:29], v19 offset:7680
    ds_read_b128 v[38:41], v62 offset:7680
    ds_read_b128 v[42:45], v62 offset:8960
    s_waitcnt lgkmcnt(3)
    v_mfma_f32_32x32x16_bf16 v[96:111], v[22:25], v[240:243], 0
    s_waitcnt lgkmcnt(2)
    v_mfma_f32_32x32x16_bf16 v[96:111], v[26:29], v[10:13], v[96:111]
    s_nop 11
    v_max_f32 v9, v96, v97
    v_max3_f32 v9, v9, v98, v99
    v_max3_f32 v9, v9, v100, v101
    v_max3_f32 v9, v9, v102, v103
    v_max3_f32 v9, v9, v104, v105
    v_max3_f32 v9, v9, v106, v107
    v_max3_f32 v9, v9, v108, v109
    v_max3_f32 v9, v9, v110, v111
    v_mov_b32 v7, v9
    s_nop 1
    v_permlane32_swap_b32 v9, v7
    v_max_f32 v9, v9, v7
    v_max_f32 v9, v9, v20
    v_sub_f32 v7, v20, v9
    v_exp_f32 v7, v7
    s_nop 0
    v_mul_f32 v64, v7, v64
    v_mul_f32 v65, v7, v65
    v_mul_f32 v66, v7, v66
    v_mul_f32 v67, v7, v67
    v_mul_f32 v68, v7, v68
    v_mul_f32 v69, v7, v69
    v_mul_f32 v70, v7, v70
    v_mul_f32 v71, v7, v71
    v_mul_f32 v72, v7, v72
    v_mul_f32 v73, v7, v73
    v_mul_f32 v74, v7, v74
    v_mul_f32 v75, v7, v75
    v_mul_f32 v76, v7, v76
    v_mul_f32 v77, v7, v77
    v_mul_f32 v78, v7, v78
    v_mul_f32 v79, v7, v79
    v_mov_b32 v20, v9
    v_sub_f32 v96, v96, v20
    v_sub_f32 v97, v97, v20
    v_sub_f32 v98, v98, v20
    v_sub_f32 v99, v99, v20
    v_sub_f32 v100, v100, v20
    v_sub_f32 v101, v101, v20
    v_sub_f32 v102, v102, v20
    v_sub_f32 v103, v103, v20
    v_sub_f32 v104, v104, v20
    v_sub_f32 v105, v105, v20
    v_sub_f32 v106, v106, v20
    v_sub_f32 v107, v107, v20
    v_sub_f32 v108, v108, v20
    v_sub_f32 v109, v109, v20
    v_sub_f32 v110, v110, v20
    v_sub_f32 v111, v111, v20
    v_exp_f32 v96, v96
    v_exp_f32 v97, v97
    v_exp_f32 v98, v98
    v_exp_f32 v99, v99
    v_exp_f32 v100, v100
    v_exp_f32 v101, v101
    v_exp_f32 v102, v102
    v_exp_f32 v103, v103
    v_exp_f32 v104, v104
    v_exp_f32 v105, v105
    v_exp_f32 v106, v106
    v_exp_f32 v107, v107
    v_exp_f32 v108, v108
    v_exp_f32 v109, v109
    v_exp_f32 v110, v110
    v_exp_f32 v111, v111
    v_cvt_pk_bf16_f32 v96, v96, v97
    v_cvt_pk_bf16_f32 v97, v98, v99
    v_cvt_pk_bf16_f32 v98, v100, v101
    v_cvt_pk_bf16_f32 v99, v102, v103
    v_cvt_pk_bf16_f32 v100, v104, v105
    v_cvt_pk_bf16_f32 v101, v106, v107
    v_cvt_pk_bf16_f32 v102, v108, v109
    v_cvt_pk_bf16_f32 v103, v110, v111
    s_waitcnt lgkmcnt(0)
    v_mfma_f32_32x32x16_bf16 v[64:79], v[38:41], v[96:99], v[64:79]
    v_mfma_f32_32x32x16_bf16 v[64:79], v[42:45], v[100:103], v[64:79]
    ds_read_b128 v[22:25], v18 offset:10240
    ds_read_b128 v[26:29], v19 offset:10240
    ds_read_b128 v[38:41], v62 offset:10240
    ds_read_b128 v[42:45], v62 offset:11520
    s_waitcnt lgkmcnt(3)
    v_mfma_f32_32x32x16_bf16 v[96:111], v[22:25], v[240:243], 0
    s_waitcnt lgkmcnt(2)
    v_mfma_f32_32x32x16_bf16 v[96:111], v[26:29], v[10:13], v[96:111]
    s_nop 11
    v_max_f32 v9, v96, v97
    v_max3_f32 v9, v9, v98, v99
    v_max3_f32 v9, v9, v100, v101
    v_max3_f32 v9, v9, v102, v103
    v_max3_f32 v9, v9, v104, v105
    v_max3_f32 v9, v9, v106, v107
    v_max3_f32 v9, v9, v108, v109
    v_max3_f32 v9, v9, v110, v111
    v_mov_b32 v7, v9
    s_nop 1
    v_permlane32_swap_b32 v9, v7
    v_max_f32 v9, v9, v7
    v_max_f32 v9, v9, v20
    v_sub_f32 v7, v20, v9
    v_exp_f32 v7, v7
    s_nop 0
    v_mul_f32 v64, v7, v64
    v_mul_f32 v65, v7, v65
    v_mul_f32 v66, v7, v66
    v_mul_f32 v67, v7, v67
    v_mul_f32 v68, v7, v68
    v_mul_f32 v69, v7, v69
    v_mul_f32 v70, v7, v70
    v_mul_f32 v71, v7, v71
    v_mul_f32 v72, v7, v72
    v_mul_f32 v73, v7, v73
    v_mul_f32 v74, v7, v74
    v_mul_f32 v75, v7, v75
    v_mul_f32 v76, v7, v76
    v_mul_f32 v77, v7, v77
    v_mul_f32 v78, v7, v78
    v_mul_f32 v79, v7, v79
    v_mov_b32 v20, v9
    v_sub_f32 v96, v96, v20
    v_sub_f32 v97, v97, v20
    v_sub_f32 v98, v98, v20
    v_sub_f32 v99, v99, v20
    v_sub_f32 v100, v100, v20
    v_sub_f32 v101, v101, v20
    v_sub_f32 v102, v102, v20
    v_sub_f32 v103, v103, v20
    v_sub_f32 v104, v104, v20
    v_sub_f32 v105, v105, v20
    v_sub_f32 v106, v106, v20
    v_sub_f32 v107, v107, v20
    v_sub_f32 v108, v108, v20
    v_sub_f32 v109, v109, v20
    v_sub_f32 v110, v110, v20
    v_sub_f32 v111, v111, v20
    v_exp_f32 v96, v96
    v_exp_f32 v97, v97
    v_exp_f32 v98, v98
    v_exp_f32 v99, v99
    v_exp_f32 v100, v100
    v_exp_f32 v101, v101
    v_exp_f32 v102, v102
    v_exp_f32 v103, v103
    v_exp_f32 v104, v104
    v_exp_f32 v105, v105
    v_exp_f32 v106, v106
    v_exp_f32 v107, v107
    v_exp_f32 v108, v108
    v_exp_f32 v109, v109
    v_exp_f32 v110, v110
    v_exp_f32 v111, v111
    v_cvt_pk_bf16_f32 v96, v96, v97
    v_cvt_pk_bf16_f32 v97, v98, v99
    v_cvt_pk_bf16_f32 v98, v100, v101
    v_cvt_pk_bf16_f32 v99, v102, v103
    v_cvt_pk_bf16_f32 v100, v104, v105
    v_cvt_pk_bf16_f32 v101, v106, v107
    v_cvt_pk_bf16_f32 v102, v108, v109
    v_cvt_pk_bf16_f32 v103, v110, v111
    s_waitcnt lgkmcnt(0)
    v_mfma_f32_32x32x16_bf16 v[64:79], v[38:41], v[96:99], v[64:79]
    v_mfma_f32_32x32x16_bf16 v[64:79], v[42:45], v[100:103], v[64:79]
    ds_read_b128 v[22:25], v18 offset:12800
    ds_read_b128 v[26:29], v19 offset:12800
    ds_read_b128 v[38:41], v62 offset:12800
    ds_read_b128 v[42:45], v62 offset:14080
    s_waitcnt lgkmcnt(3)
    v_mfma_f32_32x32x16_bf16 v[96:111], v[22:25], v[240:243], 0
    s_waitcnt lgkmcnt(2)
    v_mfma_f32_32x32x16_bf16 v[96:111], v[26:29], v[10:13], v[96:111]
    s_nop 11
    v_max_f32 v9, v96, v97
    v_max3_f32 v9, v9, v98, v99
    v_max3_f32 v9, v9, v100, v101
    v_max3_f32 v9, v9, v102, v103
    v_max3_f32 v9, v9, v104, v105
    v_max3_f32 v9, v9, v106, v107
    v_max3_f32 v9, v9, v108, v109
    v_max3_f32 v9, v9, v110, v111
    v_mov_b32 v7, v9
    s_nop 1
    v_permlane32_swap_b32 v9, v7
    v_max_f32 v9, v9, v7
    v_max_f32 v9, v9, v20
    v_sub_f32 v7, v20, v9
    v_exp_f32 v7, v7
    s_nop 0
    v_mul_f32 v64, v7, v64
    v_mul_f32 v65, v7, v65
    v_mul_f32 v66, v7, v66
    v_mul_f32 v67, v7, v67
    v_mul_f32 v68, v7, v68
    v_mul_f32 v69, v7, v69
    v_mul_f32 v70, v7, v70
    v_mul_f32 v71, v7, v71
    v_mul_f32 v72, v7, v72
    v_mul_f32 v73, v7, v73
    v_mul_f32 v74, v7, v74
    v_mul_f32 v75, v7, v75
    v_mul_f32 v76, v7, v76
    v_mul_f32 v77, v7, v77
    v_mul_f32 v78, v7, v78
    v_mul_f32 v79, v7, v79
    v_mov_b32 v20, v9
    v_sub_f32 v96, v96, v20
    v_sub_f32 v97, v97, v20
    v_sub_f32 v98, v98, v20
    v_sub_f32 v99, v99, v20
    v_sub_f32 v100, v100, v20
    v_sub_f32 v101, v101, v20
    v_sub_f32 v102, v102, v20
    v_sub_f32 v103, v103, v20
    v_sub_f32 v104, v104, v20
    v_sub_f32 v105, v105, v20
    v_sub_f32 v106, v106, v20
    v_sub_f32 v107, v107, v20
    v_sub_f32 v108, v108, v20
    v_sub_f32 v109, v109, v20
    v_sub_f32 v110, v110, v20
    v_sub_f32 v111, v111, v20
    v_exp_f32 v96, v96
    v_exp_f32 v97, v97
    v_exp_f32 v98, v98
    v_exp_f32 v99, v99
    v_exp_f32 v100, v100
    v_exp_f32 v101, v101
    v_exp_f32 v102, v102
    v_exp_f32 v103, v103
    v_exp_f32 v104, v104
    v_exp_f32 v105, v105
    v_exp_f32 v106, v106
    v_exp_f32 v107, v107
    v_exp_f32 v108, v108
    v_exp_f32 v109, v109
    v_exp_f32 v110, v110
    v_exp_f32 v111, v111
    v_cvt_pk_bf16_f32 v96, v96, v97
    v_cvt_pk_bf16_f32 v97, v98, v99
    v_cvt_pk_bf16_f32 v98, v100, v101
    v_cvt_pk_bf16_f32 v99, v102, v103
    v_cvt_pk_bf16_f32 v100, v104, v105
    v_cvt_pk_bf16_f32 v101, v106, v107
    v_cvt_pk_bf16_f32 v102, v108, v109
    v_cvt_pk_bf16_f32 v103, v110, v111
    s_waitcnt lgkmcnt(0)
    v_mfma_f32_32x32x16_bf16 v[64:79], v[38:41], v[96:99], v[64:79]
    v_mfma_f32_32x32x16_bf16 v[64:79], v[42:45], v[100:103], v[64:79]
    ds_read_b128 v[22:25], v18 offset:15360
    ds_read_b128 v[26:29], v19 offset:15360
    ds_read_b128 v[38:41], v62 offset:15360
    ds_read_b128 v[42:45], v62 offset:16640
    s_waitcnt lgkmcnt(3)
    v_mfma_f32_32x32x16_bf16 v[96:111], v[22:25], v[240:243], 0
    s_waitcnt lgkmcnt(2)
    v_mfma_f32_32x32x16_bf16 v[96:111], v[26:29], v[10:13], v[96:111]
    s_nop 11
    v_max_f32 v9, v96, v97
    v_max3_f32 v9, v9, v98, v99
    v_max3_f32 v9, v9, v100, v101
    v_max3_f32 v9, v9, v102, v103
    v_max3_f32 v9, v9, v104, v105
    v_max3_f32 v9, v9, v106, v107
    v_max3_f32 v9, v9, v108, v109
    v_max3_f32 v9, v9, v110, v111
    v_mov_b32 v7, v9
    s_nop 1
    v_permlane32_swap_b32 v9, v7
    v_max_f32 v9, v9, v7
    v_max_f32 v9, v9, v20
    v_sub_f32 v7, v20, v9
    v_exp_f32 v7, v7
    s_nop 0
    v_mul_f32 v64, v7, v64
    v_mul_f32 v65, v7, v65
    v_mul_f32 v66, v7, v66
    v_mul_f32 v67, v7, v67
    v_mul_f32 v68, v7, v68
    v_mul_f32 v69, v7, v69
    v_mul_f32 v70, v7, v70
    v_mul_f32 v71, v7, v71
    v_mul_f32 v72, v7, v72
    v_mul_f32 v73, v7, v73
    v_mul_f32 v74, v7, v74
    v_mul_f32 v75, v7, v75
    v_mul_f32 v76, v7, v76
    v_mul_f32 v77, v7, v77
    v_mul_f32 v78, v7, v78
    v_mul_f32 v79, v7, v79
    v_mov_b32 v20, v9
    v_sub_f32 v96, v96, v20
    v_sub_f32 v97, v97, v20
    v_sub_f32 v98, v98, v20
    v_sub_f32 v99, v99, v20
    v_sub_f32 v100, v100, v20
    v_sub_f32 v101, v101, v20
    v_sub_f32 v102, v102, v20
    v_sub_f32 v103, v103, v20
    v_sub_f32 v104, v104, v20
    v_sub_f32 v105, v105, v20
    v_sub_f32 v106, v106, v20
    v_sub_f32 v107, v107, v20
    v_sub_f32 v108, v108, v20
    v_sub_f32 v109, v109, v20
    v_sub_f32 v110, v110, v20
    v_sub_f32 v111, v111, v20
    v_exp_f32 v96, v96
    v_exp_f32 v97, v97
    v_exp_f32 v98, v98
    v_exp_f32 v99, v99
    v_exp_f32 v100, v100
    v_exp_f32 v101, v101
    v_exp_f32 v102, v102
    v_exp_f32 v103, v103
    v_exp_f32 v104, v104
    v_exp_f32 v105, v105
    v_exp_f32 v106, v106
    v_exp_f32 v107, v107
    v_exp_f32 v108, v108
    v_exp_f32 v109, v109
    v_exp_f32 v110, v110
    v_exp_f32 v111, v111
    v_cvt_pk_bf16_f32 v96, v96, v97
    v_cvt_pk_bf16_f32 v97, v98, v99
    v_cvt_pk_bf16_f32 v98, v100, v101
    v_cvt_pk_bf16_f32 v99, v102, v103
    v_cvt_pk_bf16_f32 v100, v104, v105
    v_cvt_pk_bf16_f32 v101, v106, v107
    v_cvt_pk_bf16_f32 v102, v108, v109
    v_cvt_pk_bf16_f32 v103, v110, v111
    s_waitcnt lgkmcnt(0)
    v_mfma_f32_32x32x16_bf16 v[64:79], v[38:41], v[96:99], v[64:79]
    v_mfma_f32_32x32x16_bf16 v[64:79], v[42:45], v[100:103], v[64:79]
    ds_read_b128 v[22:25], v18 offset:17920
    ds_read_b128 v[26:29], v19 offset:17920
    ds_read_b128 v[38:41], v62 offset:17920
    ds_read_b128 v[42:45], v62 offset:19200
    s_waitcnt lgkmcnt(3)
    v_mfma_f32_32x32x16_bf16 v[96:111], v[22:25], v[240:243], 0
    s_waitcnt lgkmcnt(2)
    v_mfma_f32_32x32x16_bf16 v[96:111], v[26:29], v[10:13], v[96:111]
    s_nop 11
    v_max_f32 v9, v96, v97
    v_max3_f32 v9, v9, v98, v99
    v_max3_f32 v9, v9, v100, v101
    v_max3_f32 v9, v9, v102, v103
    v_max3_f32 v9, v9, v104, v105
    v_max3_f32 v9, v9, v106, v107
    v_max3_f32 v9, v9, v108, v109
    v_max3_f32 v9, v9, v110, v111
    v_mov_b32 v7, v9
    s_nop 1
    v_permlane32_swap_b32 v9, v7
    v_max_f32 v9, v9, v7
    v_max_f32 v9, v9, v20
    v_sub_f32 v7, v20, v9
    v_exp_f32 v7, v7
    s_nop 0
    v_mul_f32 v64, v7, v64
    v_mul_f32 v65, v7, v65
    v_mul_f32 v66, v7, v66
    v_mul_f32 v67, v7, v67
    v_mul_f32 v68, v7, v68
    v_mul_f32 v69, v7, v69
    v_mul_f32 v70, v7, v70
    v_mul_f32 v71, v7, v71
    v_mul_f32 v72, v7, v72
    v_mul_f32 v73, v7, v73
    v_mul_f32 v74, v7, v74
    v_mul_f32 v75, v7, v75
    v_mul_f32 v76, v7, v76
    v_mul_f32 v77, v7, v77
    v_mul_f32 v78, v7, v78
    v_mul_f32 v79, v7, v79
    v_mov_b32 v20, v9
    v_sub_f32 v96, v96, v20
    v_sub_f32 v97, v97, v20
    v_sub_f32 v98, v98, v20
    v_sub_f32 v99, v99, v20
    v_sub_f32 v100, v100, v20
    v_sub_f32 v101, v101, v20
    v_sub_f32 v102, v102, v20
    v_sub_f32 v103, v103, v20
    v_sub_f32 v104, v104, v20
    v_sub_f32 v105, v105, v20
    v_sub_f32 v106, v106, v20
    v_sub_f32 v107, v107, v20
    v_sub_f32 v108, v108, v20
    v_sub_f32 v109, v109, v20
    v_sub_f32 v110, v110, v20
    v_sub_f32 v111, v111, v20
    v_exp_f32 v96, v96
    v_exp_f32 v97, v97
    v_exp_f32 v98, v98
    v_exp_f32 v99, v99
    v_exp_f32 v100, v100
    v_exp_f32 v101, v101
    v_exp_f32 v102, v102
    v_exp_f32 v103, v103
    v_exp_f32 v104, v104
    v_exp_f32 v105, v105
    v_exp_f32 v106, v106
    v_exp_f32 v107, v107
    v_exp_f32 v108, v108
    v_exp_f32 v109, v109
    v_exp_f32 v110, v110
    v_exp_f32 v111, v111
    v_cvt_pk_bf16_f32 v96, v96, v97
    v_cvt_pk_bf16_f32 v97, v98, v99
    v_cvt_pk_bf16_f32 v98, v100, v101
    v_cvt_pk_bf16_f32 v99, v102, v103
    v_cvt_pk_bf16_f32 v100, v104, v105
    v_cvt_pk_bf16_f32 v101, v106, v107
    v_cvt_pk_bf16_f32 v102, v108, v109
    v_cvt_pk_bf16_f32 v103, v110, v111
    s_waitcnt lgkmcnt(0)
    v_mfma_f32_32x32x16_bf16 v[64:79], v[38:41], v[96:99], v[64:79]
    v_mfma_f32_32x32x16_bf16 v[64:79], v[42:45], v[100:103], v[64:79]
    ds_read_b128 v[22:25], v18 offset:22016
    ds_read_b128 v[26:29], v19 offset:20480
    ds_read_b128 v[38:41], v63 offset:20480
    ds_read_b128 v[42:45], v63 offset:21760
    s_waitcnt lgkmcnt(3)
    v_mfma_f32_32x32x16_bf16 v[96:111], v[22:25], v[244:247], 0
    s_waitcnt lgkmcnt(2)
    v_mfma_f32_32x32x16_bf16 v[96:111], v[26:29], v[14:17], v[96:111]
    s_nop 11
    v_cndmask_b32_e64 v96, v8, v96, s[70:71]
    v_cndmask_b32_e64 v97, v8, v97, s[72:73]
    v_cndmask_b32_e64 v98, v8, v98, s[74:75]
    v_cndmask_b32_e64 v99, v8, v99, s[76:77]
    v_cndmask_b32_e64 v100, v8, v100, s[78:79]
    v_cndmask_b32_e64 v101, v8, v101, s[80:81]
    v_cndmask_b32_e64 v102, v8, v102, s[82:83]
    v_cndmask_b32_e64 v103, v8, v103, s[84:85]
    v_cndmask_b32_e64 v104, v8, v104, s[86:87]
    v_cndmask_b32_e64 v105, v8, v105, s[88:89]
    v_cndmask_b32_e64 v106, v8, v106, s[90:91]
    v_cndmask_b32_e64 v107, v8, v107, s[92:93]
    v_cndmask_b32_e64 v108, v8, v108, s[94:95]
    v_cndmask_b32_e64 v109, v8, v109, s[96:97]
    v_cndmask_b32_e64 v110, v8, v110, s[98:99]
    v_cndmask_b32_e64 v111, v8, v111, s[100:101]
    v_max_f32 v9, v96, v97
    v_max3_f32 v9, v9, v98, v99
    v_max3_f32 v9, v9, v100, v101
    v_max3_f32 v9, v9, v102, v103
    v_max3_f32 v9, v9, v104, v105
    v_max3_f32 v9, v9, v106, v107
    v_max3_f32 v9, v9, v108, v109
    v_max3_f32 v9, v9, v110, v111
    v_mov_b32 v7, v9
    s_nop 1
    v_permlane32_swap_b32 v9, v7
    v_max_f32 v9, v9, v7
    v_mov_b32 v20, v9
    v_sub_f32 v96, v96, v20
    v_sub_f32 v97, v97, v20
    v_sub_f32 v98, v98, v20
    v_sub_f32 v99, v99, v20
    v_sub_f32 v100, v100, v20
    v_sub_f32 v101, v101, v20
    v_sub_f32 v102, v102, v20
    v_sub_f32 v103, v103, v20
    v_sub_f32 v104, v104, v20
    v_sub_f32 v105, v105, v20
    v_sub_f32 v106, v106, v20
    v_sub_f32 v107, v107, v20
    v_sub_f32 v108, v108, v20
    v_sub_f32 v109, v109, v20
    v_sub_f32 v110, v110, v20
    v_sub_f32 v111, v111, v20
    v_exp_f32 v96, v96
    v_exp_f32 v97, v97
    v_exp_f32 v98, v98
    v_exp_f32 v99, v99
    v_exp_f32 v100, v100
    v_exp_f32 v101, v101
    v_exp_f32 v102, v102
    v_exp_f32 v103, v103
    v_exp_f32 v104, v104
    v_exp_f32 v105, v105
    v_exp_f32 v106, v106
    v_exp_f32 v107, v107
    v_exp_f32 v108, v108
    v_exp_f32 v109, v109
    v_exp_f32 v110, v110
    v_exp_f32 v111, v111
    v_cvt_pk_bf16_f32 v96, v96, v97
    v_cvt_pk_bf16_f32 v97, v98, v99
    v_cvt_pk_bf16_f32 v98, v100, v101
    v_cvt_pk_bf16_f32 v99, v102, v103
    v_cvt_pk_bf16_f32 v100, v104, v105
    v_cvt_pk_bf16_f32 v101, v106, v107
    v_cvt_pk_bf16_f32 v102, v108, v109
    v_cvt_pk_bf16_f32 v103, v110, v111
    s_waitcnt lgkmcnt(0)
    v_mfma_f32_32x32x16_bf16 v[80:95], v[38:41], v[96:99], 0
    v_mfma_f32_32x32x16_bf16 v[80:95], v[42:45], v[100:103], v[80:95]
    ds_read_b128 v[22:25], v18 offset:1536
    ds_read_b128 v[26:29], v19 offset:0
    ds_read_b128 v[38:41], v63 offset:0
    ds_read_b128 v[42:45], v63 offset:1280
    s_waitcnt lgkmcnt(3)
    v_mfma_f32_32x32x16_bf16 v[96:111], v[22:25], v[244:247], 0
    s_waitcnt lgkmcnt(2)
    v_mfma_f32_32x32x16_bf16 v[96:111], v[26:29], v[14:17], v[96:111]
    s_nop 11
    v_cndmask_b32_e64 v96, v96, v8, s[70:71]
    v_cndmask_b32_e64 v97, v97, v8, s[72:73]
    v_cndmask_b32_e64 v98, v98, v8, s[74:75]
    v_cndmask_b32_e64 v99, v99, v8, s[76:77]
    v_cndmask_b32_e64 v100, v100, v8, s[78:79]
    v_cndmask_b32_e64 v101, v101, v8, s[80:81]
    v_cndmask_b32_e64 v102, v102, v8, s[82:83]
    v_cndmask_b32_e64 v103, v103, v8, s[84:85]
    v_cndmask_b32_e64 v104, v104, v8, s[86:87]
    v_cndmask_b32_e64 v105, v105, v8, s[88:89]
    v_cndmask_b32_e64 v106, v106, v8, s[90:91]
    v_cndmask_b32_e64 v107, v107, v8, s[92:93]
    v_cndmask_b32_e64 v108, v108, v8, s[94:95]
    v_cndmask_b32_e64 v109, v109, v8, s[96:97]
    v_cndmask_b32_e64 v110, v110, v8, s[98:99]
    v_cndmask_b32_e64 v111, v111, v8, s[100:101]
    v_max_f32 v9, v96, v97
    v_max3_f32 v9, v9, v98, v99
    v_max3_f32 v9, v9, v100, v101
    v_max3_f32 v9, v9, v102, v103
    v_max3_f32 v9, v9, v104, v105
    v_max3_f32 v9, v9, v106, v107
    v_max3_f32 v9, v9, v108, v109
    v_max3_f32 v9, v9, v110, v111
    v_mov_b32 v7, v9
    s_nop 1
    v_permlane32_swap_b32 v9, v7
    v_max_f32 v9, v9, v7
    v_max_f32 v9, v9, v20
    v_sub_f32 v7, v20, v9
    v_exp_f32 v7, v7
    s_nop 0
    v_mul_f32 v80, v7, v80
    v_mul_f32 v81, v7, v81
    v_mul_f32 v82, v7, v82
    v_mul_f32 v83, v7, v83
    v_mul_f32 v84, v7, v84
    v_mul_f32 v85, v7, v85
    v_mul_f32 v86, v7, v86
    v_mul_f32 v87, v7, v87
    v_mul_f32 v88, v7, v88
    v_mul_f32 v89, v7, v89
    v_mul_f32 v90, v7, v90
    v_mul_f32 v91, v7, v91
    v_mul_f32 v92, v7, v92
    v_mul_f32 v93, v7, v93
    v_mul_f32 v94, v7, v94
    v_mul_f32 v95, v7, v95
    v_mov_b32 v20, v9
    v_sub_f32 v96, v96, v20
    v_sub_f32 v97, v97, v20
    v_sub_f32 v98, v98, v20
    v_sub_f32 v99, v99, v20
    v_sub_f32 v100, v100, v20
    v_sub_f32 v101, v101, v20
    v_sub_f32 v102, v102, v20
    v_sub_f32 v103, v103, v20
    v_sub_f32 v104, v104, v20
    v_sub_f32 v105, v105, v20
    v_sub_f32 v106, v106, v20
    v_sub_f32 v107, v107, v20
    v_sub_f32 v108, v108, v20
    v_sub_f32 v109, v109, v20
    v_sub_f32 v110, v110, v20
    v_sub_f32 v111, v111, v20
    v_exp_f32 v96, v96
    v_exp_f32 v97, v97
    v_exp_f32 v98, v98
    v_exp_f32 v99, v99
    v_exp_f32 v100, v100
    v_exp_f32 v101, v101
    v_exp_f32 v102, v102
    v_exp_f32 v103, v103
    v_exp_f32 v104, v104
    v_exp_f32 v105, v105
    v_exp_f32 v106, v106
    v_exp_f32 v107, v107
    v_exp_f32 v108, v108
    v_exp_f32 v109, v109
    v_exp_f32 v110, v110
    v_exp_f32 v111, v111
    v_cvt_pk_bf16_f32 v96, v96, v97
    v_cvt_pk_bf16_f32 v97, v98, v99
    v_cvt_pk_bf16_f32 v98, v100, v101
    v_cvt_pk_bf16_f32 v99, v102, v103
    v_cvt_pk_bf16_f32 v100, v104, v105
    v_cvt_pk_bf16_f32 v101, v106, v107
    v_cvt_pk_bf16_f32 v102, v108, v109
    v_cvt_pk_bf16_f32 v103, v110, v111
    s_waitcnt lgkmcnt(0)
    v_mfma_f32_32x32x16_bf16 v[80:95], v[38:41], v[96:99], v[80:95]
    v_mfma_f32_32x32x16_bf16 v[80:95], v[42:45], v[100:103], v[80:95]
    ds_read_b128 v[22:25], v18 offset:4096
    ds_read_b128 v[26:29], v19 offset:2560
    ds_read_b128 v[38:41], v63 offset:2560
    ds_read_b128 v[42:45], v63 offset:3840
    s_waitcnt lgkmcnt(3)
    v_mfma_f32_32x32x16_bf16 v[96:111], v[22:25], v[244:247], 0
    s_waitcnt lgkmcnt(2)
    v_mfma_f32_32x32x16_bf16 v[96:111], v[26:29], v[14:17], v[96:111]
    s_nop 11
    v_max_f32 v9, v96, v97
    v_max3_f32 v9, v9, v98, v99
    v_max3_f32 v9, v9, v100, v101
    v_max3_f32 v9, v9, v102, v103
    v_max3_f32 v9, v9, v104, v105
    v_max3_f32 v9, v9, v106, v107
    v_max3_f32 v9, v9, v108, v109
    v_max3_f32 v9, v9, v110, v111
    v_mov_b32 v7, v9
    s_nop 1
    v_permlane32_swap_b32 v9, v7
    v_max_f32 v9, v9, v7
    v_max_f32 v9, v9, v20
    v_sub_f32 v7, v20, v9
    v_exp_f32 v7, v7
    s_nop 0
    v_mul_f32 v80, v7, v80
    v_mul_f32 v81, v7, v81
    v_mul_f32 v82, v7, v82
    v_mul_f32 v83, v7, v83
    v_mul_f32 v84, v7, v84
    v_mul_f32 v85, v7, v85
    v_mul_f32 v86, v7, v86
    v_mul_f32 v87, v7, v87
    v_mul_f32 v88, v7, v88
    v_mul_f32 v89, v7, v89
    v_mul_f32 v90, v7, v90
    v_mul_f32 v91, v7, v91
    v_mul_f32 v92, v7, v92
    v_mul_f32 v93, v7, v93
    v_mul_f32 v94, v7, v94
    v_mul_f32 v95, v7, v95
    v_mov_b32 v20, v9
    v_sub_f32 v96, v96, v20
    v_sub_f32 v97, v97, v20
    v_sub_f32 v98, v98, v20
    v_sub_f32 v99, v99, v20
    v_sub_f32 v100, v100, v20
    v_sub_f32 v101, v101, v20
    v_sub_f32 v102, v102, v20
    v_sub_f32 v103, v103, v20
    v_sub_f32 v104, v104, v20
    v_sub_f32 v105, v105, v20
    v_sub_f32 v106, v106, v20
    v_sub_f32 v107, v107, v20
    v_sub_f32 v108, v108, v20
    v_sub_f32 v109, v109, v20
    v_sub_f32 v110, v110, v20
    v_sub_f32 v111, v111, v20
    v_exp_f32 v96, v96
    v_exp_f32 v97, v97
    v_exp_f32 v98, v98
    v_exp_f32 v99, v99
    v_exp_f32 v100, v100
    v_exp_f32 v101, v101
    v_exp_f32 v102, v102
    v_exp_f32 v103, v103
    v_exp_f32 v104, v104
    v_exp_f32 v105, v105
    v_exp_f32 v106, v106
    v_exp_f32 v107, v107
    v_exp_f32 v108, v108
    v_exp_f32 v109, v109
    v_exp_f32 v110, v110
    v_exp_f32 v111, v111
    v_cvt_pk_bf16_f32 v96, v96, v97
    v_cvt_pk_bf16_f32 v97, v98, v99
    v_cvt_pk_bf16_f32 v98, v100, v101
    v_cvt_pk_bf16_f32 v99, v102, v103
    v_cvt_pk_bf16_f32 v100, v104, v105
    v_cvt_pk_bf16_f32 v101, v106, v107
    v_cvt_pk_bf16_f32 v102, v108, v109
    v_cvt_pk_bf16_f32 v103, v110, v111
    s_waitcnt lgkmcnt(0)
    v_mfma_f32_32x32x16_bf16 v[80:95], v[38:41], v[96:99], v[80:95]
    v_mfma_f32_32x32x16_bf16 v[80:95], v[42:45], v[100:103], v[80:95]
    ds_read_b128 v[22:25], v18 offset:6656
    ds_read_b128 v[26:29], v19 offset:5120
    ds_read_b128 v[38:41], v63 offset:5120
    ds_read_b128 v[42:45], v63 offset:6400
    s_waitcnt lgkmcnt(3)
    v_mfma_f32_32x32x16_bf16 v[96:111], v[22:25], v[244:247], 0
    s_waitcnt lgkmcnt(2)
    v_mfma_f32_32x32x16_bf16 v[96:111], v[26:29], v[14:17], v[96:111]
    s_nop 11
    v_max_f32 v9, v96, v97
    v_max3_f32 v9, v9, v98, v99
    v_max3_f32 v9, v9, v100, v101
    v_max3_f32 v9, v9, v102, v103
    v_max3_f32 v9, v9, v104, v105
    v_max3_f32 v9, v9, v106, v107
    v_max3_f32 v9, v9, v108, v109
    v_max3_f32 v9, v9, v110, v111
    v_mov_b32 v7, v9
    s_nop 1
    v_permlane32_swap_b32 v9, v7
    v_max_f32 v9, v9, v7
    v_max_f32 v9, v9, v20
    v_sub_f32 v7, v20, v9
    v_exp_f32 v7, v7
    s_nop 0
    v_mul_f32 v80, v7, v80
    v_mul_f32 v81, v7, v81
    v_mul_f32 v82, v7, v82
    v_mul_f32 v83, v7, v83
    v_mul_f32 v84, v7, v84
    v_mul_f32 v85, v7, v85
    v_mul_f32 v86, v7, v86
    v_mul_f32 v87, v7, v87
    v_mul_f32 v88, v7, v88
    v_mul_f32 v89, v7, v89
    v_mul_f32 v90, v7, v90
    v_mul_f32 v91, v7, v91
    v_mul_f32 v92, v7, v92
    v_mul_f32 v93, v7, v93
    v_mul_f32 v94, v7, v94
    v_mul_f32 v95, v7, v95
    v_mov_b32 v20, v9
    v_sub_f32 v96, v96, v20
    v_sub_f32 v97, v97, v20
    v_sub_f32 v98, v98, v20
    v_sub_f32 v99, v99, v20
    v_sub_f32 v100, v100, v20
    v_sub_f32 v101, v101, v20
    v_sub_f32 v102, v102, v20
    v_sub_f32 v103, v103, v20
    v_sub_f32 v104, v104, v20
    v_sub_f32 v105, v105, v20
    v_sub_f32 v106, v106, v20
    v_sub_f32 v107, v107, v20
    v_sub_f32 v108, v108, v20
    v_sub_f32 v109, v109, v20
    v_sub_f32 v110, v110, v20
    v_sub_f32 v111, v111, v20
    v_exp_f32 v96, v96
    v_exp_f32 v97, v97
    v_exp_f32 v98, v98
    v_exp_f32 v99, v99
    v_exp_f32 v100, v100
    v_exp_f32 v101, v101
    v_exp_f32 v102, v102
    v_exp_f32 v103, v103
    v_exp_f32 v104, v104
    v_exp_f32 v105, v105
    v_exp_f32 v106, v106
    v_exp_f32 v107, v107
    v_exp_f32 v108, v108
    v_exp_f32 v109, v109
    v_exp_f32 v110, v110
    v_exp_f32 v111, v111
    v_cvt_pk_bf16_f32 v96, v96, v97
    v_cvt_pk_bf16_f32 v97, v98, v99
    v_cvt_pk_bf16_f32 v98, v100, v101
    v_cvt_pk_bf16_f32 v99, v102, v103
    v_cvt_pk_bf16_f32 v100, v104, v105
    v_cvt_pk_bf16_f32 v101, v106, v107
    v_cvt_pk_bf16_f32 v102, v108, v109
    v_cvt_pk_bf16_f32 v103, v110, v111
    s_waitcnt lgkmcnt(0)
    v_mfma_f32_32x32x16_bf16 v[80:95], v[38:41], v[96:99], v[80:95]
    v_mfma_f32_32x32x16_bf16 v[80:95], v[42:45], v[100:103], v[80:95]
    ds_read_b128 v[22:25], v18 offset:9216
    ds_read_b128 v[26:29], v19 offset:7680
    ds_read_b128 v[38:41], v63 offset:7680
    ds_read_b128 v[42:45], v63 offset:8960
    s_waitcnt lgkmcnt(3)
    v_mfma_f32_32x32x16_bf16 v[96:111], v[22:25], v[244:247], 0
    s_waitcnt lgkmcnt(2)
    v_mfma_f32_32x32x16_bf16 v[96:111], v[26:29], v[14:17], v[96:111]
    s_nop 11
    v_max_f32 v9, v96, v97
    v_max3_f32 v9, v9, v98, v99
    v_max3_f32 v9, v9, v100, v101
    v_max3_f32 v9, v9, v102, v103
    v_max3_f32 v9, v9, v104, v105
    v_max3_f32 v9, v9, v106, v107
    v_max3_f32 v9, v9, v108, v109
    v_max3_f32 v9, v9, v110, v111
    v_mov_b32 v7, v9
    s_nop 1
    v_permlane32_swap_b32 v9, v7
    v_max_f32 v9, v9, v7
    v_max_f32 v9, v9, v20
    v_sub_f32 v7, v20, v9
    v_exp_f32 v7, v7
    s_nop 0
    v_mul_f32 v80, v7, v80
    v_mul_f32 v81, v7, v81
    v_mul_f32 v82, v7, v82
    v_mul_f32 v83, v7, v83
    v_mul_f32 v84, v7, v84
    v_mul_f32 v85, v7, v85
    v_mul_f32 v86, v7, v86
    v_mul_f32 v87, v7, v87
    v_mul_f32 v88, v7, v88
    v_mul_f32 v89, v7, v89
    v_mul_f32 v90, v7, v90
    v_mul_f32 v91, v7, v91
    v_mul_f32 v92, v7, v92
    v_mul_f32 v93, v7, v93
    v_mul_f32 v94, v7, v94
    v_mul_f32 v95, v7, v95
    v_mov_b32 v20, v9
    v_sub_f32 v96, v96, v20
    v_sub_f32 v97, v97, v20
    v_sub_f32 v98, v98, v20
    v_sub_f32 v99, v99, v20
    v_sub_f32 v100, v100, v20
    v_sub_f32 v101, v101, v20
    v_sub_f32 v102, v102, v20
    v_sub_f32 v103, v103, v20
    v_sub_f32 v104, v104, v20
    v_sub_f32 v105, v105, v20
    v_sub_f32 v106, v106, v20
    v_sub_f32 v107, v107, v20
    v_sub_f32 v108, v108, v20
    v_sub_f32 v109, v109, v20
    v_sub_f32 v110, v110, v20
    v_sub_f32 v111, v111, v20
    v_exp_f32 v96, v96
    v_exp_f32 v97, v97
    v_exp_f32 v98, v98
    v_exp_f32 v99, v99
    v_exp_f32 v100, v100
    v_exp_f32 v101, v101
    v_exp_f32 v102, v102
    v_exp_f32 v103, v103
    v_exp_f32 v104, v104
    v_exp_f32 v105, v105
    v_exp_f32 v106, v106
    v_exp_f32 v107, v107
    v_exp_f32 v108, v108
    v_exp_f32 v109, v109
    v_exp_f32 v110, v110
    v_exp_f32 v111, v111
    v_cvt_pk_bf16_f32 v96, v96, v97
    v_cvt_pk_bf16_f32 v97, v98, v99
    v_cvt_pk_bf16_f32 v98, v100, v101
    v_cvt_pk_bf16_f32 v99, v102, v103
    v_cvt_pk_bf16_f32 v100, v104, v105
    v_cvt_pk_bf16_f32 v101, v106, v107
    v_cvt_pk_bf16_f32 v102, v108, v109
    v_cvt_pk_bf16_f32 v103, v110, v111
    s_waitcnt lgkmcnt(0)
    v_mfma_f32_32x32x16_bf16 v[80:95], v[38:41], v[96:99], v[80:95]
    v_mfma_f32_32x32x16_bf16 v[80:95], v[42:45], v[100:103], v[80:95]
    ds_read_b128 v[22:25], v18 offset:11776
    ds_read_b128 v[26:29], v19 offset:10240
    ds_read_b128 v[38:41], v63 offset:10240
    ds_read_b128 v[42:45], v63 offset:11520
    s_waitcnt lgkmcnt(3)
    v_mfma_f32_32x32x16_bf16 v[96:111], v[22:25], v[244:247], 0
    s_waitcnt lgkmcnt(2)
    v_mfma_f32_32x32x16_bf16 v[96:111], v[26:29], v[14:17], v[96:111]
    s_nop 11
    v_max_f32 v9, v96, v97
    v_max3_f32 v9, v9, v98, v99
    v_max3_f32 v9, v9, v100, v101
    v_max3_f32 v9, v9, v102, v103
    v_max3_f32 v9, v9, v104, v105
    v_max3_f32 v9, v9, v106, v107
    v_max3_f32 v9, v9, v108, v109
    v_max3_f32 v9, v9, v110, v111
    v_mov_b32 v7, v9
    s_nop 1
    v_permlane32_swap_b32 v9, v7
    v_max_f32 v9, v9, v7
    v_max_f32 v9, v9, v20
    v_sub_f32 v7, v20, v9
    v_exp_f32 v7, v7
    s_nop 0
    v_mul_f32 v80, v7, v80
    v_mul_f32 v81, v7, v81
    v_mul_f32 v82, v7, v82
    v_mul_f32 v83, v7, v83
    v_mul_f32 v84, v7, v84
    v_mul_f32 v85, v7, v85
    v_mul_f32 v86, v7, v86
    v_mul_f32 v87, v7, v87
    v_mul_f32 v88, v7, v88
    v_mul_f32 v89, v7, v89
    v_mul_f32 v90, v7, v90
    v_mul_f32 v91, v7, v91
    v_mul_f32 v92, v7, v92
    v_mul_f32 v93, v7, v93
    v_mul_f32 v94, v7, v94
    v_mul_f32 v95, v7, v95
    v_mov_b32 v20, v9
    v_sub_f32 v96, v96, v20
    v_sub_f32 v97, v97, v20
    v_sub_f32 v98, v98, v20
    v_sub_f32 v99, v99, v20
    v_sub_f32 v100, v100, v20
    v_sub_f32 v101, v101, v20
    v_sub_f32 v102, v102, v20
    v_sub_f32 v103, v103, v20
    v_sub_f32 v104, v104, v20
    v_sub_f32 v105, v105, v20
    v_sub_f32 v106, v106, v20
    v_sub_f32 v107, v107, v20
    v_sub_f32 v108, v108, v20
    v_sub_f32 v109, v109, v20
    v_sub_f32 v110, v110, v20
    v_sub_f32 v111, v111, v20
    v_exp_f32 v96, v96
    v_exp_f32 v97, v97
    v_exp_f32 v98, v98
    v_exp_f32 v99, v99
    v_exp_f32 v100, v100
    v_exp_f32 v101, v101
    v_exp_f32 v102, v102
    v_exp_f32 v103, v103
    v_exp_f32 v104, v104
    v_exp_f32 v105, v105
    v_exp_f32 v106, v106
    v_exp_f32 v107, v107
    v_exp_f32 v108, v108
    v_exp_f32 v109, v109
    v_exp_f32 v110, v110
    v_exp_f32 v111, v111
    v_cvt_pk_bf16_f32 v96, v96, v97
    v_cvt_pk_bf16_f32 v97, v98, v99
    v_cvt_pk_bf16_f32 v98, v100, v101
    v_cvt_pk_bf16_f32 v99, v102, v103
    v_cvt_pk_bf16_f32 v100, v104, v105
    v_cvt_pk_bf16_f32 v101, v106, v107
    v_cvt_pk_bf16_f32 v102, v108, v109
    v_cvt_pk_bf16_f32 v103, v110, v111
    s_waitcnt lgkmcnt(0)
    v_mfma_f32_32x32x16_bf16 v[80:95], v[38:41], v[96:99], v[80:95]
    v_mfma_f32_32x32x16_bf16 v[80:95], v[42:45], v[100:103], v[80:95]
    ds_read_b128 v[22:25], v18 offset:14336
    ds_read_b128 v[26:29], v19 offset:12800
    ds_read_b128 v[38:41], v63 offset:12800
    ds_read_b128 v[42:45], v63 offset:14080
    s_waitcnt lgkmcnt(3)
    v_mfma_f32_32x32x16_bf16 v[96:111], v[22:25], v[244:247], 0
    s_waitcnt lgkmcnt(2)
    v_mfma_f32_32x32x16_bf16 v[96:111], v[26:29], v[14:17], v[96:111]
    s_nop 11
    v_max_f32 v9, v96, v97
    v_max3_f32 v9, v9, v98, v99
    v_max3_f32 v9, v9, v100, v101
    v_max3_f32 v9, v9, v102, v103
    v_max3_f32 v9, v9, v104, v105
    v_max3_f32 v9, v9, v106, v107
    v_max3_f32 v9, v9, v108, v109
    v_max3_f32 v9, v9, v110, v111
    v_mov_b32 v7, v9
    s_nop 1
    v_permlane32_swap_b32 v9, v7
    v_max_f32 v9, v9, v7
    v_max_f32 v9, v9, v20
    v_sub_f32 v7, v20, v9
    v_exp_f32 v7, v7
    s_nop 0
    v_mul_f32 v80, v7, v80
    v_mul_f32 v81, v7, v81
    v_mul_f32 v82, v7, v82
    v_mul_f32 v83, v7, v83
    v_mul_f32 v84, v7, v84
    v_mul_f32 v85, v7, v85
    v_mul_f32 v86, v7, v86
    v_mul_f32 v87, v7, v87
    v_mul_f32 v88, v7, v88
    v_mul_f32 v89, v7, v89
    v_mul_f32 v90, v7, v90
    v_mul_f32 v91, v7, v91
    v_mul_f32 v92, v7, v92
    v_mul_f32 v93, v7, v93
    v_mul_f32 v94, v7, v94
    v_mul_f32 v95, v7, v95
    v_mov_b32 v20, v9
    v_sub_f32 v96, v96, v20
    v_sub_f32 v97, v97, v20
    v_sub_f32 v98, v98, v20
    v_sub_f32 v99, v99, v20
    v_sub_f32 v100, v100, v20
    v_sub_f32 v101, v101, v20
    v_sub_f32 v102, v102, v20
    v_sub_f32 v103, v103, v20
    v_sub_f32 v104, v104, v20
    v_sub_f32 v105, v105, v20
    v_sub_f32 v106, v106, v20
    v_sub_f32 v107, v107, v20
    v_sub_f32 v108, v108, v20
    v_sub_f32 v109, v109, v20
    v_sub_f32 v110, v110, v20
    v_sub_f32 v111, v111, v20
    v_exp_f32 v96, v96
    v_exp_f32 v97, v97
    v_exp_f32 v98, v98
    v_exp_f32 v99, v99
    v_exp_f32 v100, v100
    v_exp_f32 v101, v101
    v_exp_f32 v102, v102
    v_exp_f32 v103, v103
    v_exp_f32 v104, v104
    v_exp_f32 v105, v105
    v_exp_f32 v106, v106
    v_exp_f32 v107, v107
    v_exp_f32 v108, v108
    v_exp_f32 v109, v109
    v_exp_f32 v110, v110
    v_exp_f32 v111, v111
    v_cvt_pk_bf16_f32 v96, v96, v97
    v_cvt_pk_bf16_f32 v97, v98, v99
    v_cvt_pk_bf16_f32 v98, v100, v101
    v_cvt_pk_bf16_f32 v99, v102, v103
    v_cvt_pk_bf16_f32 v100, v104, v105
    v_cvt_pk_bf16_f32 v101, v106, v107
    v_cvt_pk_bf16_f32 v102, v108, v109
    v_cvt_pk_bf16_f32 v103, v110, v111
    s_waitcnt lgkmcnt(0)
    v_mfma_f32_32x32x16_bf16 v[80:95], v[38:41], v[96:99], v[80:95]
    v_mfma_f32_32x32x16_bf16 v[80:95], v[42:45], v[100:103], v[80:95]
    ds_read_b128 v[22:25], v18 offset:16896
    ds_read_b128 v[26:29], v19 offset:15360
    ds_read_b128 v[38:41], v63 offset:15360
    ds_read_b128 v[42:45], v63 offset:16640
    s_waitcnt lgkmcnt(3)
    v_mfma_f32_32x32x16_bf16 v[96:111], v[22:25], v[244:247], 0
    s_waitcnt lgkmcnt(2)
    v_mfma_f32_32x32x16_bf16 v[96:111], v[26:29], v[14:17], v[96:111]
    s_nop 11
    v_max_f32 v9, v96, v97
    v_max3_f32 v9, v9, v98, v99
    v_max3_f32 v9, v9, v100, v101
    v_max3_f32 v9, v9, v102, v103
    v_max3_f32 v9, v9, v104, v105
    v_max3_f32 v9, v9, v106, v107
    v_max3_f32 v9, v9, v108, v109
    v_max3_f32 v9, v9, v110, v111
    v_mov_b32 v7, v9
    s_nop 1
    v_permlane32_swap_b32 v9, v7
    v_max_f32 v9, v9, v7
    v_max_f32 v9, v9, v20
    v_sub_f32 v7, v20, v9
    v_exp_f32 v7, v7
    s_nop 0
    v_mul_f32 v80, v7, v80
    v_mul_f32 v81, v7, v81
    v_mul_f32 v82, v7, v82
    v_mul_f32 v83, v7, v83
    v_mul_f32 v84, v7, v84
    v_mul_f32 v85, v7, v85
    v_mul_f32 v86, v7, v86
    v_mul_f32 v87, v7, v87
    v_mul_f32 v88, v7, v88
    v_mul_f32 v89, v7, v89
    v_mul_f32 v90, v7, v90
    v_mul_f32 v91, v7, v91
    v_mul_f32 v92, v7, v92
    v_mul_f32 v93, v7, v93
    v_mul_f32 v94, v7, v94
    v_mul_f32 v95, v7, v95
    v_mov_b32 v20, v9
    v_sub_f32 v96, v96, v20
    v_sub_f32 v97, v97, v20
    v_sub_f32 v98, v98, v20
    v_sub_f32 v99, v99, v20
    v_sub_f32 v100, v100, v20
    v_sub_f32 v101, v101, v20
    v_sub_f32 v102, v102, v20
    v_sub_f32 v103, v103, v20
    v_sub_f32 v104, v104, v20
    v_sub_f32 v105, v105, v20
    v_sub_f32 v106, v106, v20
    v_sub_f32 v107, v107, v20
    v_sub_f32 v108, v108, v20
    v_sub_f32 v109, v109, v20
    v_sub_f32 v110, v110, v20
    v_sub_f32 v111, v111, v20
    v_exp_f32 v96, v96
    v_exp_f32 v97, v97
    v_exp_f32 v98, v98
    v_exp_f32 v99, v99
    v_exp_f32 v100, v100
    v_exp_f32 v101, v101
    v_exp_f32 v102, v102
    v_exp_f32 v103, v103
    v_exp_f32 v104, v104
    v_exp_f32 v105, v105
    v_exp_f32 v106, v106
    v_exp_f32 v107, v107
    v_exp_f32 v108, v108
    v_exp_f32 v109, v109
    v_exp_f32 v110, v110
    v_exp_f32 v111, v111
    v_cvt_pk_bf16_f32 v96, v96, v97
    v_cvt_pk_bf16_f32 v97, v98, v99
    v_cvt_pk_bf16_f32 v98, v100, v101
    v_cvt_pk_bf16_f32 v99, v102, v103
    v_cvt_pk_bf16_f32 v100, v104, v105
    v_cvt_pk_bf16_f32 v101, v106, v107
    v_cvt_pk_bf16_f32 v102, v108, v109
    v_cvt_pk_bf16_f32 v103, v110, v111
    s_waitcnt lgkmcnt(0)
    v_mfma_f32_32x32x16_bf16 v[80:95], v[38:41], v[96:99], v[80:95]
    v_mfma_f32_32x32x16_bf16 v[80:95], v[42:45], v[100:103], v[80:95]
    ds_read_b128 v[22:25], v18 offset:19456
    ds_read_b128 v[26:29], v19 offset:17920
    ds_read_b128 v[38:41], v63 offset:17920
    ds_read_b128 v[42:45], v63 offset:19200
    s_waitcnt lgkmcnt(3)
    v_mfma_f32_32x32x16_bf16 v[96:111], v[22:25], v[244:247], 0
    s_waitcnt lgkmcnt(2)
    v_mfma_f32_32x32x16_bf16 v[96:111], v[26:29], v[14:17], v[96:111]
    s_nop 11
    v_max_f32 v9, v96, v97
    v_max3_f32 v9, v9, v98, v99
    v_max3_f32 v9, v9, v100, v101
    v_max3_f32 v9, v9, v102, v103
    v_max3_f32 v9, v9, v104, v105
    v_max3_f32 v9, v9, v106, v107
    v_max3_f32 v9, v9, v108, v109
    v_max3_f32 v9, v9, v110, v111
    v_mov_b32 v7, v9
    s_nop 1
    v_permlane32_swap_b32 v9, v7
    v_max_f32 v9, v9, v7
    v_max_f32 v9, v9, v20
    v_sub_f32 v7, v20, v9
    v_exp_f32 v7, v7
    s_nop 0
    v_mul_f32 v80, v7, v80
    v_mul_f32 v81, v7, v81
    v_mul_f32 v82, v7, v82
    v_mul_f32 v83, v7, v83
    v_mul_f32 v84, v7, v84
    v_mul_f32 v85, v7, v85
    v_mul_f32 v86, v7, v86
    v_mul_f32 v87, v7, v87
    v_mul_f32 v88, v7, v88
    v_mul_f32 v89, v7, v89
    v_mul_f32 v90, v7, v90
    v_mul_f32 v91, v7, v91
    v_mul_f32 v92, v7, v92
    v_mul_f32 v93, v7, v93
    v_mul_f32 v94, v7, v94
    v_mul_f32 v95, v7, v95
    v_mov_b32 v20, v9
    v_sub_f32 v96, v96, v20
    v_sub_f32 v97, v97, v20
    v_sub_f32 v98, v98, v20
    v_sub_f32 v99, v99, v20
    v_sub_f32 v100, v100, v20
    v_sub_f32 v101, v101, v20
    v_sub_f32 v102, v102, v20
    v_sub_f32 v103, v103, v20
    v_sub_f32 v104, v104, v20
    v_sub_f32 v105, v105, v20
    v_sub_f32 v106, v106, v20
    v_sub_f32 v107, v107, v20
    v_sub_f32 v108, v108, v20
    v_sub_f32 v109, v109, v20
    v_sub_f32 v110, v110, v20
    v_sub_f32 v111, v111, v20
    v_exp_f32 v96, v96
    v_exp_f32 v97, v97
    v_exp_f32 v98, v98
    v_exp_f32 v99, v99
    v_exp_f32 v100, v100
    v_exp_f32 v101, v101
    v_exp_f32 v102, v102
    v_exp_f32 v103, v103
    v_exp_f32 v104, v104
    v_exp_f32 v105, v105
    v_exp_f32 v106, v106
    v_exp_f32 v107, v107
    v_exp_f32 v108, v108
    v_exp_f32 v109, v109
    v_exp_f32 v110, v110
    v_exp_f32 v111, v111
    v_cvt_pk_bf16_f32 v96, v96, v97
    v_cvt_pk_bf16_f32 v97, v98, v99
    v_cvt_pk_bf16_f32 v98, v100, v101
    v_cvt_pk_bf16_f32 v99, v102, v103
    v_cvt_pk_bf16_f32 v100, v104, v105
    v_cvt_pk_bf16_f32 v101, v106, v107
    v_cvt_pk_bf16_f32 v102, v108, v109
    v_cvt_pk_bf16_f32 v103, v110, v111
    s_waitcnt lgkmcnt(0)
    v_mfma_f32_32x32x16_bf16 v[80:95], v[38:41], v[96:99], v[80:95]
    v_mfma_f32_32x32x16_bf16 v[80:95], v[42:45], v[100:103], v[80:95]
    s_nop 15
    s_branch L_exact_done
.section .rodata,"a"
.p2align 6
.amdhsa_kernel parallel_sum__sliding_block__dense_activation_silu__prompt_kernel
  .amdhsa_next_free_vgpr 512
  .amdhsa_next_free_sgpr 102
  .amdhsa_accum_offset 256
  .amdhsa_group_segment_fixed_size 0
  .amdhsa_kernarg_size 72
  .amdhsa_user_sgpr_count 2
  .amdhsa_user_sgpr_kernarg_segment_ptr 1
  .amdhsa_system_sgpr_workgroup_id_x 1
.end_amdhsa_kernel
```
